```python
import torch

def _softmax(x, axis=-1):
    return torch.softmax(x, dim=axis)
def _gelu(x):
    return torch.nn.functional.gelu(x, approximate="tanh")
def _silu(x):
    return torch.nn.functional.silu(x)
def _sigmoid(x):
    return torch.sigmoid(x)
def _layernorm(x, axis=-1, eps=1e-5):
    m = x.mean(dim=axis, keepdim=True)
    v = x.var(dim=axis, keepdim=True, unbiased=False)
    return (x - m) / torch.sqrt(v + eps)
def _scatter_add(tgt, idx, src, axis=0):
    return tgt.clone().index_add_(axis, idx, src)
def _segment_sum(src, seg, n):
    out = torch.zeros((n,) + src.shape[1:], dtype=src.dtype)
    return out.index_add_(0, seg, src)
def _pad(x, pw):
    flat = tuple(v for pair in reversed(pw) for v in pair)
    return torch.nn.functional.pad(x, flat)

kernel_name = 'parallel_sum__softmax_full_mha__glu_gated_bilinear__prompt'

def setup_inputs():

    _w = (lambda a: (lambda t: t.to(torch.bfloat16) if t.is_floating_point() else t)(torch.as_tensor(a)))
    def _A_setup():
        B, S, D = 1, 2048, 1024
        return {
            "x": _w((lambda *s: torch.randn(*s, dtype=torch.bfloat16) * 0.05)(B, S, D)),
            "wqkv": _w((lambda *s: torch.randn(*s, dtype=torch.bfloat16) * 0.05)(D, 3 * D)),
            "wo": _w((lambda *s: torch.randn(*s, dtype=torch.bfloat16) * 0.05)(D, D)),
        }
    _A_in = _A_setup()

    def _B_setup():
        B, S, D, F = 1, 2048, 1024, 3584
        return {
            "x": _w((lambda *s: torch.randn(*s, dtype=torch.bfloat16) * 0.05)(B, S, D)),
            "w_gate": _w((lambda *s: torch.randn(*s, dtype=torch.bfloat16) * 0.8)(D, F) * (D ** -0.5)),
            "w_up": _w((lambda *s: torch.randn(*s, dtype=torch.bfloat16) * 0.8)(D, F) * (D ** -0.5)),
            "w_down": _w((lambda *s: torch.randn(*s, dtype=torch.bfloat16) * 0.8)(F, D) * (F ** -0.5)),
        }
    _B_in = _B_setup()

    return {
        "A_x": _A_in["x"],
        "A_wqkv": _A_in["wqkv"],
        "A_wo": _A_in["wo"],
        "B_x": _B_in["x"],
        "B_w_gate": _B_in["w_gate"],
        "B_w_up": _B_in["w_up"],
        "B_w_down": _B_in["w_down"],
    }

def reference(A_x, A_wqkv, A_wo, B_x, B_w_gate, B_w_up, B_w_down):
    def _A_ref(x, wqkv, wo):
        B, S, D = x.shape
        H = 32; Dh = D // H
        qkv = (lambda x, *d: x.permute(*d))((x @ wqkv).reshape(B, S, 3, H, Dh), 2, 0, 3, 1, 4)
        q, k, v = qkv[0], qkv[1], qkv[2]
        scale = Dh ** -0.5
        scores = torch.einsum("bhqd,bhkd->bhqk", q, k) * scale
        p = _softmax(scores, axis=-1)
        o = torch.einsum("bhqk,bhkd->bhqd", p, v)
        return (lambda x, *d: x.permute(*d))(o, 0, 2, 1, 3).reshape(B, S, D) @ wo

    def _B_ref(x, w_gate, w_up, w_down):
        g = torch.einsum("bsd,df->bsf", x, w_gate)
        u = torch.einsum("bsd,df->bsf", x, w_up)
        h = g * u
        return torch.einsum("bsf,fd->bsd", h, w_down)

    x = A_x
    xn = _layernorm(x, axis=-1)
    return x + _A_ref(xn, A_wqkv, A_wo) + _B_ref(xn, B_w_gate, B_w_up, B_w_down)
```

```asm
; @launch kernel=k1_gemm_kernel grid=(256,1,1) block=(512,1,1) lds=149568
; @launch kernel=k2_attn_kernel grid=(256,1,1) block=(512,1,1) lds=163840
.amdgcn_target "amdgcn-amd-amdhsa--gfx950"
.text
.globl k1_gemm_kernel
.p2align 8
.type k1_gemm_kernel,@function
k1_gemm_kernel:
  s_cmp_ge_u32 s2, 256
  s_cbranch_scc1 L_k1_end
  s_load_dwordx4 s[60:63], s[0:1], 0
  s_load_dwordx4 s[8:11], s[0:1], 32
  s_load_dwordx4 s[4:7], s[0:1], 64
  v_and_b32 v1, 63, v0
  v_lshrrev_b32 v12, 6, v0
  s_lshr_b32 s41, s2, 5
  v_readfirstlane_b32 s40, v12
  s_and_b32 s42, s2, 7
  s_lshl_b32 s42, s42, 2
  s_lshr_b32 s3, s2, 3
  s_and_b32 s3, s3, 3
  s_add_u32 s42, s42, s3
  s_and_b32 s48, s40, 3
  s_lshr_b32 s49, s40, 2
  s_cmp_eq_u32 s3, 3
  s_cselect_b32 s59, 6, 7
  s_lshl_b32 s59, s59, 10
  s_lshl_b32 s45, s59, 5
  v_lshrrev_b32 v13, 4, v1
  v_lshrrev_b32 v14, 3, v1
  v_and_b32 v15, 7, v1
  v_mov_b32 v35, 0
  v_mov_b32 v90, 0
  v_mov_b32 v91, 0
  s_mov_b32 s66, 0
  s_mov_b32 s56, 0x8000
  s_mov_b32 s57, 0x10000
  s_mov_b32 s58, 0x18000
  s_cmp_eq_u32 s49, 0
  s_cbranch_scc0 L_k1_a1
  v_xor_b32 v10, v15, v13
  v_lshlrev_b32 v10, 4, v10
  v_lshl_add_u32 v10, v14, 11, v10
  s_lshl_b32 s3, s48, 17
  v_add_u32 v10, s3, v10
  v_xor_b32 v11, 64, v10
  v_add_u32 v11, 0x4000, v11
  s_lshl_b32 s46, s48, 13
  s_add_u32 s46, s46, 81920
  s_lshl_b32 s3, s42, 2
  s_add_u32 s3, s3, s48
  s_lshl_b32 s3, s3, 1
  v_lshrrev_b32 v91, 5, v1
  v_add_u32 v91, s3, v91
  v_and_b32 v90, 31, v1
  v_lshlrev_b32 v90, 4, v90
  v_lshl_add_u32 v90, v91, 11, v90
  v_lshlrev_b32 v91, 3, v91
  s_lshl_b32 s66, s41, 11
  s_branch L_k1_a2
L_k1_a1:
  s_and_b32 s3, s48, 1
  s_lshl_b32 s3, s3, 2
  v_and_b32 v12, 1, v13
  v_lshlrev_b32 v12, 1, v12
  v_or_b32 v12, s3, v12
  v_xor_b32 v12, v12, v15
  v_lshlrev_b32 v12, 4, v12
  s_lshl_b32 s3, s48, 3
  v_add_u32 v14, s3, v14
  s_movk_i32 s3, 6144
  v_mad_u32_u24 v10, v14, s3, v12
  v_mad_u32_u24 v35, v14, s59, v12
  s_movk_i32 s3, 7168
  v_mad_u32_u24 v11, v14, s3, v12
  s_lshl_b32 s46, s48, 10
L_k1_a2:
  s_waitcnt lgkmcnt(0)
  s_lshl_b32 s3, s41, 19
  s_add_u32 s12, s60, s3
  s_addc_u32 s13, s61, 0
  s_mov_b32 s14, 524288
  s_mov_b32 s15, 0x20000
  s_mov_b32 s36, s6
  s_mov_b32 s37, s7
  s_mov_b32 s38, 41943040
  s_mov_b32 s39, 0x20000
  s_mov_b32 s68, s4
  s_mov_b32 s69, s5
  s_mov_b32 s70, 256
  s_mov_b32 s71, 0x20000
  s_mov_b32 s4, s62
  s_mov_b32 s5, s63
  s_lshl_b32 s72, s41, 5
  s_lshr_b32 s50, s42, 2
  s_and_b32 s51, s42, 3
  s_lshl_b32 s60, s50, 1
  s_add_u32 s60, s60, s51
  s_add_u32 s60, s60, 32
  s_sub_u32 s3, s42, 2
  s_cmp_ge_u32 s51, 2
  s_cselect_b32 s60, s3, s60
  s_mul_i32 s63, s50, 3
  s_add_u32 s63, s63, s51
  s_lshl_b32 s63, s63, 1
  s_add_u32 s3, s50, 48
  s_cmp_eq_u32 s51, 3
  s_cselect_b32 s63, s3, s63
  s_lshl_b32 s3, s60, 7
  s_lshl_b32 s61, s63, 7
  s_add_u32 s16, s4, s3
  s_addc_u32 s17, s5, 0
  s_sub_u32 s18, 6291456, s3
  s_mov_b32 s19, 0x20000
  s_add_u32 s20, s8, s61
  s_addc_u32 s21, s9, 0
  s_sub_u32 s22, 7340032, s61
  s_mov_b32 s23, 0x20000
  s_add_u32 s28, s10, s61
  s_addc_u32 s29, s11, 0
  s_sub_u32 s30, 7340032, s61
  s_mov_b32 s31, 0x20000
  s_cmp_eq_u32 s51, 3
  s_cbranch_scc1 L_k1_typeC
  s_add_u32 s61, s61, 128
  s_add_u32 s24, s8, s61
  s_addc_u32 s25, s9, 0
  s_sub_u32 s26, 7340032, s61
  s_mov_b32 s27, 0x20000
  s_add_u32 s32, s10, s61
  s_addc_u32 s33, s11, 0
  s_sub_u32 s34, 7340032, s61
  s_mov_b32 s35, 0x20000
  s_branch L_k1_srd_done
L_k1_typeC:
  s_add_u32 s3, s3, 128
  s_add_u32 s24, s4, s3
  s_addc_u32 s25, s5, 0
  s_sub_u32 s26, 6291456, s3
  s_mov_b32 s27, 0x20000
  s_add_u32 s3, s3, 128
  s_add_u32 s32, s4, s3
  s_addc_u32 s33, s5, 0
  s_sub_u32 s34, 6291456, s3
  s_mov_b32 s35, 0x20000
L_k1_srd_done:
  s_add_u32 s63, s63, s49
  s_mov_b32 s73, 0
  s_mov_b32 s43, 0
  s_mov_b32 s44, 0
  s_cmp_eq_u32 s49, 0
  s_cbranch_scc0 L_k1_role1
  s_bitcmp0_b32 s42, 1
  s_cbranch_scc1 L_k1_r0s
  buffer_load_dwordx4 v[36:39], v90, s[12:15], 0 offen offset:0
  buffer_load_dwordx4 v[40:43], v90, s[12:15], 0 offen offset:512
  buffer_load_dwordx4 v[44:47], v90, s[12:15], 0 offen offset:1024
  buffer_load_dwordx4 v[48:51], v90, s[12:15], 0 offen offset:1536
  s_add_u32 m0, s46, 0
  s_nop 0
  buffer_load_dwordx4 v10, s[12:15], 0 offen lds
  s_add_u32 m0, s46, 1024
  s_nop 0
  buffer_load_dwordx4 v11, s[12:15], 0 offen lds
  s_add_u32 m0, s46, 2048
  s_nop 0
  buffer_load_dwordx4 v10, s[12:15], s56 offen lds
  s_add_u32 m0, s46, 3072
  s_nop 0
  buffer_load_dwordx4 v11, s[12:15], s56 offen lds
  s_add_u32 m0, s46, 4096
  s_nop 0
  buffer_load_dwordx4 v10, s[12:15], s57 offen lds
  s_add_u32 m0, s46, 5120
  s_nop 0
  buffer_load_dwordx4 v11, s[12:15], s57 offen lds
  s_add_u32 m0, s46, 6144
  s_nop 0
  buffer_load_dwordx4 v10, s[12:15], s58 offen lds
  s_add_u32 m0, s46, 7168
  s_nop 0
  buffer_load_dwordx4 v11, s[12:15], s58 offen lds
  v_add_u32 v10, 128, v10
  v_add_u32 v11, 128, v11
  v_lshrrev_b32 v13, 4, v1
  v_and_b32 v34, 15, v1
  v_lshrrev_b32 v2, 1, v34
  v_xor_b32 v2, v2, v13
  v_lshlrev_b32 v2, 4, v2
  v_lshl_add_u32 v2, v34, 7, v2
  s_lshl_b32 s3, s48, 13
  s_add_u32 s3, s3, 81920
  v_add_u32 v2, s3, v2
  v_xor_b32 v3, 64, v2
  v_lshrrev_b32 v14, 2, v34
  v_lshl_add_u32 v15, v13, 3, v14
  v_lshlrev_b32 v15, 7, v15
  v_lshrrev_b32 v14, 1, v14
  v_lshl_add_u32 v15, v14, 5, v15
  v_and_b32 v14, 1, v13
  v_lshl_add_u32 v15, v14, 6, v15
  v_and_b32 v14, 3, v1
  v_lshl_add_u32 v15, v14, 3, v15
  s_lshl_b32 s3, s49, 6
  v_xor_b32 v8, s3, v15
  v_xor_b32 v9, 32, v8
  s_lshl_b32 s3, s48, 5
  v_xor_b32 v4, s3, v15
  s_add_u32 s3, s49, 1
  s_lshl_b32 s3, s3, 14
  v_add_u32 v4, s3, v4
  v_xor_b32 v5, 32, v4
  v_xor_b32 v6, 64, v4
  v_xor_b32 v7, 96, v4
  v_bfe_u32 v14, v1, 1, 1
  v_lshrrev_b32 v15, 5, v1
  v_cmp_eq_u32 vcc, v14, v15
  v_mov_b32 v14, 0x3f803f80
  s_nop 0
  v_cndmask_b32 v12, 0, v14, vcc
  v_and_b32 v14, 1, v1
  v_cmp_eq_u32 vcc, 0, v14
  v_mov_b32 v14, 0x44444444
  v_mov_b32 v15, 0xeeeeeeee
  v_cndmask_b32 v16, v15, v14, vcc
  v_mov_b32 v13, v12
  v_mov_b32 v14, v12
  v_mov_b32 v15, v12
  v_mov_b32 v17, 1
  v_lshlrev_b32 v34, 3, v34
  s_lshl_b32 s67, s41, 2
  s_add_u32 s67, s67, s48
  s_lshl_b32 s67, s67, 9
  v_mov_b32 v96, 0
  v_mov_b32 v97, 0
  v_mov_b32 v98, 0
  v_mov_b32 v99, 0
  v_mov_b32 v100, 0
  v_mov_b32 v101, 0
  v_mov_b32 v102, 0
  v_mov_b32 v103, 0
  v_mov_b32 v104, 0
  v_mov_b32 v105, 0
  v_mov_b32 v106, 0
  v_mov_b32 v107, 0
  v_mov_b32 v108, 0
  v_mov_b32 v109, 0
  v_mov_b32 v110, 0
  v_mov_b32 v111, 0
  v_mov_b32 v112, 0
  v_mov_b32 v113, 0
  v_mov_b32 v114, 0
  v_mov_b32 v115, 0
  v_mov_b32 v116, 0
  v_mov_b32 v117, 0
  v_mov_b32 v118, 0
  v_mov_b32 v119, 0
  v_mov_b32 v120, 0
  v_mov_b32 v121, 0
  v_mov_b32 v122, 0
  v_mov_b32 v123, 0
  v_mov_b32 v124, 0
  v_mov_b32 v125, 0
  v_mov_b32 v126, 0
  v_mov_b32 v127, 0
  v_mov_b32 v128, 0
  v_mov_b32 v129, 0
  v_mov_b32 v130, 0
  v_mov_b32 v131, 0
  v_mov_b32 v132, 0
  v_mov_b32 v133, 0
  v_mov_b32 v134, 0
  v_mov_b32 v135, 0
  v_mov_b32 v136, 0
  v_mov_b32 v137, 0
  v_mov_b32 v138, 0
  v_mov_b32 v139, 0
  v_mov_b32 v140, 0
  v_mov_b32 v141, 0
  v_mov_b32 v142, 0
  v_mov_b32 v143, 0
  v_mov_b32 v144, 0
  v_mov_b32 v145, 0
  v_mov_b32 v146, 0
  v_mov_b32 v147, 0
  v_mov_b32 v148, 0
  v_mov_b32 v149, 0
  v_mov_b32 v150, 0
  v_mov_b32 v151, 0
  v_mov_b32 v152, 0
  v_mov_b32 v153, 0
  v_mov_b32 v154, 0
  v_mov_b32 v155, 0
  v_mov_b32 v156, 0
  v_mov_b32 v157, 0
  v_mov_b32 v158, 0
  v_mov_b32 v159, 0
  v_mov_b32 v160, 0
  v_mov_b32 v161, 0
  v_mov_b32 v162, 0
  v_mov_b32 v163, 0
  v_mov_b32 v164, 0
  v_mov_b32 v165, 0
  v_mov_b32 v166, 0
  v_mov_b32 v167, 0
  v_mov_b32 v168, 0
  v_mov_b32 v169, 0
  v_mov_b32 v170, 0
  v_mov_b32 v171, 0
  v_mov_b32 v172, 0
  v_mov_b32 v173, 0
  v_mov_b32 v174, 0
  v_mov_b32 v175, 0
  v_mov_b32 v176, 0
  v_mov_b32 v177, 0
  v_mov_b32 v178, 0
  v_mov_b32 v179, 0
  v_mov_b32 v180, 0
  v_mov_b32 v181, 0
  v_mov_b32 v182, 0
  v_mov_b32 v183, 0
  v_mov_b32 v184, 0
  v_mov_b32 v185, 0
  v_mov_b32 v186, 0
  v_mov_b32 v187, 0
  v_mov_b32 v188, 0
  v_mov_b32 v189, 0
  v_mov_b32 v190, 0
  v_mov_b32 v191, 0
  v_mov_b32 v192, 0
  v_mov_b32 v193, 0
  v_mov_b32 v194, 0
  v_mov_b32 v195, 0
  v_mov_b32 v196, 0
  v_mov_b32 v197, 0
  v_mov_b32 v198, 0
  v_mov_b32 v199, 0
  v_mov_b32 v200, 0
  v_mov_b32 v201, 0
  v_mov_b32 v202, 0
  v_mov_b32 v203, 0
  v_mov_b32 v204, 0
  v_mov_b32 v205, 0
  v_mov_b32 v206, 0
  v_mov_b32 v207, 0
  v_mov_b32 v208, 0
  v_mov_b32 v209, 0
  v_mov_b32 v210, 0
  v_mov_b32 v211, 0
  v_mov_b32 v212, 0
  v_mov_b32 v213, 0
  v_mov_b32 v214, 0
  v_mov_b32 v215, 0
  v_mov_b32 v216, 0
  v_mov_b32 v217, 0
  v_mov_b32 v218, 0
  v_mov_b32 v219, 0
  v_mov_b32 v220, 0
  v_mov_b32 v221, 0
  v_mov_b32 v222, 0
  v_mov_b32 v223, 0
  v_mov_b32 v224, 0
  v_mov_b32 v225, 0
  v_mov_b32 v226, 0
  v_mov_b32 v227, 0
  v_mov_b32 v228, 0
  v_mov_b32 v229, 0
  v_mov_b32 v230, 0
  v_mov_b32 v231, 0
  v_mov_b32 v232, 0
  v_mov_b32 v233, 0
  v_mov_b32 v234, 0
  v_mov_b32 v235, 0
  v_mov_b32 v236, 0
  v_mov_b32 v237, 0
  v_mov_b32 v238, 0
  v_mov_b32 v239, 0
  v_mov_b32 v240, 0
  v_mov_b32 v241, 0
  v_mov_b32 v242, 0
  v_mov_b32 v243, 0
  v_mov_b32 v244, 0
  v_mov_b32 v245, 0
  v_mov_b32 v246, 0
  v_mov_b32 v247, 0
  v_mov_b32 v248, 0
  v_mov_b32 v249, 0
  v_mov_b32 v250, 0
  v_mov_b32 v251, 0
  v_mov_b32 v252, 0
  v_mov_b32 v253, 0
  v_mov_b32 v254, 0
  v_mov_b32 v255, 0
  v_mov_b32 v26, 0
  v_mov_b32 v27, 0
  v_mov_b32 v28, 0
  v_mov_b32 v29, 0
  v_mov_b32 v30, 0
  v_mov_b32 v31, 0
  v_mov_b32 v32, 0
  v_mov_b32 v33, 0
  v_mov_b32 v92, 149504
  ds_write_b128 v92, v[96:99]
  ds_write_b128 v92, v[96:99] offset:16
  s_waitcnt vmcnt(8)
  v_lshlrev_b32 v52, 16, v36
  v_and_b32 v53, 0xffff0000, v36
  v_lshlrev_b32 v54, 16, v37
  v_and_b32 v55, 0xffff0000, v37
  v_lshlrev_b32 v56, 16, v38
  v_and_b32 v57, 0xffff0000, v38
  v_lshlrev_b32 v58, 16, v39
  v_and_b32 v59, 0xffff0000, v39
  v_lshlrev_b32 v60, 16, v40
  v_and_b32 v61, 0xffff0000, v40
  v_lshlrev_b32 v62, 16, v41
  v_and_b32 v63, 0xffff0000, v41
  v_lshlrev_b32 v64, 16, v42
  v_and_b32 v65, 0xffff0000, v42
  v_lshlrev_b32 v66, 16, v43
  v_and_b32 v67, 0xffff0000, v43
  v_lshlrev_b32 v68, 16, v44
  v_and_b32 v69, 0xffff0000, v44
  v_lshlrev_b32 v70, 16, v45
  v_and_b32 v71, 0xffff0000, v45
  v_lshlrev_b32 v72, 16, v46
  v_and_b32 v73, 0xffff0000, v46
  v_lshlrev_b32 v74, 16, v47
  v_and_b32 v75, 0xffff0000, v47
  v_lshlrev_b32 v76, 16, v48
  v_and_b32 v77, 0xffff0000, v48
  v_lshlrev_b32 v78, 16, v49
  v_and_b32 v79, 0xffff0000, v49
  v_lshlrev_b32 v80, 16, v50
  v_and_b32 v81, 0xffff0000, v50
  v_lshlrev_b32 v82, 16, v51
  v_and_b32 v83, 0xffff0000, v51
  v_pk_add_f32 v[84:85], v[52:53], v[54:55]
  v_pk_add_f32 v[86:87], v[56:57], v[58:59]
  v_pk_add_f32 v[84:85], v[84:85], v[60:61]
  v_pk_add_f32 v[86:87], v[86:87], v[62:63]
  v_pk_add_f32 v[84:85], v[84:85], v[64:65]
  v_pk_add_f32 v[86:87], v[86:87], v[66:67]
  v_pk_add_f32 v[84:85], v[84:85], v[68:69]
  v_pk_add_f32 v[86:87], v[86:87], v[70:71]
  v_pk_add_f32 v[84:85], v[84:85], v[72:73]
  v_pk_add_f32 v[86:87], v[86:87], v[74:75]
  v_pk_add_f32 v[84:85], v[84:85], v[76:77]
  v_pk_add_f32 v[86:87], v[86:87], v[78:79]
  v_pk_add_f32 v[84:85], v[84:85], v[80:81]
  v_pk_add_f32 v[86:87], v[86:87], v[82:83]
  v_pk_add_f32 v[84:85], v[84:85], v[86:87]
  v_add_f32 v84, v84, v85
  s_nop 1
  v_add_f32_dpp v84, v84, v84 quad_perm:[1,0,3,2] row_mask:0xf bank_mask:0xf
  s_nop 1
  v_add_f32_dpp v84, v84, v84 quad_perm:[2,3,0,1] row_mask:0xf bank_mask:0xf
  s_nop 1
  v_add_f32_dpp v84, v84, v84 row_half_mirror row_mask:0xf bank_mask:0xf
  s_nop 1
  v_add_f32_dpp v84, v84, v84 row_mirror row_mask:0xf bank_mask:0xf
  s_nop 1
  v_mov_b32 v85, v84
  s_nop 1
  v_permlane16_swap_b32 v84, v85
  s_nop 1
  v_add_f32 v84, v84, v85
  v_mul_f32 v84, 0xba800000, v84
  v_pk_add_f32 v[52:53], v[52:53], v[84:85] op_sel_hi:[1,0]
  v_pk_add_f32 v[54:55], v[54:55], v[84:85] op_sel_hi:[1,0]
  v_pk_add_f32 v[56:57], v[56:57], v[84:85] op_sel_hi:[1,0]
  v_pk_add_f32 v[58:59], v[58:59], v[84:85] op_sel_hi:[1,0]
  v_pk_add_f32 v[60:61], v[60:61], v[84:85] op_sel_hi:[1,0]
  v_pk_add_f32 v[62:63], v[62:63], v[84:85] op_sel_hi:[1,0]
  v_pk_add_f32 v[64:65], v[64:65], v[84:85] op_sel_hi:[1,0]
  v_pk_add_f32 v[66:67], v[66:67], v[84:85] op_sel_hi:[1,0]
  v_pk_add_f32 v[68:69], v[68:69], v[84:85] op_sel_hi:[1,0]
  v_pk_add_f32 v[70:71], v[70:71], v[84:85] op_sel_hi:[1,0]
  v_pk_add_f32 v[72:73], v[72:73], v[84:85] op_sel_hi:[1,0]
  v_pk_add_f32 v[74:75], v[74:75], v[84:85] op_sel_hi:[1,0]
  v_pk_add_f32 v[76:77], v[76:77], v[84:85] op_sel_hi:[1,0]
  v_pk_add_f32 v[78:79], v[78:79], v[84:85] op_sel_hi:[1,0]
  v_pk_add_f32 v[80:81], v[80:81], v[84:85] op_sel_hi:[1,0]
  v_pk_add_f32 v[82:83], v[82:83], v[84:85] op_sel_hi:[1,0]
  v_pk_mul_f32 v[86:87], v[52:53], v[52:53]
  v_pk_mul_f32 v[88:89], v[54:55], v[54:55]
  v_pk_fma_f32 v[86:87], v[56:57], v[56:57], v[86:87]
  v_pk_fma_f32 v[88:89], v[58:59], v[58:59], v[88:89]
  v_pk_fma_f32 v[86:87], v[60:61], v[60:61], v[86:87]
  v_pk_fma_f32 v[88:89], v[62:63], v[62:63], v[88:89]
  v_pk_fma_f32 v[86:87], v[64:65], v[64:65], v[86:87]
  v_pk_fma_f32 v[88:89], v[66:67], v[66:67], v[88:89]
  v_pk_fma_f32 v[86:87], v[68:69], v[68:69], v[86:87]
  v_pk_fma_f32 v[88:89], v[70:71], v[70:71], v[88:89]
  v_pk_fma_f32 v[86:87], v[72:73], v[72:73], v[86:87]
  v_pk_fma_f32 v[88:89], v[74:75], v[74:75], v[88:89]
  v_pk_fma_f32 v[86:87], v[76:77], v[76:77], v[86:87]
  v_pk_fma_f32 v[88:89], v[78:79], v[78:79], v[88:89]
  v_pk_fma_f32 v[86:87], v[80:81], v[80:81], v[86:87]
  v_pk_fma_f32 v[88:89], v[82:83], v[82:83], v[88:89]
  v_pk_add_f32 v[86:87], v[86:87], v[88:89]
  v_add_f32 v86, v86, v87
  s_nop 1
  v_add_f32_dpp v86, v86, v86 quad_perm:[1,0,3,2] row_mask:0xf bank_mask:0xf
  s_nop 1
  v_add_f32_dpp v86, v86, v86 quad_perm:[2,3,0,1] row_mask:0xf bank_mask:0xf
  s_nop 1
  v_add_f32_dpp v86, v86, v86 row_half_mirror row_mask:0xf bank_mask:0xf
  s_nop 1
  v_add_f32_dpp v86, v86, v86 row_mirror row_mask:0xf bank_mask:0xf
  s_nop 1
  v_mov_b32 v87, v86
  s_nop 1
  v_permlane16_swap_b32 v86, v87
  s_nop 1
  v_add_f32 v86, v86, v87
  v_mov_b32 v85, 0x3727c5ac
  v_fmac_f32 v85, 0x3a800000, v86
  v_rsq_f32 v85, v85
  s_mov_b32 exec_lo, 1
  s_mov_b32 exec_hi, 1
  buffer_store_dwordx2 v[84:85], v91, s[36:39], s66 offen sc1
  s_mov_b64 exec, -1
  s_lshl_b32 s3, s2, 2
  s_add_u32 s3, s3, s48
  s_lshl_b32 s3, s3, 8
  s_add_u32 s3, s3, 2097152
  v_lshlrev_b32 v93, 2, v1
  buffer_store_dword v96, v93, s[36:39], s3 offen sc1
  s_waitcnt vmcnt(2) lgkmcnt(0)
  s_barrier
  ds_read_b128 v[36:39], v2 offset:0
  ds_read_b128 v[40:43], v2 offset:2048
  ds_read_b128 v[44:47], v2 offset:4096
  ds_read_b128 v[48:51], v2 offset:6144
  ds_read_b64_tr_b16 v[68:69], v4 offset:0
  ds_read_b64_tr_b16 v[70:71], v4 offset:512
  ds_read_b64_tr_b16 v[72:73], v4 offset:32768
  ds_read_b64_tr_b16 v[74:75], v4 offset:33280
  ds_read_b64_tr_b16 v[76:77], v8 offset:0
  ds_read_b64_tr_b16 v[78:79], v8 offset:512
  s_add_u32 m0, s46, 32768
  s_nop 0
  buffer_load_dwordx4 v10, s[12:15], 0 offen lds
  s_add_u32 m0, s46, 33792
  s_nop 0
  buffer_load_dwordx4 v11, s[12:15], 0 offen lds
  s_add_u32 m0, s46, 34816
  s_nop 0
  buffer_load_dwordx4 v10, s[12:15], s56 offen lds
  s_add_u32 m0, s46, 35840
  s_nop 0
  buffer_load_dwordx4 v11, s[12:15], s56 offen lds
  s_mov_b32 s47, 7
  s_mov_b32 s66, 6
L_k1loop_1:
  s_waitcnt lgkmcnt(4)
  s_setprio 2
  v_mfma_f32_16x16x32_bf16 v[96:99], v[68:71], v[36:39], v[96:99]
  ds_read_b64_tr_b16 v[80:81], v9 offset:0
  s_add_u32 m0, s46, 36864
  v_mfma_f32_16x16x32_bf16 v[100:103], v[68:71], v[40:43], v[100:103]
  ds_read_b64_tr_b16 v[82:83], v9 offset:512
  buffer_load_dwordx4 v10, s[12:15], s57 offen lds
  v_mfma_f32_16x16x32_bf16 v[104:107], v[68:71], v[44:47], v[104:107]
  s_add_u32 m0, s46, 37888
  v_mfma_f32_16x16x32_bf16 v[108:111], v[68:71], v[48:51], v[108:111]
  buffer_load_dwordx4 v11, s[12:15], s57 offen lds
  s_waitcnt lgkmcnt(4)
  v_smfmac_f32_16x16x64_bf16 v[26:29], v[12:15], v[68:75], v16
  v_mfma_f32_16x16x32_bf16 v[112:115], v[72:75], v[36:39], v[112:115]
  ds_read_b64_tr_b16 v[68:69], v5 offset:0
  s_add_u32 m0, s46, 38912
  v_mfma_f32_16x16x32_bf16 v[116:119], v[72:75], v[40:43], v[116:119]
  ds_read_b64_tr_b16 v[70:71], v5 offset:512
  buffer_load_dwordx4 v10, s[12:15], s58 offen lds
  v_mfma_f32_16x16x32_bf16 v[120:123], v[72:75], v[44:47], v[120:123]
  s_add_u32 m0, s46, 39936
  v_mfma_f32_16x16x32_bf16 v[124:127], v[72:75], v[48:51], v[124:127]
  buffer_load_dwordx4 v11, s[12:15], s58 offen lds
  v_add_u32 v10, 128, v10
  v_add_u32 v11, 128, v11
  s_waitcnt lgkmcnt(4)
  v_mfma_f32_16x16x32_bf16 v[128:131], v[76:79], v[36:39], v[128:131]
  ds_read_b64_tr_b16 v[72:73], v5 offset:32768
  v_mfma_f32_16x16x32_bf16 v[132:135], v[76:79], v[40:43], v[132:135]
  ds_read_b64_tr_b16 v[74:75], v5 offset:33280
  v_mfma_f32_16x16x32_bf16 v[136:139], v[76:79], v[44:47], v[136:139]
  v_mfma_f32_16x16x32_bf16 v[140:143], v[76:79], v[48:51], v[140:143]
  s_waitcnt lgkmcnt(4)
  s_setprio 1
  s_cmp_lg_u32 s48, 0
  s_cbranch_scc1 L_k1sk_4
  v_smfmac_f32_16x16x64_bf16 v[30:33], v[12:15], v[76:83], v16
L_k1sk_4:
  v_mfma_f32_16x16x32_bf16 v[144:147], v[80:83], v[36:39], v[144:147]
  ds_read_b64_tr_b16 v[76:77], v6 offset:0
  v_mfma_f32_16x16x32_bf16 v[148:151], v[80:83], v[40:43], v[148:151]
  ds_read_b64_tr_b16 v[78:79], v6 offset:512
  v_mfma_f32_16x16x32_bf16 v[152:155], v[80:83], v[44:47], v[152:155]
  v_mfma_f32_16x16x32_bf16 v[156:159], v[80:83], v[48:51], v[156:159]
  s_waitcnt lgkmcnt(4)
  v_mfma_f32_16x16x32_bf16 v[160:163], v[68:71], v[36:39], v[160:163]
  ds_read_b64_tr_b16 v[80:81], v6 offset:32768
  v_mfma_f32_16x16x32_bf16 v[164:167], v[68:71], v[40:43], v[164:167]
  ds_read_b64_tr_b16 v[82:83], v6 offset:33280
  v_mfma_f32_16x16x32_bf16 v[168:171], v[68:71], v[44:47], v[168:171]
  v_mfma_f32_16x16x32_bf16 v[172:175], v[68:71], v[48:51], v[172:175]
  s_waitcnt lgkmcnt(4)
  s_setprio 0
  v_mfma_f32_16x16x32_bf16 v[176:179], v[72:75], v[36:39], v[176:179]
  ds_read_b64_tr_b16 v[68:69], v7 offset:0
  v_mfma_f32_16x16x32_bf16 v[180:183], v[72:75], v[40:43], v[180:183]
  ds_read_b64_tr_b16 v[70:71], v7 offset:512
  v_mfma_f32_16x16x32_bf16 v[184:187], v[72:75], v[44:47], v[184:187]
  v_mfma_f32_16x16x32_bf16 v[188:191], v[72:75], v[48:51], v[188:191]
  s_waitcnt lgkmcnt(4)
  v_mfma_f32_16x16x32_bf16 v[192:195], v[76:79], v[36:39], v[192:195]
  ds_read_b64_tr_b16 v[72:73], v7 offset:32768
  v_mfma_f32_16x16x32_bf16 v[196:199], v[76:79], v[40:43], v[196:199]
  ds_read_b64_tr_b16 v[74:75], v7 offset:33280
  v_mfma_f32_16x16x32_bf16 v[200:203], v[76:79], v[44:47], v[200:203]
  v_mfma_f32_16x16x32_bf16 v[204:207], v[76:79], v[48:51], v[204:207]
  s_waitcnt lgkmcnt(0)
  s_barrier
  s_setprio 3
  v_mfma_f32_16x16x32_bf16 v[208:211], v[80:83], v[36:39], v[208:211]
  ds_read_b128 v[52:55], v3 offset:0
  ds_read_b128 v[56:59], v3 offset:2048
  v_mfma_f32_16x16x32_bf16 v[212:215], v[80:83], v[40:43], v[212:215]
  ds_read_b128 v[60:63], v3 offset:4096
  ds_read_b128 v[64:67], v3 offset:6144
  v_mfma_f32_16x16x32_bf16 v[216:219], v[80:83], v[44:47], v[216:219]
  ds_read_b64_tr_b16 v[76:77], v4 offset:4096
  ds_read_b64_tr_b16 v[78:79], v4 offset:4608
  v_mfma_f32_16x16x32_bf16 v[220:223], v[80:83], v[48:51], v[220:223]
  v_mfma_f32_16x16x32_bf16 v[224:227], v[68:71], v[36:39], v[224:227]
  ds_read_b64_tr_b16 v[80:81], v4 offset:36864
  v_mfma_f32_16x16x32_bf16 v[228:231], v[68:71], v[40:43], v[228:231]
  ds_read_b64_tr_b16 v[82:83], v4 offset:37376
  v_mfma_f32_16x16x32_bf16 v[232:235], v[68:71], v[44:47], v[232:235]
  v_mfma_f32_16x16x32_bf16 v[236:239], v[68:71], v[48:51], v[236:239]
  v_mfma_f32_16x16x32_bf16 v[240:243], v[72:75], v[36:39], v[240:243]
  ds_read_b64_tr_b16 v[68:69], v8 offset:4096
  v_mfma_f32_16x16x32_bf16 v[244:247], v[72:75], v[40:43], v[244:247]
  ds_read_b64_tr_b16 v[70:71], v8 offset:4608
  v_mfma_f32_16x16x32_bf16 v[248:251], v[72:75], v[44:47], v[248:251]
  v_mfma_f32_16x16x32_bf16 v[252:255], v[72:75], v[48:51], v[252:255]
  s_waitcnt lgkmcnt(4)
  s_setprio 2
  v_mfma_f32_16x16x32_bf16 v[96:99], v[76:79], v[52:55], v[96:99]
  ds_read_b64_tr_b16 v[72:73], v9 offset:4096
  v_mfma_f32_16x16x32_bf16 v[100:103], v[76:79], v[56:59], v[100:103]
  ds_read_b64_tr_b16 v[74:75], v9 offset:4608
  v_mfma_f32_16x16x32_bf16 v[104:107], v[76:79], v[60:63], v[104:107]
  v_mfma_f32_16x16x32_bf16 v[108:111], v[76:79], v[64:67], v[108:111]
  s_waitcnt lgkmcnt(4)
  v_smfmac_f32_16x16x64_bf16 v[26:29], v[12:15], v[76:83], v16
  v_mfma_f32_16x16x32_bf16 v[112:115], v[80:83], v[52:55], v[112:115]
  ds_read_b64_tr_b16 v[76:77], v5 offset:4096
  v_mfma_f32_16x16x32_bf16 v[116:119], v[80:83], v[56:59], v[116:119]
  ds_read_b64_tr_b16 v[78:79], v5 offset:4608
  v_mfma_f32_16x16x32_bf16 v[120:123], v[80:83], v[60:63], v[120:123]
  v_mfma_f32_16x16x32_bf16 v[124:127], v[80:83], v[64:67], v[124:127]
  s_waitcnt lgkmcnt(4)
  v_mfma_f32_16x16x32_bf16 v[128:131], v[68:71], v[52:55], v[128:131]
  ds_read_b64_tr_b16 v[80:81], v5 offset:36864
  v_mfma_f32_16x16x32_bf16 v[132:135], v[68:71], v[56:59], v[132:135]
  ds_read_b64_tr_b16 v[82:83], v5 offset:37376
  v_mfma_f32_16x16x32_bf16 v[136:139], v[68:71], v[60:63], v[136:139]
  v_mfma_f32_16x16x32_bf16 v[140:143], v[68:71], v[64:67], v[140:143]
  s_waitcnt lgkmcnt(4)
  s_setprio 1
  s_cmp_lg_u32 s48, 1
  s_cbranch_scc1 L_k1sk_5
  v_smfmac_f32_16x16x64_bf16 v[30:33], v[12:15], v[68:75], v16
L_k1sk_5:
  v_mfma_f32_16x16x32_bf16 v[144:147], v[72:75], v[52:55], v[144:147]
  ds_read_b64_tr_b16 v[68:69], v6 offset:4096
  v_mfma_f32_16x16x32_bf16 v[148:151], v[72:75], v[56:59], v[148:151]
  ds_read_b64_tr_b16 v[70:71], v6 offset:4608
  v_mfma_f32_16x16x32_bf16 v[152:155], v[72:75], v[60:63], v[152:155]
  v_mfma_f32_16x16x32_bf16 v[156:159], v[72:75], v[64:67], v[156:159]
  s_waitcnt lgkmcnt(4)
  v_mfma_f32_16x16x32_bf16 v[160:163], v[76:79], v[52:55], v[160:163]
  ds_read_b64_tr_b16 v[72:73], v6 offset:36864
  v_mfma_f32_16x16x32_bf16 v[164:167], v[76:79], v[56:59], v[164:167]
  ds_read_b64_tr_b16 v[74:75], v6 offset:37376
  v_mfma_f32_16x16x32_bf16 v[168:171], v[76:79], v[60:63], v[168:171]
  v_mfma_f32_16x16x32_bf16 v[172:175], v[76:79], v[64:67], v[172:175]
  s_waitcnt lgkmcnt(4)
  s_setprio 0
  v_mfma_f32_16x16x32_bf16 v[176:179], v[80:83], v[52:55], v[176:179]
  ds_read_b64_tr_b16 v[76:77], v7 offset:4096
  v_mfma_f32_16x16x32_bf16 v[180:183], v[80:83], v[56:59], v[180:183]
  ds_read_b64_tr_b16 v[78:79], v7 offset:4608
  v_mfma_f32_16x16x32_bf16 v[184:187], v[80:83], v[60:63], v[184:187]
  v_mfma_f32_16x16x32_bf16 v[188:191], v[80:83], v[64:67], v[188:191]
  s_waitcnt lgkmcnt(4)
  v_mfma_f32_16x16x32_bf16 v[192:195], v[68:71], v[52:55], v[192:195]
  ds_read_b64_tr_b16 v[80:81], v7 offset:36864
  v_mfma_f32_16x16x32_bf16 v[196:199], v[68:71], v[56:59], v[196:199]
  ds_read_b64_tr_b16 v[82:83], v7 offset:37376
  v_mfma_f32_16x16x32_bf16 v[200:203], v[68:71], v[60:63], v[200:203]
  v_mfma_f32_16x16x32_bf16 v[204:207], v[68:71], v[64:67], v[204:207]
  s_waitcnt vmcnt(0) lgkmcnt(0)
  s_barrier
  s_setprio 3
  v_mfma_f32_16x16x32_bf16 v[208:211], v[72:75], v[52:55], v[208:211]
  ds_read_b128 v[36:39], v2 offset:32768
  ds_read_b128 v[40:43], v2 offset:34816
  v_mfma_f32_16x16x32_bf16 v[212:215], v[72:75], v[56:59], v[212:215]
  ds_read_b128 v[44:47], v2 offset:36864
  ds_read_b128 v[48:51], v2 offset:38912
  v_mfma_f32_16x16x32_bf16 v[216:219], v[72:75], v[60:63], v[216:219]
  ds_read_b64_tr_b16 v[68:69], v4 offset:8192
  ds_read_b64_tr_b16 v[70:71], v4 offset:8704
  v_mfma_f32_16x16x32_bf16 v[220:223], v[72:75], v[64:67], v[220:223]
  v_mfma_f32_16x16x32_bf16 v[224:227], v[76:79], v[52:55], v[224:227]
  ds_read_b64_tr_b16 v[72:73], v4 offset:40960
  s_add_u32 m0, s46, 0
  v_mfma_f32_16x16x32_bf16 v[228:231], v[76:79], v[56:59], v[228:231]
  ds_read_b64_tr_b16 v[74:75], v4 offset:41472
  buffer_load_dwordx4 v10, s[12:15], 0 offen lds
  v_mfma_f32_16x16x32_bf16 v[232:235], v[76:79], v[60:63], v[232:235]
  s_add_u32 m0, s46, 1024
  v_mfma_f32_16x16x32_bf16 v[236:239], v[76:79], v[64:67], v[236:239]
  buffer_load_dwordx4 v11, s[12:15], 0 offen lds
  v_mfma_f32_16x16x32_bf16 v[240:243], v[80:83], v[52:55], v[240:243]
  ds_read_b64_tr_b16 v[76:77], v8 offset:8192
  s_add_u32 m0, s46, 2048
  v_mfma_f32_16x16x32_bf16 v[244:247], v[80:83], v[56:59], v[244:247]
  ds_read_b64_tr_b16 v[78:79], v8 offset:8704
  buffer_load_dwordx4 v10, s[12:15], s56 offen lds
  v_mfma_f32_16x16x32_bf16 v[248:251], v[80:83], v[60:63], v[248:251]
  s_add_u32 m0, s46, 3072
  v_mfma_f32_16x16x32_bf16 v[252:255], v[80:83], v[64:67], v[252:255]
  buffer_load_dwordx4 v11, s[12:15], s56 offen lds
  s_waitcnt lgkmcnt(4)
  s_setprio 2
  v_mfma_f32_16x16x32_bf16 v[96:99], v[68:71], v[36:39], v[96:99]
  ds_read_b64_tr_b16 v[80:81], v9 offset:8192
  s_add_u32 m0, s46, 4096
  v_mfma_f32_16x16x32_bf16 v[100:103], v[68:71], v[40:43], v[100:103]
  ds_read_b64_tr_b16 v[82:83], v9 offset:8704
  buffer_load_dwordx4 v10, s[12:15], s57 offen lds
  v_mfma_f32_16x16x32_bf16 v[104:107], v[68:71], v[44:47], v[104:107]
  s_add_u32 m0, s46, 5120
  v_mfma_f32_16x16x32_bf16 v[108:111], v[68:71], v[48:51], v[108:111]
  buffer_load_dwordx4 v11, s[12:15], s57 offen lds
  s_waitcnt lgkmcnt(4)
  v_smfmac_f32_16x16x64_bf16 v[26:29], v[12:15], v[68:75], v16
  v_mfma_f32_16x16x32_bf16 v[112:115], v[72:75], v[36:39], v[112:115]
  ds_read_b64_tr_b16 v[68:69], v5 offset:8192
  s_add_u32 m0, s46, 6144
  v_mfma_f32_16x16x32_bf16 v[116:119], v[72:75], v[40:43], v[116:119]
  ds_read_b64_tr_b16 v[70:71], v5 offset:8704
  buffer_load_dwordx4 v10, s[12:15], s58 offen lds
  v_mfma_f32_16x16x32_bf16 v[120:123], v[72:75], v[44:47], v[120:123]
  s_add_u32 m0, s46, 7168
  v_mfma_f32_16x16x32_bf16 v[124:127], v[72:75], v[48:51], v[124:127]
  buffer_load_dwordx4 v11, s[12:15], s58 offen lds
  v_add_u32 v10, 128, v10
  v_add_u32 v11, 128, v11
  s_waitcnt lgkmcnt(4)
  v_mfma_f32_16x16x32_bf16 v[128:131], v[76:79], v[36:39], v[128:131]
  ds_read_b64_tr_b16 v[72:73], v5 offset:40960
  v_mfma_f32_16x16x32_bf16 v[132:135], v[76:79], v[40:43], v[132:135]
  ds_read_b64_tr_b16 v[74:75], v5 offset:41472
  v_mfma_f32_16x16x32_bf16 v[136:139], v[76:79], v[44:47], v[136:139]
  v_mfma_f32_16x16x32_bf16 v[140:143], v[76:79], v[48:51], v[140:143]
  s_waitcnt lgkmcnt(4)
  s_setprio 1
  s_cmp_lg_u32 s48, 2
  s_cbranch_scc1 L_k1sk_6
  v_smfmac_f32_16x16x64_bf16 v[30:33], v[12:15], v[76:83], v16
L_k1sk_6:
  v_mfma_f32_16x16x32_bf16 v[144:147], v[80:83], v[36:39], v[144:147]
  ds_read_b64_tr_b16 v[76:77], v6 offset:8192
  v_mfma_f32_16x16x32_bf16 v[148:151], v[80:83], v[40:43], v[148:151]
  ds_read_b64_tr_b16 v[78:79], v6 offset:8704
  v_mfma_f32_16x16x32_bf16 v[152:155], v[80:83], v[44:47], v[152:155]
  v_mfma_f32_16x16x32_bf16 v[156:159], v[80:83], v[48:51], v[156:159]
  s_waitcnt lgkmcnt(4)
  v_mfma_f32_16x16x32_bf16 v[160:163], v[68:71], v[36:39], v[160:163]
  ds_read_b64_tr_b16 v[80:81], v6 offset:40960
  v_mfma_f32_16x16x32_bf16 v[164:167], v[68:71], v[40:43], v[164:167]
  ds_read_b64_tr_b16 v[82:83], v6 offset:41472
  v_mfma_f32_16x16x32_bf16 v[168:171], v[68:71], v[44:47], v[168:171]
  v_mfma_f32_16x16x32_bf16 v[172:175], v[68:71], v[48:51], v[172:175]
  s_waitcnt lgkmcnt(4)
  s_setprio 0
  v_mfma_f32_16x16x32_bf16 v[176:179], v[72:75], v[36:39], v[176:179]
  ds_read_b64_tr_b16 v[68:69], v7 offset:8192
  v_mfma_f32_16x16x32_bf16 v[180:183], v[72:75], v[40:43], v[180:183]
  ds_read_b64_tr_b16 v[70:71], v7 offset:8704
  v_mfma_f32_16x16x32_bf16 v[184:187], v[72:75], v[44:47], v[184:187]
  v_mfma_f32_16x16x32_bf16 v[188:191], v[72:75], v[48:51], v[188:191]
  s_waitcnt lgkmcnt(4)
  v_mfma_f32_16x16x32_bf16 v[192:195], v[76:79], v[36:39], v[192:195]
  ds_read_b64_tr_b16 v[72:73], v7 offset:40960
  v_mfma_f32_16x16x32_bf16 v[196:199], v[76:79], v[40:43], v[196:199]
  ds_read_b64_tr_b16 v[74:75], v7 offset:41472
  v_mfma_f32_16x16x32_bf16 v[200:203], v[76:79], v[44:47], v[200:203]
  v_mfma_f32_16x16x32_bf16 v[204:207], v[76:79], v[48:51], v[204:207]
  s_waitcnt lgkmcnt(0)
  s_barrier
  s_setprio 3
  v_mfma_f32_16x16x32_bf16 v[208:211], v[80:83], v[36:39], v[208:211]
  ds_read_b128 v[52:55], v3 offset:32768
  ds_read_b128 v[56:59], v3 offset:34816
  v_mfma_f32_16x16x32_bf16 v[212:215], v[80:83], v[40:43], v[212:215]
  ds_read_b128 v[60:63], v3 offset:36864
  ds_read_b128 v[64:67], v3 offset:38912
  v_mfma_f32_16x16x32_bf16 v[216:219], v[80:83], v[44:47], v[216:219]
  ds_read_b64_tr_b16 v[76:77], v4 offset:12288
  ds_read_b64_tr_b16 v[78:79], v4 offset:12800
  v_mfma_f32_16x16x32_bf16 v[220:223], v[80:83], v[48:51], v[220:223]
  v_mfma_f32_16x16x32_bf16 v[224:227], v[68:71], v[36:39], v[224:227]
  ds_read_b64_tr_b16 v[80:81], v4 offset:45056
  v_mfma_f32_16x16x32_bf16 v[228:231], v[68:71], v[40:43], v[228:231]
  ds_read_b64_tr_b16 v[82:83], v4 offset:45568
  v_mfma_f32_16x16x32_bf16 v[232:235], v[68:71], v[44:47], v[232:235]
  v_mfma_f32_16x16x32_bf16 v[236:239], v[68:71], v[48:51], v[236:239]
  v_mfma_f32_16x16x32_bf16 v[240:243], v[72:75], v[36:39], v[240:243]
  ds_read_b64_tr_b16 v[68:69], v8 offset:12288
  v_mfma_f32_16x16x32_bf16 v[244:247], v[72:75], v[40:43], v[244:247]
  ds_read_b64_tr_b16 v[70:71], v8 offset:12800
  v_mfma_f32_16x16x32_bf16 v[248:251], v[72:75], v[44:47], v[248:251]
  v_mfma_f32_16x16x32_bf16 v[252:255], v[72:75], v[48:51], v[252:255]
  s_waitcnt lgkmcnt(4)
  s_setprio 2
  v_mfma_f32_16x16x32_bf16 v[96:99], v[76:79], v[52:55], v[96:99]
  ds_read_b64_tr_b16 v[72:73], v9 offset:12288
  v_mfma_f32_16x16x32_bf16 v[100:103], v[76:79], v[56:59], v[100:103]
  ds_read_b64_tr_b16 v[74:75], v9 offset:12800
  v_mfma_f32_16x16x32_bf16 v[104:107], v[76:79], v[60:63], v[104:107]
  v_mfma_f32_16x16x32_bf16 v[108:111], v[76:79], v[64:67], v[108:111]
  s_waitcnt lgkmcnt(4)
  v_smfmac_f32_16x16x64_bf16 v[26:29], v[12:15], v[76:83], v16
  v_mfma_f32_16x16x32_bf16 v[112:115], v[80:83], v[52:55], v[112:115]
  ds_read_b64_tr_b16 v[76:77], v5 offset:12288
  v_mfma_f32_16x16x32_bf16 v[116:119], v[80:83], v[56:59], v[116:119]
  ds_read_b64_tr_b16 v[78:79], v5 offset:12800
  v_mfma_f32_16x16x32_bf16 v[120:123], v[80:83], v[60:63], v[120:123]
  v_mfma_f32_16x16x32_bf16 v[124:127], v[80:83], v[64:67], v[124:127]
  s_waitcnt lgkmcnt(4)
  v_mfma_f32_16x16x32_bf16 v[128:131], v[68:71], v[52:55], v[128:131]
  ds_read_b64_tr_b16 v[80:81], v5 offset:45056
  v_mfma_f32_16x16x32_bf16 v[132:135], v[68:71], v[56:59], v[132:135]
  ds_read_b64_tr_b16 v[82:83], v5 offset:45568
  v_mfma_f32_16x16x32_bf16 v[136:139], v[68:71], v[60:63], v[136:139]
  v_mfma_f32_16x16x32_bf16 v[140:143], v[68:71], v[64:67], v[140:143]
  s_waitcnt lgkmcnt(4)
  s_setprio 1
  s_cmp_lg_u32 s48, 3
  s_cbranch_scc1 L_k1sk_7
  v_smfmac_f32_16x16x64_bf16 v[30:33], v[12:15], v[68:75], v16
L_k1sk_7:
  v_mfma_f32_16x16x32_bf16 v[144:147], v[72:75], v[52:55], v[144:147]
  ds_read_b64_tr_b16 v[68:69], v6 offset:12288
  v_mfma_f32_16x16x32_bf16 v[148:151], v[72:75], v[56:59], v[148:151]
  ds_read_b64_tr_b16 v[70:71], v6 offset:12800
  v_mfma_f32_16x16x32_bf16 v[152:155], v[72:75], v[60:63], v[152:155]
  v_mfma_f32_16x16x32_bf16 v[156:159], v[72:75], v[64:67], v[156:159]
  s_waitcnt lgkmcnt(4)
  v_mfma_f32_16x16x32_bf16 v[160:163], v[76:79], v[52:55], v[160:163]
  ds_read_b64_tr_b16 v[72:73], v6 offset:45056
  v_mfma_f32_16x16x32_bf16 v[164:167], v[76:79], v[56:59], v[164:167]
  ds_read_b64_tr_b16 v[74:75], v6 offset:45568
  v_mfma_f32_16x16x32_bf16 v[168:171], v[76:79], v[60:63], v[168:171]
  v_mfma_f32_16x16x32_bf16 v[172:175], v[76:79], v[64:67], v[172:175]
  s_waitcnt lgkmcnt(4)
  s_setprio 0
  v_mfma_f32_16x16x32_bf16 v[176:179], v[80:83], v[52:55], v[176:179]
  ds_read_b64_tr_b16 v[76:77], v7 offset:12288
  v_mfma_f32_16x16x32_bf16 v[180:183], v[80:83], v[56:59], v[180:183]
  ds_read_b64_tr_b16 v[78:79], v7 offset:12800
  v_mfma_f32_16x16x32_bf16 v[184:187], v[80:83], v[60:63], v[184:187]
  v_mfma_f32_16x16x32_bf16 v[188:191], v[80:83], v[64:67], v[188:191]
  s_waitcnt lgkmcnt(4)
  v_mfma_f32_16x16x32_bf16 v[192:195], v[68:71], v[52:55], v[192:195]
  ds_read_b64_tr_b16 v[80:81], v7 offset:45056
  v_mfma_f32_16x16x32_bf16 v[196:199], v[68:71], v[56:59], v[196:199]
  ds_read_b64_tr_b16 v[82:83], v7 offset:45568
  v_mfma_f32_16x16x32_bf16 v[200:203], v[68:71], v[60:63], v[200:203]
  v_mfma_f32_16x16x32_bf16 v[204:207], v[68:71], v[64:67], v[204:207]
  s_waitcnt vmcnt(0) lgkmcnt(0)
  s_barrier
  s_setprio 3
  v_mfma_f32_16x16x32_bf16 v[208:211], v[72:75], v[52:55], v[208:211]
  ds_read_b128 v[36:39], v2 offset:0
  ds_read_b128 v[40:43], v2 offset:2048
  v_mfma_f32_16x16x32_bf16 v[212:215], v[72:75], v[56:59], v[212:215]
  ds_read_b128 v[44:47], v2 offset:4096
  ds_read_b128 v[48:51], v2 offset:6144
  v_mfma_f32_16x16x32_bf16 v[216:219], v[72:75], v[60:63], v[216:219]
  ds_read_b64_tr_b16 v[68:69], v4 offset:0
  ds_read_b64_tr_b16 v[70:71], v4 offset:512
  v_mfma_f32_16x16x32_bf16 v[220:223], v[72:75], v[64:67], v[220:223]
  v_mfma_f32_16x16x32_bf16 v[224:227], v[76:79], v[52:55], v[224:227]
  ds_read_b64_tr_b16 v[72:73], v4 offset:32768
  s_add_u32 m0, s46, 32768
  v_mfma_f32_16x16x32_bf16 v[228:231], v[76:79], v[56:59], v[228:231]
  ds_read_b64_tr_b16 v[74:75], v4 offset:33280
  buffer_load_dwordx4 v10, s[12:15], 0 offen lds
  v_mfma_f32_16x16x32_bf16 v[232:235], v[76:79], v[60:63], v[232:235]
  s_add_u32 m0, s46, 33792
  v_mfma_f32_16x16x32_bf16 v[236:239], v[76:79], v[64:67], v[236:239]
  buffer_load_dwordx4 v11, s[12:15], 0 offen lds
  v_mfma_f32_16x16x32_bf16 v[240:243], v[80:83], v[52:55], v[240:243]
  ds_read_b64_tr_b16 v[76:77], v8 offset:0
  s_add_u32 m0, s46, 34816
  v_mfma_f32_16x16x32_bf16 v[244:247], v[80:83], v[56:59], v[244:247]
  ds_read_b64_tr_b16 v[78:79], v8 offset:512
  buffer_load_dwordx4 v10, s[12:15], s56 offen lds
  v_mfma_f32_16x16x32_bf16 v[248:251], v[80:83], v[60:63], v[248:251]
  s_add_u32 m0, s46, 35840
  v_mfma_f32_16x16x32_bf16 v[252:255], v[80:83], v[64:67], v[252:255]
  buffer_load_dwordx4 v11, s[12:15], s56 offen lds
  s_sub_u32 s47, s47, 1
  s_cmp_lg_u32 s47, s66
  s_cbranch_scc1 L_k1loop_1
  s_cmp_eq_u32 s47, 0
  s_cbranch_scc1 L_k1tail_2
  s_cmp_eq_u32 s47, 1
  s_cbranch_scc1 L_k1poll_3
  s_mov_b32 s66, 1
  s_cmp_lg_u32 s40, 0
  s_cbranch_scc1 L_k1loop_1
  s_nop 7
  s_nop 7
  s_mov_b64 exec, 1
  buffer_atomic_add v17, off, s[68:71], s72 sc1
  s_mov_b64 exec, -1
  s_nop 7
  s_branch L_k1loop_1
L_k1poll_3:
  s_mov_b32 s66, 0
  buffer_load_dword v1, off, s[68:71], s72 sc1
  s_branch L_k1loop_1
L_k1tail_2:
  v_readfirstlane_b32 s61, v1
  s_lshl_b32 s3, s2, 3
  s_add_u32 s3, s3, s40
  s_lshl_b32 s3, s3, 9
  s_add_u32 s3, s3, 1048576
  s_cmp_eq_u32 s61, 32
  s_cselect_b32 s67, s67, s3
  buffer_load_dwordx2 v[18:19], v34, s[36:39], s67 offen offset:0 sc1
  buffer_load_dwordx2 v[20:21], v34, s[36:39], s67 offen offset:128 sc1
  buffer_load_dwordx2 v[22:23], v34, s[36:39], s67 offen offset:256 sc1
  buffer_load_dwordx2 v[24:25], v34, s[36:39], s67 offen offset:384 sc1
  s_waitcnt lgkmcnt(4)
  s_setprio 2
  v_mfma_f32_16x16x32_bf16 v[96:99], v[68:71], v[36:39], v[96:99]
  ds_read_b64_tr_b16 v[80:81], v9 offset:0
  s_add_u32 m0, s46, 36864
  v_mfma_f32_16x16x32_bf16 v[100:103], v[68:71], v[40:43], v[100:103]
  ds_read_b64_tr_b16 v[82:83], v9 offset:512
  buffer_load_dwordx4 v10, s[12:15], s57 offen lds
  v_mfma_f32_16x16x32_bf16 v[104:107], v[68:71], v[44:47], v[104:107]
  s_add_u32 m0, s46, 37888
  v_mfma_f32_16x16x32_bf16 v[108:111], v[68:71], v[48:51], v[108:111]
  buffer_load_dwordx4 v11, s[12:15], s57 offen lds
  s_waitcnt lgkmcnt(4)
  v_smfmac_f32_16x16x64_bf16 v[26:29], v[12:15], v[68:75], v16
  v_mfma_f32_16x16x32_bf16 v[112:115], v[72:75], v[36:39], v[112:115]
  ds_read_b64_tr_b16 v[68:69], v5 offset:0
  s_add_u32 m0, s46, 38912
  v_mfma_f32_16x16x32_bf16 v[116:119], v[72:75], v[40:43], v[116:119]
  ds_read_b64_tr_b16 v[70:71], v5 offset:512
  buffer_load_dwordx4 v10, s[12:15], s58 offen lds
  v_mfma_f32_16x16x32_bf16 v[120:123], v[72:75], v[44:47], v[120:123]
  s_add_u32 m0, s46, 39936
  v_mfma_f32_16x16x32_bf16 v[124:127], v[72:75], v[48:51], v[124:127]
  buffer_load_dwordx4 v11, s[12:15], s58 offen lds
  v_add_u32 v10, 128, v10
  v_add_u32 v11, 128, v11
  s_waitcnt lgkmcnt(4)
  v_mfma_f32_16x16x32_bf16 v[128:131], v[76:79], v[36:39], v[128:131]
  ds_read_b64_tr_b16 v[72:73], v5 offset:32768
  v_mfma_f32_16x16x32_bf16 v[132:135], v[76:79], v[40:43], v[132:135]
  ds_read_b64_tr_b16 v[74:75], v5 offset:33280
  v_mfma_f32_16x16x32_bf16 v[136:139], v[76:79], v[44:47], v[136:139]
  v_mfma_f32_16x16x32_bf16 v[140:143], v[76:79], v[48:51], v[140:143]
  s_waitcnt lgkmcnt(4)
  s_setprio 1
  s_cmp_lg_u32 s48, 0
  s_cbranch_scc1 L_k1sk_8
  v_smfmac_f32_16x16x64_bf16 v[30:33], v[12:15], v[76:83], v16
L_k1sk_8:
  v_mfma_f32_16x16x32_bf16 v[144:147], v[80:83], v[36:39], v[144:147]
  ds_read_b64_tr_b16 v[76:77], v6 offset:0
  v_mfma_f32_16x16x32_bf16 v[148:151], v[80:83], v[40:43], v[148:151]
  ds_read_b64_tr_b16 v[78:79], v6 offset:512
  v_mfma_f32_16x16x32_bf16 v[152:155], v[80:83], v[44:47], v[152:155]
  v_mfma_f32_16x16x32_bf16 v[156:159], v[80:83], v[48:51], v[156:159]
  s_waitcnt lgkmcnt(4)
  v_mfma_f32_16x16x32_bf16 v[160:163], v[68:71], v[36:39], v[160:163]
  ds_read_b64_tr_b16 v[80:81], v6 offset:32768
  v_mfma_f32_16x16x32_bf16 v[164:167], v[68:71], v[40:43], v[164:167]
  ds_read_b64_tr_b16 v[82:83], v6 offset:33280
  v_mfma_f32_16x16x32_bf16 v[168:171], v[68:71], v[44:47], v[168:171]
  v_mfma_f32_16x16x32_bf16 v[172:175], v[68:71], v[48:51], v[172:175]
  s_waitcnt lgkmcnt(4)
  s_setprio 0
  v_mfma_f32_16x16x32_bf16 v[176:179], v[72:75], v[36:39], v[176:179]
  ds_read_b64_tr_b16 v[68:69], v7 offset:0
  v_mfma_f32_16x16x32_bf16 v[180:183], v[72:75], v[40:43], v[180:183]
  ds_read_b64_tr_b16 v[70:71], v7 offset:512
  v_mfma_f32_16x16x32_bf16 v[184:187], v[72:75], v[44:47], v[184:187]
  v_mfma_f32_16x16x32_bf16 v[188:191], v[72:75], v[48:51], v[188:191]
  s_waitcnt lgkmcnt(4)
  v_mfma_f32_16x16x32_bf16 v[192:195], v[76:79], v[36:39], v[192:195]
  ds_read_b64_tr_b16 v[72:73], v7 offset:32768
  v_mfma_f32_16x16x32_bf16 v[196:199], v[76:79], v[40:43], v[196:199]
  ds_read_b64_tr_b16 v[74:75], v7 offset:33280
  v_mfma_f32_16x16x32_bf16 v[200:203], v[76:79], v[44:47], v[200:203]
  v_mfma_f32_16x16x32_bf16 v[204:207], v[76:79], v[48:51], v[204:207]
  s_waitcnt lgkmcnt(0)
  s_barrier
  s_setprio 3
  v_mfma_f32_16x16x32_bf16 v[208:211], v[80:83], v[36:39], v[208:211]
  ds_read_b128 v[52:55], v3 offset:0
  ds_read_b128 v[56:59], v3 offset:2048
  v_mfma_f32_16x16x32_bf16 v[212:215], v[80:83], v[40:43], v[212:215]
  ds_read_b128 v[60:63], v3 offset:4096
  ds_read_b128 v[64:67], v3 offset:6144
  v_mfma_f32_16x16x32_bf16 v[216:219], v[80:83], v[44:47], v[216:219]
  ds_read_b64_tr_b16 v[76:77], v4 offset:4096
  ds_read_b64_tr_b16 v[78:79], v4 offset:4608
  v_mfma_f32_16x16x32_bf16 v[220:223], v[80:83], v[48:51], v[220:223]
  v_mfma_f32_16x16x32_bf16 v[224:227], v[68:71], v[36:39], v[224:227]
  ds_read_b64_tr_b16 v[80:81], v4 offset:36864
  v_mfma_f32_16x16x32_bf16 v[228:231], v[68:71], v[40:43], v[228:231]
  ds_read_b64_tr_b16 v[82:83], v4 offset:37376
  v_mfma_f32_16x16x32_bf16 v[232:235], v[68:71], v[44:47], v[232:235]
  v_mfma_f32_16x16x32_bf16 v[236:239], v[68:71], v[48:51], v[236:239]
  v_mfma_f32_16x16x32_bf16 v[240:243], v[72:75], v[36:39], v[240:243]
  ds_read_b64_tr_b16 v[68:69], v8 offset:4096
  v_mfma_f32_16x16x32_bf16 v[244:247], v[72:75], v[40:43], v[244:247]
  ds_read_b64_tr_b16 v[70:71], v8 offset:4608
  v_mfma_f32_16x16x32_bf16 v[248:251], v[72:75], v[44:47], v[248:251]
  v_mfma_f32_16x16x32_bf16 v[252:255], v[72:75], v[48:51], v[252:255]
  s_waitcnt lgkmcnt(4)
  s_setprio 2
  v_mfma_f32_16x16x32_bf16 v[96:99], v[76:79], v[52:55], v[96:99]
  ds_read_b64_tr_b16 v[72:73], v9 offset:4096
  v_mfma_f32_16x16x32_bf16 v[100:103], v[76:79], v[56:59], v[100:103]
  ds_read_b64_tr_b16 v[74:75], v9 offset:4608
  v_mfma_f32_16x16x32_bf16 v[104:107], v[76:79], v[60:63], v[104:107]
  v_mfma_f32_16x16x32_bf16 v[108:111], v[76:79], v[64:67], v[108:111]
  s_waitcnt lgkmcnt(4)
  v_smfmac_f32_16x16x64_bf16 v[26:29], v[12:15], v[76:83], v16
  v_mfma_f32_16x16x32_bf16 v[112:115], v[80:83], v[52:55], v[112:115]
  ds_read_b64_tr_b16 v[76:77], v5 offset:4096
  v_mfma_f32_16x16x32_bf16 v[116:119], v[80:83], v[56:59], v[116:119]
  ds_read_b64_tr_b16 v[78:79], v5 offset:4608
  v_mfma_f32_16x16x32_bf16 v[120:123], v[80:83], v[60:63], v[120:123]
  v_mfma_f32_16x16x32_bf16 v[124:127], v[80:83], v[64:67], v[124:127]
  s_waitcnt lgkmcnt(4)
  v_mfma_f32_16x16x32_bf16 v[128:131], v[68:71], v[52:55], v[128:131]
  ds_read_b64_tr_b16 v[80:81], v5 offset:36864
  v_mfma_f32_16x16x32_bf16 v[132:135], v[68:71], v[56:59], v[132:135]
  ds_read_b64_tr_b16 v[82:83], v5 offset:37376
  v_mfma_f32_16x16x32_bf16 v[136:139], v[68:71], v[60:63], v[136:139]
  v_mfma_f32_16x16x32_bf16 v[140:143], v[68:71], v[64:67], v[140:143]
  s_waitcnt lgkmcnt(4)
  s_setprio 1
  s_cmp_lg_u32 s48, 1
  s_cbranch_scc1 L_k1sk_9
  v_smfmac_f32_16x16x64_bf16 v[30:33], v[12:15], v[68:75], v16
L_k1sk_9:
  v_mfma_f32_16x16x32_bf16 v[144:147], v[72:75], v[52:55], v[144:147]
  ds_read_b64_tr_b16 v[68:69], v6 offset:4096
  v_mfma_f32_16x16x32_bf16 v[148:151], v[72:75], v[56:59], v[148:151]
  ds_read_b64_tr_b16 v[70:71], v6 offset:4608
  v_mfma_f32_16x16x32_bf16 v[152:155], v[72:75], v[60:63], v[152:155]
  v_mfma_f32_16x16x32_bf16 v[156:159], v[72:75], v[64:67], v[156:159]
  s_waitcnt lgkmcnt(4)
  v_mfma_f32_16x16x32_bf16 v[160:163], v[76:79], v[52:55], v[160:163]
  ds_read_b64_tr_b16 v[72:73], v6 offset:36864
  v_mfma_f32_16x16x32_bf16 v[164:167], v[76:79], v[56:59], v[164:167]
  ds_read_b64_tr_b16 v[74:75], v6 offset:37376
  v_mfma_f32_16x16x32_bf16 v[168:171], v[76:79], v[60:63], v[168:171]
  v_mfma_f32_16x16x32_bf16 v[172:175], v[76:79], v[64:67], v[172:175]
  s_waitcnt lgkmcnt(4)
  s_setprio 0
  v_mfma_f32_16x16x32_bf16 v[176:179], v[80:83], v[52:55], v[176:179]
  ds_read_b64_tr_b16 v[76:77], v7 offset:4096
  v_mfma_f32_16x16x32_bf16 v[180:183], v[80:83], v[56:59], v[180:183]
  ds_read_b64_tr_b16 v[78:79], v7 offset:4608
  v_mfma_f32_16x16x32_bf16 v[184:187], v[80:83], v[60:63], v[184:187]
  v_mfma_f32_16x16x32_bf16 v[188:191], v[80:83], v[64:67], v[188:191]
  s_waitcnt lgkmcnt(4)
  v_mfma_f32_16x16x32_bf16 v[192:195], v[68:71], v[52:55], v[192:195]
  ds_read_b64_tr_b16 v[80:81], v7 offset:36864
  v_mfma_f32_16x16x32_bf16 v[196:199], v[68:71], v[56:59], v[196:199]
  ds_read_b64_tr_b16 v[82:83], v7 offset:37376
  v_mfma_f32_16x16x32_bf16 v[200:203], v[68:71], v[60:63], v[200:203]
  v_mfma_f32_16x16x32_bf16 v[204:207], v[68:71], v[64:67], v[204:207]
  s_waitcnt vmcnt(0) lgkmcnt(0)
  s_barrier
  s_setprio 0
  v_mfma_f32_16x16x32_bf16 v[208:211], v[72:75], v[52:55], v[208:211]
  ds_read_b128 v[36:39], v2 offset:32768
  ds_read_b128 v[40:43], v2 offset:34816
  v_mfma_f32_16x16x32_bf16 v[212:215], v[72:75], v[56:59], v[212:215]
  ds_read_b128 v[44:47], v2 offset:36864
  ds_read_b128 v[48:51], v2 offset:38912
  v_mfma_f32_16x16x32_bf16 v[216:219], v[72:75], v[60:63], v[216:219]
  ds_read_b64_tr_b16 v[68:69], v4 offset:8192
  ds_read_b64_tr_b16 v[70:71], v4 offset:8704
  v_mfma_f32_16x16x32_bf16 v[220:223], v[72:75], v[64:67], v[220:223]
  v_mfma_f32_16x16x32_bf16 v[224:227], v[76:79], v[52:55], v[224:227]
  ds_read_b64_tr_b16 v[72:73], v4 offset:40960
  v_mfma_f32_16x16x32_bf16 v[228:231], v[76:79], v[56:59], v[228:231]
  ds_read_b64_tr_b16 v[74:75], v4 offset:41472
  v_mfma_f32_16x16x32_bf16 v[232:235], v[76:79], v[60:63], v[232:235]
  v_mfma_f32_16x16x32_bf16 v[236:239], v[76:79], v[64:67], v[236:239]
  v_mfma_f32_16x16x32_bf16 v[240:243], v[80:83], v[52:55], v[240:243]
  ds_read_b64_tr_b16 v[76:77], v8 offset:8192
  v_mfma_f32_16x16x32_bf16 v[244:247], v[80:83], v[56:59], v[244:247]
  ds_read_b64_tr_b16 v[78:79], v8 offset:8704
  v_mfma_f32_16x16x32_bf16 v[248:251], v[80:83], v[60:63], v[248:251]
  v_mfma_f32_16x16x32_bf16 v[252:255], v[80:83], v[64:67], v[252:255]
  s_waitcnt lgkmcnt(4)
  v_mfma_f32_16x16x32_bf16 v[96:99], v[68:71], v[36:39], v[96:99]
  ds_read_b64_tr_b16 v[80:81], v9 offset:8192
  v_mfma_f32_16x16x32_bf16 v[100:103], v[68:71], v[40:43], v[100:103]
  ds_read_b64_tr_b16 v[82:83], v9 offset:8704
  v_mfma_f32_16x16x32_bf16 v[104:107], v[68:71], v[44:47], v[104:107]
  v_mfma_f32_16x16x32_bf16 v[108:111], v[68:71], v[48:51], v[108:111]
  s_waitcnt lgkmcnt(4)
  v_smfmac_f32_16x16x64_bf16 v[26:29], v[12:15], v[68:75], v16
  v_mfma_f32_16x16x32_bf16 v[112:115], v[72:75], v[36:39], v[112:115]
  ds_read_b64_tr_b16 v[68:69], v5 offset:8192
  v_mfma_f32_16x16x32_bf16 v[116:119], v[72:75], v[40:43], v[116:119]
  ds_read_b64_tr_b16 v[70:71], v5 offset:8704
  v_mfma_f32_16x16x32_bf16 v[120:123], v[72:75], v[44:47], v[120:123]
  v_mfma_f32_16x16x32_bf16 v[124:127], v[72:75], v[48:51], v[124:127]
  s_waitcnt lgkmcnt(4)
  v_mfma_f32_16x16x32_bf16 v[128:131], v[76:79], v[36:39], v[128:131]
  ds_read_b64_tr_b16 v[72:73], v5 offset:40960
  v_mfma_f32_16x16x32_bf16 v[132:135], v[76:79], v[40:43], v[132:135]
  ds_read_b64_tr_b16 v[74:75], v5 offset:41472
  v_mfma_f32_16x16x32_bf16 v[136:139], v[76:79], v[44:47], v[136:139]
  v_mfma_f32_16x16x32_bf16 v[140:143], v[76:79], v[48:51], v[140:143]
  s_waitcnt lgkmcnt(4)
  s_cmp_lg_u32 s48, 2
  s_cbranch_scc1 L_k1sk_10
  v_smfmac_f32_16x16x64_bf16 v[30:33], v[12:15], v[76:83], v16
L_k1sk_10:
  v_mfma_f32_16x16x32_bf16 v[144:147], v[80:83], v[36:39], v[144:147]
  ds_read_b64_tr_b16 v[76:77], v6 offset:8192
  v_mfma_f32_16x16x32_bf16 v[148:151], v[80:83], v[40:43], v[148:151]
  ds_read_b64_tr_b16 v[78:79], v6 offset:8704
  v_mfma_f32_16x16x32_bf16 v[152:155], v[80:83], v[44:47], v[152:155]
  v_mfma_f32_16x16x32_bf16 v[156:159], v[80:83], v[48:51], v[156:159]
  s_waitcnt lgkmcnt(4)
  v_mfma_f32_16x16x32_bf16 v[160:163], v[68:71], v[36:39], v[160:163]
  ds_read_b64_tr_b16 v[80:81], v6 offset:40960
  v_mfma_f32_16x16x32_bf16 v[164:167], v[68:71], v[40:43], v[164:167]
  ds_read_b64_tr_b16 v[82:83], v6 offset:41472
  v_mfma_f32_16x16x32_bf16 v[168:171], v[68:71], v[44:47], v[168:171]
  v_mfma_f32_16x16x32_bf16 v[172:175], v[68:71], v[48:51], v[172:175]
  s_waitcnt lgkmcnt(4)
  v_mfma_f32_16x16x32_bf16 v[176:179], v[72:75], v[36:39], v[176:179]
  ds_read_b64_tr_b16 v[68:69], v7 offset:8192
  v_mfma_f32_16x16x32_bf16 v[180:183], v[72:75], v[40:43], v[180:183]
  ds_read_b64_tr_b16 v[70:71], v7 offset:8704
  v_mfma_f32_16x16x32_bf16 v[184:187], v[72:75], v[44:47], v[184:187]
  v_mfma_f32_16x16x32_bf16 v[188:191], v[72:75], v[48:51], v[188:191]
  s_waitcnt lgkmcnt(4)
  v_mfma_f32_16x16x32_bf16 v[192:195], v[76:79], v[36:39], v[192:195]
  ds_read_b64_tr_b16 v[72:73], v7 offset:40960
  v_mfma_f32_16x16x32_bf16 v[196:199], v[76:79], v[40:43], v[196:199]
  ds_read_b64_tr_b16 v[74:75], v7 offset:41472
  v_mfma_f32_16x16x32_bf16 v[200:203], v[76:79], v[44:47], v[200:203]
  v_mfma_f32_16x16x32_bf16 v[204:207], v[76:79], v[48:51], v[204:207]
  s_waitcnt lgkmcnt(4)
  v_mfma_f32_16x16x32_bf16 v[208:211], v[80:83], v[36:39], v[208:211]
  ds_read_b128 v[52:55], v3 offset:32768
  ds_read_b128 v[56:59], v3 offset:34816
  v_mfma_f32_16x16x32_bf16 v[212:215], v[80:83], v[40:43], v[212:215]
  ds_read_b128 v[60:63], v3 offset:36864
  ds_read_b128 v[64:67], v3 offset:38912
  v_mfma_f32_16x16x32_bf16 v[216:219], v[80:83], v[44:47], v[216:219]
  ds_read_b64_tr_b16 v[76:77], v4 offset:12288
  ds_read_b64_tr_b16 v[78:79], v4 offset:12800
  v_mfma_f32_16x16x32_bf16 v[220:223], v[80:83], v[48:51], v[220:223]
  s_waitcnt lgkmcnt(8)
  v_mfma_f32_16x16x32_bf16 v[224:227], v[68:71], v[36:39], v[224:227]
  ds_read_b64_tr_b16 v[80:81], v4 offset:45056
  v_mfma_f32_16x16x32_bf16 v[228:231], v[68:71], v[40:43], v[228:231]
  ds_read_b64_tr_b16 v[82:83], v4 offset:45568
  v_mfma_f32_16x16x32_bf16 v[232:235], v[68:71], v[44:47], v[232:235]
  v_mfma_f32_16x16x32_bf16 v[236:239], v[68:71], v[48:51], v[236:239]
  s_waitcnt lgkmcnt(8)
  v_mfma_f32_16x16x32_bf16 v[240:243], v[72:75], v[36:39], v[240:243]
  ds_read_b64_tr_b16 v[68:69], v8 offset:12288
  v_mfma_f32_16x16x32_bf16 v[244:247], v[72:75], v[40:43], v[244:247]
  ds_read_b64_tr_b16 v[70:71], v8 offset:12800
  v_mfma_f32_16x16x32_bf16 v[248:251], v[72:75], v[44:47], v[248:251]
  v_mfma_f32_16x16x32_bf16 v[252:255], v[72:75], v[48:51], v[252:255]
  s_waitcnt lgkmcnt(4)
  v_mfma_f32_16x16x32_bf16 v[96:99], v[76:79], v[52:55], v[96:99]
  ds_read_b64_tr_b16 v[72:73], v9 offset:12288
  v_mfma_f32_16x16x32_bf16 v[100:103], v[76:79], v[56:59], v[100:103]
  ds_read_b64_tr_b16 v[74:75], v9 offset:12800
  v_mfma_f32_16x16x32_bf16 v[104:107], v[76:79], v[60:63], v[104:107]
  v_mfma_f32_16x16x32_bf16 v[108:111], v[76:79], v[64:67], v[108:111]
  s_waitcnt lgkmcnt(4)
  v_smfmac_f32_16x16x64_bf16 v[26:29], v[12:15], v[76:83], v16
  v_mfma_f32_16x16x32_bf16 v[112:115], v[80:83], v[52:55], v[112:115]
  ds_read_b64_tr_b16 v[76:77], v5 offset:12288
  v_mfma_f32_16x16x32_bf16 v[116:119], v[80:83], v[56:59], v[116:119]
  ds_read_b64_tr_b16 v[78:79], v5 offset:12800
  v_mfma_f32_16x16x32_bf16 v[120:123], v[80:83], v[60:63], v[120:123]
  v_mfma_f32_16x16x32_bf16 v[124:127], v[80:83], v[64:67], v[124:127]
  s_waitcnt lgkmcnt(4)
  v_mfma_f32_16x16x32_bf16 v[128:131], v[68:71], v[52:55], v[128:131]
  ds_read_b64_tr_b16 v[80:81], v5 offset:45056
  v_mfma_f32_16x16x32_bf16 v[132:135], v[68:71], v[56:59], v[132:135]
  ds_read_b64_tr_b16 v[82:83], v5 offset:45568
  v_mfma_f32_16x16x32_bf16 v[136:139], v[68:71], v[60:63], v[136:139]
  v_mfma_f32_16x16x32_bf16 v[140:143], v[68:71], v[64:67], v[140:143]
  s_waitcnt lgkmcnt(4)
  s_cmp_lg_u32 s48, 3
  s_cbranch_scc1 L_k1sk_11
  v_smfmac_f32_16x16x64_bf16 v[30:33], v[12:15], v[68:75], v16
L_k1sk_11:
  v_mfma_f32_16x16x32_bf16 v[144:147], v[72:75], v[52:55], v[144:147]
  ds_read_b64_tr_b16 v[68:69], v6 offset:12288
  v_mfma_f32_16x16x32_bf16 v[148:151], v[72:75], v[56:59], v[148:151]
  ds_read_b64_tr_b16 v[70:71], v6 offset:12800
  v_mfma_f32_16x16x32_bf16 v[152:155], v[72:75], v[60:63], v[152:155]
  v_mfma_f32_16x16x32_bf16 v[156:159], v[72:75], v[64:67], v[156:159]
  s_waitcnt lgkmcnt(4)
  v_mfma_f32_16x16x32_bf16 v[160:163], v[76:79], v[52:55], v[160:163]
  ds_read_b64_tr_b16 v[72:73], v6 offset:45056
  v_and_b32 v10, 15, v0
  s_lshl_b32 s3, s49, 10
  s_lshl_b32 s50, s48, 6
  v_mfma_f32_16x16x32_bf16 v[164:167], v[76:79], v[56:59], v[164:167]
  ds_read_b64_tr_b16 v[74:75], v6 offset:45568
  v_lshlrev_b32 v10, 2, v10
  s_add_u32 s3, s3, s50
  s_add_u32 s3, s3, 147456
  v_mfma_f32_16x16x32_bf16 v[168:171], v[76:79], v[60:63], v[168:171]
  v_add_u32 v10, s3, v10
  s_add_u32 s50, s50, 512
  v_mfma_f32_16x16x32_bf16 v[172:175], v[76:79], v[64:67], v[172:175]
  v_add_u32 v11, s50, v10
  s_lshl_b32 s3, s40, 2
  s_add_u32 s3, s3, 149504
  v_mov_b32 v35, s3
  s_waitcnt lgkmcnt(4)
  v_mfma_f32_16x16x32_bf16 v[176:179], v[80:83], v[52:55], v[176:179]
  ds_read_b64_tr_b16 v[76:77], v7 offset:12288
  v_add_f32 v26, v26, v27
  v_add_f32 v28, v28, v29
  v_add_f32 v30, v30, v31
  v_add_f32 v32, v32, v33
  v_mfma_f32_16x16x32_bf16 v[180:183], v[80:83], v[56:59], v[180:183]
  ds_read_b64_tr_b16 v[78:79], v7 offset:12800
  v_mfma_f32_16x16x32_bf16 v[184:187], v[80:83], v[60:63], v[184:187]
  ds_write_b32 v10, v26
  ds_write_b32 v10, v28 offset:256
  v_mfma_f32_16x16x32_bf16 v[188:191], v[80:83], v[64:67], v[188:191]
  ds_write_b32 v11, v30
  ds_write_b32 v11, v32 offset:64
  s_waitcnt lgkmcnt(8)
  v_mfma_f32_16x16x32_bf16 v[192:195], v[68:71], v[52:55], v[192:195]
  ds_read_b64_tr_b16 v[80:81], v7 offset:45056
  v_mfma_f32_16x16x32_bf16 v[196:199], v[68:71], v[56:59], v[196:199]
  ds_read_b64_tr_b16 v[82:83], v7 offset:45568
  v_mfma_f32_16x16x32_bf16 v[200:203], v[68:71], v[60:63], v[200:203]
  v_mfma_f32_16x16x32_bf16 v[204:207], v[68:71], v[64:67], v[204:207]
  s_waitcnt lgkmcnt(8)
  v_mfma_f32_16x16x32_bf16 v[208:211], v[72:75], v[52:55], v[208:211]
  v_mfma_f32_16x16x32_bf16 v[212:215], v[72:75], v[56:59], v[212:215]
  ds_write_b32 v35, v17
  v_mfma_f32_16x16x32_bf16 v[216:219], v[72:75], v[60:63], v[216:219]
  v_mfma_f32_16x16x32_bf16 v[220:223], v[72:75], v[64:67], v[220:223]
  s_waitcnt lgkmcnt(7)
  v_mfma_f32_16x16x32_bf16 v[224:227], v[76:79], v[52:55], v[224:227]
  v_mfma_f32_16x16x32_bf16 v[228:231], v[76:79], v[56:59], v[228:231]
  v_mfma_f32_16x16x32_bf16 v[232:235], v[76:79], v[60:63], v[232:235]
  v_mfma_f32_16x16x32_bf16 v[236:239], v[76:79], v[64:67], v[236:239]
  s_waitcnt lgkmcnt(1)
  v_mfma_f32_16x16x32_bf16 v[240:243], v[80:83], v[52:55], v[240:243]
  v_mfma_f32_16x16x32_bf16 v[244:247], v[80:83], v[56:59], v[244:247]
  v_mfma_f32_16x16x32_bf16 v[248:251], v[80:83], v[60:63], v[248:251]
  v_mfma_f32_16x16x32_bf16 v[252:255], v[80:83], v[64:67], v[252:255]
  s_branch L_k1_epi
L_k1_r0s:
  buffer_load_dwordx4 v[36:39], v90, s[12:15], 0 offen offset:0
  buffer_load_dwordx4 v[40:43], v90, s[12:15], 0 offen offset:512
  buffer_load_dwordx4 v[44:47], v90, s[12:15], 0 offen offset:1024
  buffer_load_dwordx4 v[48:51], v90, s[12:15], 0 offen offset:1536
  s_add_u32 m0, s46, 0
  s_nop 0
  buffer_load_dwordx4 v10, s[12:15], 0 offen lds
  s_add_u32 m0, s46, 1024
  s_nop 0
  buffer_load_dwordx4 v11, s[12:15], 0 offen lds
  s_add_u32 m0, s46, 2048
  s_nop 0
  buffer_load_dwordx4 v10, s[12:15], s56 offen lds
  s_add_u32 m0, s46, 3072
  s_nop 0
  buffer_load_dwordx4 v11, s[12:15], s56 offen lds
  s_add_u32 m0, s46, 4096
  s_nop 0
  buffer_load_dwordx4 v10, s[12:15], s57 offen lds
  s_add_u32 m0, s46, 5120
  s_nop 0
  buffer_load_dwordx4 v11, s[12:15], s57 offen lds
  s_add_u32 m0, s46, 6144
  s_nop 0
  buffer_load_dwordx4 v10, s[12:15], s58 offen lds
  s_add_u32 m0, s46, 7168
  s_nop 0
  buffer_load_dwordx4 v11, s[12:15], s58 offen lds
  v_add_u32 v10, 128, v10
  v_add_u32 v11, 128, v11
  v_lshrrev_b32 v13, 4, v1
  v_and_b32 v34, 15, v1
  v_lshrrev_b32 v2, 1, v34
  v_xor_b32 v2, v2, v13
  v_lshlrev_b32 v2, 4, v2
  v_lshl_add_u32 v2, v34, 7, v2
  s_lshl_b32 s3, s48, 13
  s_add_u32 s3, s3, 81920
  v_add_u32 v2, s3, v2
  v_xor_b32 v3, 64, v2
  v_lshrrev_b32 v14, 2, v34
  v_lshl_add_u32 v15, v13, 3, v14
  v_lshlrev_b32 v15, 7, v15
  v_lshrrev_b32 v14, 1, v14
  v_lshl_add_u32 v15, v14, 5, v15
  v_and_b32 v14, 1, v13
  v_lshl_add_u32 v15, v14, 6, v15
  v_and_b32 v14, 3, v1
  v_lshl_add_u32 v15, v14, 3, v15
  s_lshl_b32 s3, s49, 6
  v_xor_b32 v8, s3, v15
  v_xor_b32 v9, 32, v8
  s_lshl_b32 s3, s48, 5
  v_xor_b32 v4, s3, v15
  s_add_u32 s3, s49, 1
  s_lshl_b32 s3, s3, 14
  v_add_u32 v4, s3, v4
  v_xor_b32 v5, 32, v4
  v_xor_b32 v6, 64, v4
  v_xor_b32 v7, 96, v4
  v_bfe_u32 v14, v1, 1, 1
  v_lshrrev_b32 v15, 5, v1
  v_cmp_eq_u32 vcc, v14, v15
  v_mov_b32 v14, 0x3f803f80
  s_nop 0
  v_cndmask_b32 v12, 0, v14, vcc
  v_and_b32 v14, 1, v1
  v_cmp_eq_u32 vcc, 0, v14
  v_mov_b32 v14, 0x44444444
  v_mov_b32 v15, 0xeeeeeeee
  v_cndmask_b32 v16, v15, v14, vcc
  v_mov_b32 v13, v12
  v_mov_b32 v14, v12
  v_mov_b32 v15, v12
  v_mov_b32 v17, 1
  v_lshlrev_b32 v34, 3, v34
  s_lshl_b32 s67, s41, 2
  s_add_u32 s67, s67, s48
  s_lshl_b32 s67, s67, 9
  v_mov_b32 v96, 0
  v_mov_b32 v97, 0
  v_mov_b32 v98, 0
  v_mov_b32 v99, 0
  v_mov_b32 v100, 0
  v_mov_b32 v101, 0
  v_mov_b32 v102, 0
  v_mov_b32 v103, 0
  v_mov_b32 v104, 0
  v_mov_b32 v105, 0
  v_mov_b32 v106, 0
  v_mov_b32 v107, 0
  v_mov_b32 v108, 0
  v_mov_b32 v109, 0
  v_mov_b32 v110, 0
  v_mov_b32 v111, 0
  v_mov_b32 v112, 0
  v_mov_b32 v113, 0
  v_mov_b32 v114, 0
  v_mov_b32 v115, 0
  v_mov_b32 v116, 0
  v_mov_b32 v117, 0
  v_mov_b32 v118, 0
  v_mov_b32 v119, 0
  v_mov_b32 v120, 0
  v_mov_b32 v121, 0
  v_mov_b32 v122, 0
  v_mov_b32 v123, 0
  v_mov_b32 v124, 0
  v_mov_b32 v125, 0
  v_mov_b32 v126, 0
  v_mov_b32 v127, 0
  v_mov_b32 v128, 0
  v_mov_b32 v129, 0
  v_mov_b32 v130, 0
  v_mov_b32 v131, 0
  v_mov_b32 v132, 0
  v_mov_b32 v133, 0
  v_mov_b32 v134, 0
  v_mov_b32 v135, 0
  v_mov_b32 v136, 0
  v_mov_b32 v137, 0
  v_mov_b32 v138, 0
  v_mov_b32 v139, 0
  v_mov_b32 v140, 0
  v_mov_b32 v141, 0
  v_mov_b32 v142, 0
  v_mov_b32 v143, 0
  v_mov_b32 v144, 0
  v_mov_b32 v145, 0
  v_mov_b32 v146, 0
  v_mov_b32 v147, 0
  v_mov_b32 v148, 0
  v_mov_b32 v149, 0
  v_mov_b32 v150, 0
  v_mov_b32 v151, 0
  v_mov_b32 v152, 0
  v_mov_b32 v153, 0
  v_mov_b32 v154, 0
  v_mov_b32 v155, 0
  v_mov_b32 v156, 0
  v_mov_b32 v157, 0
  v_mov_b32 v158, 0
  v_mov_b32 v159, 0
  v_mov_b32 v160, 0
  v_mov_b32 v161, 0
  v_mov_b32 v162, 0
  v_mov_b32 v163, 0
  v_mov_b32 v164, 0
  v_mov_b32 v165, 0
  v_mov_b32 v166, 0
  v_mov_b32 v167, 0
  v_mov_b32 v168, 0
  v_mov_b32 v169, 0
  v_mov_b32 v170, 0
  v_mov_b32 v171, 0
  v_mov_b32 v172, 0
  v_mov_b32 v173, 0
  v_mov_b32 v174, 0
  v_mov_b32 v175, 0
  v_mov_b32 v176, 0
  v_mov_b32 v177, 0
  v_mov_b32 v178, 0
  v_mov_b32 v179, 0
  v_mov_b32 v180, 0
  v_mov_b32 v181, 0
  v_mov_b32 v182, 0
  v_mov_b32 v183, 0
  v_mov_b32 v184, 0
  v_mov_b32 v185, 0
  v_mov_b32 v186, 0
  v_mov_b32 v187, 0
  v_mov_b32 v188, 0
  v_mov_b32 v189, 0
  v_mov_b32 v190, 0
  v_mov_b32 v191, 0
  v_mov_b32 v192, 0
  v_mov_b32 v193, 0
  v_mov_b32 v194, 0
  v_mov_b32 v195, 0
  v_mov_b32 v196, 0
  v_mov_b32 v197, 0
  v_mov_b32 v198, 0
  v_mov_b32 v199, 0
  v_mov_b32 v200, 0
  v_mov_b32 v201, 0
  v_mov_b32 v202, 0
  v_mov_b32 v203, 0
  v_mov_b32 v204, 0
  v_mov_b32 v205, 0
  v_mov_b32 v206, 0
  v_mov_b32 v207, 0
  v_mov_b32 v208, 0
  v_mov_b32 v209, 0
  v_mov_b32 v210, 0
  v_mov_b32 v211, 0
  v_mov_b32 v212, 0
  v_mov_b32 v213, 0
  v_mov_b32 v214, 0
  v_mov_b32 v215, 0
  v_mov_b32 v216, 0
  v_mov_b32 v217, 0
  v_mov_b32 v218, 0
  v_mov_b32 v219, 0
  v_mov_b32 v220, 0
  v_mov_b32 v221, 0
  v_mov_b32 v222, 0
  v_mov_b32 v223, 0
  v_mov_b32 v224, 0
  v_mov_b32 v225, 0
  v_mov_b32 v226, 0
  v_mov_b32 v227, 0
  v_mov_b32 v228, 0
  v_mov_b32 v229, 0
  v_mov_b32 v230, 0
  v_mov_b32 v231, 0
  v_mov_b32 v232, 0
  v_mov_b32 v233, 0
  v_mov_b32 v234, 0
  v_mov_b32 v235, 0
  v_mov_b32 v236, 0
  v_mov_b32 v237, 0
  v_mov_b32 v238, 0
  v_mov_b32 v239, 0
  v_mov_b32 v240, 0
  v_mov_b32 v241, 0
  v_mov_b32 v242, 0
  v_mov_b32 v243, 0
  v_mov_b32 v244, 0
  v_mov_b32 v245, 0
  v_mov_b32 v246, 0
  v_mov_b32 v247, 0
  v_mov_b32 v248, 0
  v_mov_b32 v249, 0
  v_mov_b32 v250, 0
  v_mov_b32 v251, 0
  v_mov_b32 v252, 0
  v_mov_b32 v253, 0
  v_mov_b32 v254, 0
  v_mov_b32 v255, 0
  v_mov_b32 v26, 0
  v_mov_b32 v27, 0
  v_mov_b32 v28, 0
  v_mov_b32 v29, 0
  v_mov_b32 v30, 0
  v_mov_b32 v31, 0
  v_mov_b32 v32, 0
  v_mov_b32 v33, 0
  v_mov_b32 v92, 149504
  ds_write_b128 v92, v[96:99]
  ds_write_b128 v92, v[96:99] offset:16
  s_waitcnt vmcnt(8)
  v_lshlrev_b32 v52, 16, v36
  v_and_b32 v53, 0xffff0000, v36
  v_lshlrev_b32 v54, 16, v37
  v_and_b32 v55, 0xffff0000, v37
  v_lshlrev_b32 v56, 16, v38
  v_and_b32 v57, 0xffff0000, v38
  v_lshlrev_b32 v58, 16, v39
  v_and_b32 v59, 0xffff0000, v39
  v_lshlrev_b32 v60, 16, v40
  v_and_b32 v61, 0xffff0000, v40
  v_lshlrev_b32 v62, 16, v41
  v_and_b32 v63, 0xffff0000, v41
  v_lshlrev_b32 v64, 16, v42
  v_and_b32 v65, 0xffff0000, v42
  v_lshlrev_b32 v66, 16, v43
  v_and_b32 v67, 0xffff0000, v43
  v_lshlrev_b32 v68, 16, v44
  v_and_b32 v69, 0xffff0000, v44
  v_lshlrev_b32 v70, 16, v45
  v_and_b32 v71, 0xffff0000, v45
  v_lshlrev_b32 v72, 16, v46
  v_and_b32 v73, 0xffff0000, v46
  v_lshlrev_b32 v74, 16, v47
  v_and_b32 v75, 0xffff0000, v47
  v_lshlrev_b32 v76, 16, v48
  v_and_b32 v77, 0xffff0000, v48
  v_lshlrev_b32 v78, 16, v49
  v_and_b32 v79, 0xffff0000, v49
  v_lshlrev_b32 v80, 16, v50
  v_and_b32 v81, 0xffff0000, v50
  v_lshlrev_b32 v82, 16, v51
  v_and_b32 v83, 0xffff0000, v51
  v_pk_add_f32 v[84:85], v[52:53], v[54:55]
  v_pk_add_f32 v[86:87], v[56:57], v[58:59]
  v_pk_add_f32 v[84:85], v[84:85], v[60:61]
  v_pk_add_f32 v[86:87], v[86:87], v[62:63]
  v_pk_add_f32 v[84:85], v[84:85], v[64:65]
  v_pk_add_f32 v[86:87], v[86:87], v[66:67]
  v_pk_add_f32 v[84:85], v[84:85], v[68:69]
  v_pk_add_f32 v[86:87], v[86:87], v[70:71]
  v_pk_add_f32 v[84:85], v[84:85], v[72:73]
  v_pk_add_f32 v[86:87], v[86:87], v[74:75]
  v_pk_add_f32 v[84:85], v[84:85], v[76:77]
  v_pk_add_f32 v[86:87], v[86:87], v[78:79]
  v_pk_add_f32 v[84:85], v[84:85], v[80:81]
  v_pk_add_f32 v[86:87], v[86:87], v[82:83]
  v_pk_add_f32 v[84:85], v[84:85], v[86:87]
  v_add_f32 v84, v84, v85
  s_nop 1
  v_add_f32_dpp v84, v84, v84 quad_perm:[1,0,3,2] row_mask:0xf bank_mask:0xf
  s_nop 1
  v_add_f32_dpp v84, v84, v84 quad_perm:[2,3,0,1] row_mask:0xf bank_mask:0xf
  s_nop 1
  v_add_f32_dpp v84, v84, v84 row_half_mirror row_mask:0xf bank_mask:0xf
  s_nop 1
  v_add_f32_dpp v84, v84, v84 row_mirror row_mask:0xf bank_mask:0xf
  s_nop 1
  v_mov_b32 v85, v84
  s_nop 1
  v_permlane16_swap_b32 v84, v85
  s_nop 1
  v_add_f32 v84, v84, v85
  v_mul_f32 v84, 0xba800000, v84
  v_pk_add_f32 v[52:53], v[52:53], v[84:85] op_sel_hi:[1,0]
  v_pk_add_f32 v[54:55], v[54:55], v[84:85] op_sel_hi:[1,0]
  v_pk_add_f32 v[56:57], v[56:57], v[84:85] op_sel_hi:[1,0]
  v_pk_add_f32 v[58:59], v[58:59], v[84:85] op_sel_hi:[1,0]
  v_pk_add_f32 v[60:61], v[60:61], v[84:85] op_sel_hi:[1,0]
  v_pk_add_f32 v[62:63], v[62:63], v[84:85] op_sel_hi:[1,0]
  v_pk_add_f32 v[64:65], v[64:65], v[84:85] op_sel_hi:[1,0]
  v_pk_add_f32 v[66:67], v[66:67], v[84:85] op_sel_hi:[1,0]
  v_pk_add_f32 v[68:69], v[68:69], v[84:85] op_sel_hi:[1,0]
  v_pk_add_f32 v[70:71], v[70:71], v[84:85] op_sel_hi:[1,0]
  v_pk_add_f32 v[72:73], v[72:73], v[84:85] op_sel_hi:[1,0]
  v_pk_add_f32 v[74:75], v[74:75], v[84:85] op_sel_hi:[1,0]
  v_pk_add_f32 v[76:77], v[76:77], v[84:85] op_sel_hi:[1,0]
  v_pk_add_f32 v[78:79], v[78:79], v[84:85] op_sel_hi:[1,0]
  v_pk_add_f32 v[80:81], v[80:81], v[84:85] op_sel_hi:[1,0]
  v_pk_add_f32 v[82:83], v[82:83], v[84:85] op_sel_hi:[1,0]
  v_pk_mul_f32 v[86:87], v[52:53], v[52:53]
  v_pk_mul_f32 v[88:89], v[54:55], v[54:55]
  v_pk_fma_f32 v[86:87], v[56:57], v[56:57], v[86:87]
  v_pk_fma_f32 v[88:89], v[58:59], v[58:59], v[88:89]
  v_pk_fma_f32 v[86:87], v[60:61], v[60:61], v[86:87]
  v_pk_fma_f32 v[88:89], v[62:63], v[62:63], v[88:89]
  v_pk_fma_f32 v[86:87], v[64:65], v[64:65], v[86:87]
  v_pk_fma_f32 v[88:89], v[66:67], v[66:67], v[88:89]
  v_pk_fma_f32 v[86:87], v[68:69], v[68:69], v[86:87]
  v_pk_fma_f32 v[88:89], v[70:71], v[70:71], v[88:89]
  v_pk_fma_f32 v[86:87], v[72:73], v[72:73], v[86:87]
  v_pk_fma_f32 v[88:89], v[74:75], v[74:75], v[88:89]
  v_pk_fma_f32 v[86:87], v[76:77], v[76:77], v[86:87]
  v_pk_fma_f32 v[88:89], v[78:79], v[78:79], v[88:89]
  v_pk_fma_f32 v[86:87], v[80:81], v[80:81], v[86:87]
  v_pk_fma_f32 v[88:89], v[82:83], v[82:83], v[88:89]
  v_pk_add_f32 v[86:87], v[86:87], v[88:89]
  v_add_f32 v86, v86, v87
  s_nop 1
  v_add_f32_dpp v86, v86, v86 quad_perm:[1,0,3,2] row_mask:0xf bank_mask:0xf
  s_nop 1
  v_add_f32_dpp v86, v86, v86 quad_perm:[2,3,0,1] row_mask:0xf bank_mask:0xf
  s_nop 1
  v_add_f32_dpp v86, v86, v86 row_half_mirror row_mask:0xf bank_mask:0xf
  s_nop 1
  v_add_f32_dpp v86, v86, v86 row_mirror row_mask:0xf bank_mask:0xf
  s_nop 1
  v_mov_b32 v87, v86
  s_nop 1
  v_permlane16_swap_b32 v86, v87
  s_nop 1
  v_add_f32 v86, v86, v87
  v_mov_b32 v85, 0x3727c5ac
  v_fmac_f32 v85, 0x3a800000, v86
  v_rsq_f32 v85, v85
  s_mov_b32 exec_lo, 1
  s_mov_b32 exec_hi, 1
  buffer_store_dwordx2 v[84:85], v91, s[36:39], s66 offen sc1
  s_mov_b64 exec, -1
  s_lshl_b32 s3, s2, 2
  s_add_u32 s3, s3, s48
  s_lshl_b32 s3, s3, 8
  s_add_u32 s3, s3, 2097152
  v_lshlrev_b32 v93, 2, v1
  buffer_store_dword v96, v93, s[36:39], s3 offen sc1
  s_waitcnt vmcnt(2) lgkmcnt(0)
  s_barrier
  ds_read_b128 v[36:39], v2 offset:0
  ds_read_b128 v[40:43], v2 offset:2048
  ds_read_b128 v[44:47], v2 offset:4096
  ds_read_b128 v[48:51], v2 offset:6144
  ds_read_b64_tr_b16 v[68:69], v4 offset:0
  ds_read_b64_tr_b16 v[70:71], v4 offset:512
  ds_read_b64_tr_b16 v[72:73], v4 offset:32768
  ds_read_b64_tr_b16 v[74:75], v4 offset:33280
  ds_read_b64_tr_b16 v[76:77], v8 offset:0
  ds_read_b64_tr_b16 v[78:79], v8 offset:512
  s_add_u32 m0, s46, 32768
  s_nop 0
  buffer_load_dwordx4 v10, s[12:15], 0 offen lds
  s_add_u32 m0, s46, 33792
  s_nop 0
  buffer_load_dwordx4 v11, s[12:15], 0 offen lds
  s_add_u32 m0, s46, 34816
  s_nop 0
  buffer_load_dwordx4 v10, s[12:15], s56 offen lds
  s_add_u32 m0, s46, 35840
  s_nop 0
  buffer_load_dwordx4 v11, s[12:15], s56 offen lds
  s_mov_b32 s47, 7
  s_mov_b32 s66, 6
L_k1loop_12:
  s_waitcnt lgkmcnt(4)
  s_setprio 2
  v_mfma_f32_16x16x32_bf16 v[96:99], v[68:71], v[36:39], v[96:99]
  ds_read_b64_tr_b16 v[80:81], v9 offset:0
  s_add_u32 m0, s46, 36864
  v_mfma_f32_16x16x32_bf16 v[100:103], v[68:71], v[40:43], v[100:103]
  ds_read_b64_tr_b16 v[82:83], v9 offset:512
  buffer_load_dwordx4 v10, s[12:15], s57 offen lds
  v_mfma_f32_16x16x32_bf16 v[104:107], v[68:71], v[44:47], v[104:107]
  s_add_u32 m0, s46, 37888
  v_mfma_f32_16x16x32_bf16 v[108:111], v[68:71], v[48:51], v[108:111]
  buffer_load_dwordx4 v11, s[12:15], s57 offen lds
  s_waitcnt lgkmcnt(4)
  v_smfmac_f32_16x16x64_bf16 v[26:29], v[12:15], v[68:75], v16
  v_mfma_f32_16x16x32_bf16 v[112:115], v[72:75], v[36:39], v[112:115]
  ds_read_b64_tr_b16 v[68:69], v5 offset:0
  s_add_u32 m0, s46, 38912
  v_mfma_f32_16x16x32_bf16 v[116:119], v[72:75], v[40:43], v[116:119]
  ds_read_b64_tr_b16 v[70:71], v5 offset:512
  buffer_load_dwordx4 v10, s[12:15], s58 offen lds
  v_mfma_f32_16x16x32_bf16 v[120:123], v[72:75], v[44:47], v[120:123]
  s_add_u32 m0, s46, 39936
  v_mfma_f32_16x16x32_bf16 v[124:127], v[72:75], v[48:51], v[124:127]
  buffer_load_dwordx4 v11, s[12:15], s58 offen lds
  v_add_u32 v10, 128, v10
  v_add_u32 v11, 128, v11
  s_waitcnt lgkmcnt(4)
  v_mfma_f32_16x16x32_bf16 v[128:131], v[36:39], v[76:79], v[128:131]
  ds_read_b64_tr_b16 v[72:73], v5 offset:32768
  v_mfma_f32_16x16x32_bf16 v[132:135], v[40:43], v[76:79], v[132:135]
  ds_read_b64_tr_b16 v[74:75], v5 offset:33280
  v_mfma_f32_16x16x32_bf16 v[136:139], v[44:47], v[76:79], v[136:139]
  v_mfma_f32_16x16x32_bf16 v[140:143], v[48:51], v[76:79], v[140:143]
  s_waitcnt lgkmcnt(4)
  s_setprio 1
  s_cmp_lg_u32 s48, 0
  s_cbranch_scc1 L_k1sk_15
  v_smfmac_f32_16x16x64_bf16 v[30:33], v[12:15], v[76:83], v16
L_k1sk_15:
  v_mfma_f32_16x16x32_bf16 v[144:147], v[36:39], v[80:83], v[144:147]
  ds_read_b64_tr_b16 v[76:77], v6 offset:0
  v_mfma_f32_16x16x32_bf16 v[148:151], v[40:43], v[80:83], v[148:151]
  ds_read_b64_tr_b16 v[78:79], v6 offset:512
  v_mfma_f32_16x16x32_bf16 v[152:155], v[44:47], v[80:83], v[152:155]
  v_mfma_f32_16x16x32_bf16 v[156:159], v[48:51], v[80:83], v[156:159]
  s_waitcnt lgkmcnt(4)
  v_mfma_f32_16x16x32_bf16 v[160:163], v[68:71], v[36:39], v[160:163]
  ds_read_b64_tr_b16 v[80:81], v6 offset:32768
  v_mfma_f32_16x16x32_bf16 v[164:167], v[68:71], v[40:43], v[164:167]
  ds_read_b64_tr_b16 v[82:83], v6 offset:33280
  v_mfma_f32_16x16x32_bf16 v[168:171], v[68:71], v[44:47], v[168:171]
  v_mfma_f32_16x16x32_bf16 v[172:175], v[68:71], v[48:51], v[172:175]
  s_waitcnt lgkmcnt(4)
  s_setprio 0
  v_mfma_f32_16x16x32_bf16 v[176:179], v[72:75], v[36:39], v[176:179]
  ds_read_b64_tr_b16 v[68:69], v7 offset:0
  v_mfma_f32_16x16x32_bf16 v[180:183], v[72:75], v[40:43], v[180:183]
  ds_read_b64_tr_b16 v[70:71], v7 offset:512
  v_mfma_f32_16x16x32_bf16 v[184:187], v[72:75], v[44:47], v[184:187]
  v_mfma_f32_16x16x32_bf16 v[188:191], v[72:75], v[48:51], v[188:191]
  s_waitcnt lgkmcnt(4)
  v_mfma_f32_16x16x32_bf16 v[192:195], v[76:79], v[36:39], v[192:195]
  ds_read_b64_tr_b16 v[72:73], v7 offset:32768
  v_mfma_f32_16x16x32_bf16 v[196:199], v[76:79], v[40:43], v[196:199]
  ds_read_b64_tr_b16 v[74:75], v7 offset:33280
  v_mfma_f32_16x16x32_bf16 v[200:203], v[76:79], v[44:47], v[200:203]
  v_mfma_f32_16x16x32_bf16 v[204:207], v[76:79], v[48:51], v[204:207]
  s_waitcnt lgkmcnt(0)
  s_barrier
  s_setprio 3
  v_mfma_f32_16x16x32_bf16 v[208:211], v[80:83], v[36:39], v[208:211]
  ds_read_b128 v[52:55], v3 offset:0
  ds_read_b128 v[56:59], v3 offset:2048
  v_mfma_f32_16x16x32_bf16 v[212:215], v[80:83], v[40:43], v[212:215]
  ds_read_b128 v[60:63], v3 offset:4096
  ds_read_b128 v[64:67], v3 offset:6144
  v_mfma_f32_16x16x32_bf16 v[216:219], v[80:83], v[44:47], v[216:219]
  ds_read_b64_tr_b16 v[76:77], v4 offset:4096
  ds_read_b64_tr_b16 v[78:79], v4 offset:4608
  v_mfma_f32_16x16x32_bf16 v[220:223], v[80:83], v[48:51], v[220:223]
  v_mfma_f32_16x16x32_bf16 v[224:227], v[68:71], v[36:39], v[224:227]
  ds_read_b64_tr_b16 v[80:81], v4 offset:36864
  v_mfma_f32_16x16x32_bf16 v[228:231], v[68:71], v[40:43], v[228:231]
  ds_read_b64_tr_b16 v[82:83], v4 offset:37376
  v_mfma_f32_16x16x32_bf16 v[232:235], v[68:71], v[44:47], v[232:235]
  v_mfma_f32_16x16x32_bf16 v[236:239], v[68:71], v[48:51], v[236:239]
  v_mfma_f32_16x16x32_bf16 v[240:243], v[72:75], v[36:39], v[240:243]
  ds_read_b64_tr_b16 v[68:69], v8 offset:4096
  v_mfma_f32_16x16x32_bf16 v[244:247], v[72:75], v[40:43], v[244:247]
  ds_read_b64_tr_b16 v[70:71], v8 offset:4608
  v_mfma_f32_16x16x32_bf16 v[248:251], v[72:75], v[44:47], v[248:251]
  v_mfma_f32_16x16x32_bf16 v[252:255], v[72:75], v[48:51], v[252:255]
  s_waitcnt lgkmcnt(4)
  s_setprio 2
  v_mfma_f32_16x16x32_bf16 v[96:99], v[76:79], v[52:55], v[96:99]
  ds_read_b64_tr_b16 v[72:73], v9 offset:4096
  v_mfma_f32_16x16x32_bf16 v[100:103], v[76:79], v[56:59], v[100:103]
  ds_read_b64_tr_b16 v[74:75], v9 offset:4608
  v_mfma_f32_16x16x32_bf16 v[104:107], v[76:79], v[60:63], v[104:107]
  v_mfma_f32_16x16x32_bf16 v[108:111], v[76:79], v[64:67], v[108:111]
  s_waitcnt lgkmcnt(4)
  v_smfmac_f32_16x16x64_bf16 v[26:29], v[12:15], v[76:83], v16
  v_mfma_f32_16x16x32_bf16 v[112:115], v[80:83], v[52:55], v[112:115]
  ds_read_b64_tr_b16 v[76:77], v5 offset:4096
  v_mfma_f32_16x16x32_bf16 v[116:119], v[80:83], v[56:59], v[116:119]
  ds_read_b64_tr_b16 v[78:79], v5 offset:4608
  v_mfma_f32_16x16x32_bf16 v[120:123], v[80:83], v[60:63], v[120:123]
  v_mfma_f32_16x16x32_bf16 v[124:127], v[80:83], v[64:67], v[124:127]
  s_waitcnt lgkmcnt(4)
  v_mfma_f32_16x16x32_bf16 v[128:131], v[52:55], v[68:71], v[128:131]
  ds_read_b64_tr_b16 v[80:81], v5 offset:36864
  v_mfma_f32_16x16x32_bf16 v[132:135], v[56:59], v[68:71], v[132:135]
  ds_read_b64_tr_b16 v[82:83], v5 offset:37376
  v_mfma_f32_16x16x32_bf16 v[136:139], v[60:63], v[68:71], v[136:139]
  v_mfma_f32_16x16x32_bf16 v[140:143], v[64:67], v[68:71], v[140:143]
  s_waitcnt lgkmcnt(4)
  s_setprio 1
  s_cmp_lg_u32 s48, 1
  s_cbranch_scc1 L_k1sk_16
  v_smfmac_f32_16x16x64_bf16 v[30:33], v[12:15], v[68:75], v16
L_k1sk_16:
  v_mfma_f32_16x16x32_bf16 v[144:147], v[52:55], v[72:75], v[144:147]
  ds_read_b64_tr_b16 v[68:69], v6 offset:4096
  v_mfma_f32_16x16x32_bf16 v[148:151], v[56:59], v[72:75], v[148:151]
  ds_read_b64_tr_b16 v[70:71], v6 offset:4608
  v_mfma_f32_16x16x32_bf16 v[152:155], v[60:63], v[72:75], v[152:155]
  v_mfma_f32_16x16x32_bf16 v[156:159], v[64:67], v[72:75], v[156:159]
  s_waitcnt lgkmcnt(4)
  v_mfma_f32_16x16x32_bf16 v[160:163], v[76:79], v[52:55], v[160:163]
  ds_read_b64_tr_b16 v[72:73], v6 offset:36864
  v_mfma_f32_16x16x32_bf16 v[164:167], v[76:79], v[56:59], v[164:167]
  ds_read_b64_tr_b16 v[74:75], v6 offset:37376
  v_mfma_f32_16x16x32_bf16 v[168:171], v[76:79], v[60:63], v[168:171]
  v_mfma_f32_16x16x32_bf16 v[172:175], v[76:79], v[64:67], v[172:175]
  s_waitcnt lgkmcnt(4)
  s_setprio 0
  v_mfma_f32_16x16x32_bf16 v[176:179], v[80:83], v[52:55], v[176:179]
  ds_read_b64_tr_b16 v[76:77], v7 offset:4096
  v_mfma_f32_16x16x32_bf16 v[180:183], v[80:83], v[56:59], v[180:183]
  ds_read_b64_tr_b16 v[78:79], v7 offset:4608
  v_mfma_f32_16x16x32_bf16 v[184:187], v[80:83], v[60:63], v[184:187]
  v_mfma_f32_16x16x32_bf16 v[188:191], v[80:83], v[64:67], v[188:191]
  s_waitcnt lgkmcnt(4)
  v_mfma_f32_16x16x32_bf16 v[192:195], v[68:71], v[52:55], v[192:195]
  ds_read_b64_tr_b16 v[80:81], v7 offset:36864
  v_mfma_f32_16x16x32_bf16 v[196:199], v[68:71], v[56:59], v[196:199]
  ds_read_b64_tr_b16 v[82:83], v7 offset:37376
  v_mfma_f32_16x16x32_bf16 v[200:203], v[68:71], v[60:63], v[200:203]
  v_mfma_f32_16x16x32_bf16 v[204:207], v[68:71], v[64:67], v[204:207]
  s_waitcnt vmcnt(0) lgkmcnt(0)
  s_barrier
  s_setprio 3
  v_mfma_f32_16x16x32_bf16 v[208:211], v[72:75], v[52:55], v[208:211]
  ds_read_b128 v[36:39], v2 offset:32768
  ds_read_b128 v[40:43], v2 offset:34816
  v_mfma_f32_16x16x32_bf16 v[212:215], v[72:75], v[56:59], v[212:215]
  ds_read_b128 v[44:47], v2 offset:36864
  ds_read_b128 v[48:51], v2 offset:38912
  v_mfma_f32_16x16x32_bf16 v[216:219], v[72:75], v[60:63], v[216:219]
  ds_read_b64_tr_b16 v[68:69], v4 offset:8192
  ds_read_b64_tr_b16 v[70:71], v4 offset:8704
  v_mfma_f32_16x16x32_bf16 v[220:223], v[72:75], v[64:67], v[220:223]
  v_mfma_f32_16x16x32_bf16 v[224:227], v[76:79], v[52:55], v[224:227]
  ds_read_b64_tr_b16 v[72:73], v4 offset:40960
  s_add_u32 m0, s46, 0
  v_mfma_f32_16x16x32_bf16 v[228:231], v[76:79], v[56:59], v[228:231]
  ds_read_b64_tr_b16 v[74:75], v4 offset:41472
  buffer_load_dwordx4 v10, s[12:15], 0 offen lds
  v_mfma_f32_16x16x32_bf16 v[232:235], v[76:79], v[60:63], v[232:235]
  s_add_u32 m0, s46, 1024
  v_mfma_f32_16x16x32_bf16 v[236:239], v[76:79], v[64:67], v[236:239]
  buffer_load_dwordx4 v11, s[12:15], 0 offen lds
  v_mfma_f32_16x16x32_bf16 v[240:243], v[80:83], v[52:55], v[240:243]
  ds_read_b64_tr_b16 v[76:77], v8 offset:8192
  s_add_u32 m0, s46, 2048
  v_mfma_f32_16x16x32_bf16 v[244:247], v[80:83], v[56:59], v[244:247]
  ds_read_b64_tr_b16 v[78:79], v8 offset:8704
  buffer_load_dwordx4 v10, s[12:15], s56 offen lds
  v_mfma_f32_16x16x32_bf16 v[248:251], v[80:83], v[60:63], v[248:251]
  s_add_u32 m0, s46, 3072
  v_mfma_f32_16x16x32_bf16 v[252:255], v[80:83], v[64:67], v[252:255]
  buffer_load_dwordx4 v11, s[12:15], s56 offen lds
  s_waitcnt lgkmcnt(4)
  s_setprio 2
  v_mfma_f32_16x16x32_bf16 v[96:99], v[68:71], v[36:39], v[96:99]
  ds_read_b64_tr_b16 v[80:81], v9 offset:8192
  s_add_u32 m0, s46, 4096
  v_mfma_f32_16x16x32_bf16 v[100:103], v[68:71], v[40:43], v[100:103]
  ds_read_b64_tr_b16 v[82:83], v9 offset:8704
  buffer_load_dwordx4 v10, s[12:15], s57 offen lds
  v_mfma_f32_16x16x32_bf16 v[104:107], v[68:71], v[44:47], v[104:107]
  s_add_u32 m0, s46, 5120
  v_mfma_f32_16x16x32_bf16 v[108:111], v[68:71], v[48:51], v[108:111]
  buffer_load_dwordx4 v11, s[12:15], s57 offen lds
  s_waitcnt lgkmcnt(4)
  v_smfmac_f32_16x16x64_bf16 v[26:29], v[12:15], v[68:75], v16
  v_mfma_f32_16x16x32_bf16 v[112:115], v[72:75], v[36:39], v[112:115]
  ds_read_b64_tr_b16 v[68:69], v5 offset:8192
  s_add_u32 m0, s46, 6144
  v_mfma_f32_16x16x32_bf16 v[116:119], v[72:75], v[40:43], v[116:119]
  ds_read_b64_tr_b16 v[70:71], v5 offset:8704
  buffer_load_dwordx4 v10, s[12:15], s58 offen lds
  v_mfma_f32_16x16x32_bf16 v[120:123], v[72:75], v[44:47], v[120:123]
  s_add_u32 m0, s46, 7168
  v_mfma_f32_16x16x32_bf16 v[124:127], v[72:75], v[48:51], v[124:127]
  buffer_load_dwordx4 v11, s[12:15], s58 offen lds
  v_add_u32 v10, 128, v10
  v_add_u32 v11, 128, v11
  s_waitcnt lgkmcnt(4)
  v_mfma_f32_16x16x32_bf16 v[128:131], v[36:39], v[76:79], v[128:131]
  ds_read_b64_tr_b16 v[72:73], v5 offset:40960
  v_mfma_f32_16x16x32_bf16 v[132:135], v[40:43], v[76:79], v[132:135]
  ds_read_b64_tr_b16 v[74:75], v5 offset:41472
  v_mfma_f32_16x16x32_bf16 v[136:139], v[44:47], v[76:79], v[136:139]
  v_mfma_f32_16x16x32_bf16 v[140:143], v[48:51], v[76:79], v[140:143]
  s_waitcnt lgkmcnt(4)
  s_setprio 1
  s_cmp_lg_u32 s48, 2
  s_cbranch_scc1 L_k1sk_17
  v_smfmac_f32_16x16x64_bf16 v[30:33], v[12:15], v[76:83], v16
L_k1sk_17:
  v_mfma_f32_16x16x32_bf16 v[144:147], v[36:39], v[80:83], v[144:147]
  ds_read_b64_tr_b16 v[76:77], v6 offset:8192
  v_mfma_f32_16x16x32_bf16 v[148:151], v[40:43], v[80:83], v[148:151]
  ds_read_b64_tr_b16 v[78:79], v6 offset:8704
  v_mfma_f32_16x16x32_bf16 v[152:155], v[44:47], v[80:83], v[152:155]
  v_mfma_f32_16x16x32_bf16 v[156:159], v[48:51], v[80:83], v[156:159]
  s_waitcnt lgkmcnt(4)
  v_mfma_f32_16x16x32_bf16 v[160:163], v[68:71], v[36:39], v[160:163]
  ds_read_b64_tr_b16 v[80:81], v6 offset:40960
  v_mfma_f32_16x16x32_bf16 v[164:167], v[68:71], v[40:43], v[164:167]
  ds_read_b64_tr_b16 v[82:83], v6 offset:41472
  v_mfma_f32_16x16x32_bf16 v[168:171], v[68:71], v[44:47], v[168:171]
  v_mfma_f32_16x16x32_bf16 v[172:175], v[68:71], v[48:51], v[172:175]
  s_waitcnt lgkmcnt(4)
  s_setprio 0
  v_mfma_f32_16x16x32_bf16 v[176:179], v[72:75], v[36:39], v[176:179]
  ds_read_b64_tr_b16 v[68:69], v7 offset:8192
  v_mfma_f32_16x16x32_bf16 v[180:183], v[72:75], v[40:43], v[180:183]
  ds_read_b64_tr_b16 v[70:71], v7 offset:8704
  v_mfma_f32_16x16x32_bf16 v[184:187], v[72:75], v[44:47], v[184:187]
  v_mfma_f32_16x16x32_bf16 v[188:191], v[72:75], v[48:51], v[188:191]
  s_waitcnt lgkmcnt(4)
  v_mfma_f32_16x16x32_bf16 v[192:195], v[76:79], v[36:39], v[192:195]
  ds_read_b64_tr_b16 v[72:73], v7 offset:40960
  v_mfma_f32_16x16x32_bf16 v[196:199], v[76:79], v[40:43], v[196:199]
  ds_read_b64_tr_b16 v[74:75], v7 offset:41472
  v_mfma_f32_16x16x32_bf16 v[200:203], v[76:79], v[44:47], v[200:203]
  v_mfma_f32_16x16x32_bf16 v[204:207], v[76:79], v[48:51], v[204:207]
  s_waitcnt lgkmcnt(0)
  s_barrier
  s_setprio 3
  v_mfma_f32_16x16x32_bf16 v[208:211], v[80:83], v[36:39], v[208:211]
  ds_read_b128 v[52:55], v3 offset:32768
  ds_read_b128 v[56:59], v3 offset:34816
  v_mfma_f32_16x16x32_bf16 v[212:215], v[80:83], v[40:43], v[212:215]
  ds_read_b128 v[60:63], v3 offset:36864
  ds_read_b128 v[64:67], v3 offset:38912
  v_mfma_f32_16x16x32_bf16 v[216:219], v[80:83], v[44:47], v[216:219]
  ds_read_b64_tr_b16 v[76:77], v4 offset:12288
  ds_read_b64_tr_b16 v[78:79], v4 offset:12800
  v_mfma_f32_16x16x32_bf16 v[220:223], v[80:83], v[48:51], v[220:223]
  v_mfma_f32_16x16x32_bf16 v[224:227], v[68:71], v[36:39], v[224:227]
  ds_read_b64_tr_b16 v[80:81], v4 offset:45056
  v_mfma_f32_16x16x32_bf16 v[228:231], v[68:71], v[40:43], v[228:231]
  ds_read_b64_tr_b16 v[82:83], v4 offset:45568
  v_mfma_f32_16x16x32_bf16 v[232:235], v[68:71], v[44:47], v[232:235]
  v_mfma_f32_16x16x32_bf16 v[236:239], v[68:71], v[48:51], v[236:239]
  v_mfma_f32_16x16x32_bf16 v[240:243], v[72:75], v[36:39], v[240:243]
  ds_read_b64_tr_b16 v[68:69], v8 offset:12288
  v_mfma_f32_16x16x32_bf16 v[244:247], v[72:75], v[40:43], v[244:247]
  ds_read_b64_tr_b16 v[70:71], v8 offset:12800
  v_mfma_f32_16x16x32_bf16 v[248:251], v[72:75], v[44:47], v[248:251]
  v_mfma_f32_16x16x32_bf16 v[252:255], v[72:75], v[48:51], v[252:255]
  s_waitcnt lgkmcnt(4)
  s_setprio 2
  v_mfma_f32_16x16x32_bf16 v[96:99], v[76:79], v[52:55], v[96:99]
  ds_read_b64_tr_b16 v[72:73], v9 offset:12288
  v_mfma_f32_16x16x32_bf16 v[100:103], v[76:79], v[56:59], v[100:103]
  ds_read_b64_tr_b16 v[74:75], v9 offset:12800
  v_mfma_f32_16x16x32_bf16 v[104:107], v[76:79], v[60:63], v[104:107]
  v_mfma_f32_16x16x32_bf16 v[108:111], v[76:79], v[64:67], v[108:111]
  s_waitcnt lgkmcnt(4)
  v_smfmac_f32_16x16x64_bf16 v[26:29], v[12:15], v[76:83], v16
  v_mfma_f32_16x16x32_bf16 v[112:115], v[80:83], v[52:55], v[112:115]
  ds_read_b64_tr_b16 v[76:77], v5 offset:12288
  v_mfma_f32_16x16x32_bf16 v[116:119], v[80:83], v[56:59], v[116:119]
  ds_read_b64_tr_b16 v[78:79], v5 offset:12800
  v_mfma_f32_16x16x32_bf16 v[120:123], v[80:83], v[60:63], v[120:123]
  v_mfma_f32_16x16x32_bf16 v[124:127], v[80:83], v[64:67], v[124:127]
  s_waitcnt lgkmcnt(4)
  v_mfma_f32_16x16x32_bf16 v[128:131], v[52:55], v[68:71], v[128:131]
  ds_read_b64_tr_b16 v[80:81], v5 offset:45056
  v_mfma_f32_16x16x32_bf16 v[132:135], v[56:59], v[68:71], v[132:135]
  ds_read_b64_tr_b16 v[82:83], v5 offset:45568
  v_mfma_f32_16x16x32_bf16 v[136:139], v[60:63], v[68:71], v[136:139]
  v_mfma_f32_16x16x32_bf16 v[140:143], v[64:67], v[68:71], v[140:143]
  s_waitcnt lgkmcnt(4)
  s_setprio 1
  s_cmp_lg_u32 s48, 3
  s_cbranch_scc1 L_k1sk_18
  v_smfmac_f32_16x16x64_bf16 v[30:33], v[12:15], v[68:75], v16
L_k1sk_18:
  v_mfma_f32_16x16x32_bf16 v[144:147], v[52:55], v[72:75], v[144:147]
  ds_read_b64_tr_b16 v[68:69], v6 offset:12288
  v_mfma_f32_16x16x32_bf16 v[148:151], v[56:59], v[72:75], v[148:151]
  ds_read_b64_tr_b16 v[70:71], v6 offset:12800
  v_mfma_f32_16x16x32_bf16 v[152:155], v[60:63], v[72:75], v[152:155]
  v_mfma_f32_16x16x32_bf16 v[156:159], v[64:67], v[72:75], v[156:159]
  s_waitcnt lgkmcnt(4)
  v_mfma_f32_16x16x32_bf16 v[160:163], v[76:79], v[52:55], v[160:163]
  ds_read_b64_tr_b16 v[72:73], v6 offset:45056
  v_mfma_f32_16x16x32_bf16 v[164:167], v[76:79], v[56:59], v[164:167]
  ds_read_b64_tr_b16 v[74:75], v6 offset:45568
  v_mfma_f32_16x16x32_bf16 v[168:171], v[76:79], v[60:63], v[168:171]
  v_mfma_f32_16x16x32_bf16 v[172:175], v[76:79], v[64:67], v[172:175]
  s_waitcnt lgkmcnt(4)
  s_setprio 0
  v_mfma_f32_16x16x32_bf16 v[176:179], v[80:83], v[52:55], v[176:179]
  ds_read_b64_tr_b16 v[76:77], v7 offset:12288
  v_mfma_f32_16x16x32_bf16 v[180:183], v[80:83], v[56:59], v[180:183]
  ds_read_b64_tr_b16 v[78:79], v7 offset:12800
  v_mfma_f32_16x16x32_bf16 v[184:187], v[80:83], v[60:63], v[184:187]
  v_mfma_f32_16x16x32_bf16 v[188:191], v[80:83], v[64:67], v[188:191]
  s_waitcnt lgkmcnt(4)
  v_mfma_f32_16x16x32_bf16 v[192:195], v[68:71], v[52:55], v[192:195]
  ds_read_b64_tr_b16 v[80:81], v7 offset:45056
  v_mfma_f32_16x16x32_bf16 v[196:199], v[68:71], v[56:59], v[196:199]
  ds_read_b64_tr_b16 v[82:83], v7 offset:45568
  v_mfma_f32_16x16x32_bf16 v[200:203], v[68:71], v[60:63], v[200:203]
  v_mfma_f32_16x16x32_bf16 v[204:207], v[68:71], v[64:67], v[204:207]
  s_waitcnt vmcnt(0) lgkmcnt(0)
  s_barrier
  s_setprio 3
  v_mfma_f32_16x16x32_bf16 v[208:211], v[72:75], v[52:55], v[208:211]
  ds_read_b128 v[36:39], v2 offset:0
  ds_read_b128 v[40:43], v2 offset:2048
  v_mfma_f32_16x16x32_bf16 v[212:215], v[72:75], v[56:59], v[212:215]
  ds_read_b128 v[44:47], v2 offset:4096
  ds_read_b128 v[48:51], v2 offset:6144
  v_mfma_f32_16x16x32_bf16 v[216:219], v[72:75], v[60:63], v[216:219]
  ds_read_b64_tr_b16 v[68:69], v4 offset:0
  ds_read_b64_tr_b16 v[70:71], v4 offset:512
  v_mfma_f32_16x16x32_bf16 v[220:223], v[72:75], v[64:67], v[220:223]
  v_mfma_f32_16x16x32_bf16 v[224:227], v[76:79], v[52:55], v[224:227]
  ds_read_b64_tr_b16 v[72:73], v4 offset:32768
  s_add_u32 m0, s46, 32768
  v_mfma_f32_16x16x32_bf16 v[228:231], v[76:79], v[56:59], v[228:231]
  ds_read_b64_tr_b16 v[74:75], v4 offset:33280
  buffer_load_dwordx4 v10, s[12:15], 0 offen lds
  v_mfma_f32_16x16x32_bf16 v[232:235], v[76:79], v[60:63], v[232:235]
  s_add_u32 m0, s46, 33792
  v_mfma_f32_16x16x32_bf16 v[236:239], v[76:79], v[64:67], v[236:239]
  buffer_load_dwordx4 v11, s[12:15], 0 offen lds
  v_mfma_f32_16x16x32_bf16 v[240:243], v[80:83], v[52:55], v[240:243]
  ds_read_b64_tr_b16 v[76:77], v8 offset:0
  s_add_u32 m0, s46, 34816
  v_mfma_f32_16x16x32_bf16 v[244:247], v[80:83], v[56:59], v[244:247]
  ds_read_b64_tr_b16 v[78:79], v8 offset:512
  buffer_load_dwordx4 v10, s[12:15], s56 offen lds
  v_mfma_f32_16x16x32_bf16 v[248:251], v[80:83], v[60:63], v[248:251]
  s_add_u32 m0, s46, 35840
  v_mfma_f32_16x16x32_bf16 v[252:255], v[80:83], v[64:67], v[252:255]
  buffer_load_dwordx4 v11, s[12:15], s56 offen lds
  s_sub_u32 s47, s47, 1
  s_cmp_lg_u32 s47, s66
  s_cbranch_scc1 L_k1loop_12
  s_cmp_eq_u32 s47, 0
  s_cbranch_scc1 L_k1tail_13
  s_cmp_eq_u32 s47, 1
  s_cbranch_scc1 L_k1poll_14
  s_mov_b32 s66, 1
  s_cmp_lg_u32 s40, 0
  s_cbranch_scc1 L_k1loop_12
  s_nop 7
  s_nop 7
  s_mov_b64 exec, 1
  buffer_atomic_add v17, off, s[68:71], s72 sc1
  s_mov_b64 exec, -1
  s_nop 7
  s_branch L_k1loop_12
L_k1poll_14:
  s_mov_b32 s66, 0
  buffer_load_dword v1, off, s[68:71], s72 sc1
  s_branch L_k1loop_12
L_k1tail_13:
  v_readfirstlane_b32 s61, v1
  s_lshl_b32 s3, s2, 3
  s_add_u32 s3, s3, s40
  s_lshl_b32 s3, s3, 9
  s_add_u32 s3, s3, 1048576
  s_cmp_eq_u32 s61, 32
  s_cselect_b32 s67, s67, s3
  buffer_load_dwordx2 v[18:19], v34, s[36:39], s67 offen offset:0 sc1
  buffer_load_dwordx2 v[20:21], v34, s[36:39], s67 offen offset:128 sc1
  buffer_load_dwordx2 v[22:23], v34, s[36:39], s67 offen offset:256 sc1
  buffer_load_dwordx2 v[24:25], v34, s[36:39], s67 offen offset:384 sc1
  s_waitcnt lgkmcnt(4)
  s_setprio 2
  v_mfma_f32_16x16x32_bf16 v[96:99], v[68:71], v[36:39], v[96:99]
  ds_read_b64_tr_b16 v[80:81], v9 offset:0
  s_add_u32 m0, s46, 36864
  v_mfma_f32_16x16x32_bf16 v[100:103], v[68:71], v[40:43], v[100:103]
  ds_read_b64_tr_b16 v[82:83], v9 offset:512
  buffer_load_dwordx4 v10, s[12:15], s57 offen lds
  v_mfma_f32_16x16x32_bf16 v[104:107], v[68:71], v[44:47], v[104:107]
  s_add_u32 m0, s46, 37888
  v_mfma_f32_16x16x32_bf16 v[108:111], v[68:71], v[48:51], v[108:111]
  buffer_load_dwordx4 v11, s[12:15], s57 offen lds
  s_waitcnt lgkmcnt(4)
  v_smfmac_f32_16x16x64_bf16 v[26:29], v[12:15], v[68:75], v16
  v_mfma_f32_16x16x32_bf16 v[112:115], v[72:75], v[36:39], v[112:115]
  ds_read_b64_tr_b16 v[68:69], v5 offset:0
  s_add_u32 m0, s46, 38912
  v_mfma_f32_16x16x32_bf16 v[116:119], v[72:75], v[40:43], v[116:119]
  ds_read_b64_tr_b16 v[70:71], v5 offset:512
  buffer_load_dwordx4 v10, s[12:15], s58 offen lds
  v_mfma_f32_16x16x32_bf16 v[120:123], v[72:75], v[44:47], v[120:123]
  s_add_u32 m0, s46, 39936
  v_mfma_f32_16x16x32_bf16 v[124:127], v[72:75], v[48:51], v[124:127]
  buffer_load_dwordx4 v11, s[12:15], s58 offen lds
  v_add_u32 v10, 128, v10
  v_add_u32 v11, 128, v11
  s_waitcnt lgkmcnt(4)
  v_mfma_f32_16x16x32_bf16 v[128:131], v[36:39], v[76:79], v[128:131]
  ds_read_b64_tr_b16 v[72:73], v5 offset:32768
  v_mfma_f32_16x16x32_bf16 v[132:135], v[40:43], v[76:79], v[132:135]
  ds_read_b64_tr_b16 v[74:75], v5 offset:33280
  v_mfma_f32_16x16x32_bf16 v[136:139], v[44:47], v[76:79], v[136:139]
  v_mfma_f32_16x16x32_bf16 v[140:143], v[48:51], v[76:79], v[140:143]
  s_waitcnt lgkmcnt(4)
  s_setprio 1
  s_cmp_lg_u32 s48, 0
  s_cbranch_scc1 L_k1sk_19
  v_smfmac_f32_16x16x64_bf16 v[30:33], v[12:15], v[76:83], v16
L_k1sk_19:
  v_mfma_f32_16x16x32_bf16 v[144:147], v[36:39], v[80:83], v[144:147]
  ds_read_b64_tr_b16 v[76:77], v6 offset:0
  v_mfma_f32_16x16x32_bf16 v[148:151], v[40:43], v[80:83], v[148:151]
  ds_read_b64_tr_b16 v[78:79], v6 offset:512
  v_mfma_f32_16x16x32_bf16 v[152:155], v[44:47], v[80:83], v[152:155]
  v_mfma_f32_16x16x32_bf16 v[156:159], v[48:51], v[80:83], v[156:159]
  s_waitcnt lgkmcnt(4)
  v_mfma_f32_16x16x32_bf16 v[160:163], v[68:71], v[36:39], v[160:163]
  ds_read_b64_tr_b16 v[80:81], v6 offset:32768
  v_mfma_f32_16x16x32_bf16 v[164:167], v[68:71], v[40:43], v[164:167]
  ds_read_b64_tr_b16 v[82:83], v6 offset:33280
  v_mfma_f32_16x16x32_bf16 v[168:171], v[68:71], v[44:47], v[168:171]
  v_mfma_f32_16x16x32_bf16 v[172:175], v[68:71], v[48:51], v[172:175]
  s_waitcnt lgkmcnt(4)
  s_setprio 0
  v_mfma_f32_16x16x32_bf16 v[176:179], v[72:75], v[36:39], v[176:179]
  ds_read_b64_tr_b16 v[68:69], v7 offset:0
  v_mfma_f32_16x16x32_bf16 v[180:183], v[72:75], v[40:43], v[180:183]
  ds_read_b64_tr_b16 v[70:71], v7 offset:512
  v_mfma_f32_16x16x32_bf16 v[184:187], v[72:75], v[44:47], v[184:187]
  v_mfma_f32_16x16x32_bf16 v[188:191], v[72:75], v[48:51], v[188:191]
  s_waitcnt lgkmcnt(4)
  v_mfma_f32_16x16x32_bf16 v[192:195], v[76:79], v[36:39], v[192:195]
  ds_read_b64_tr_b16 v[72:73], v7 offset:32768
  v_mfma_f32_16x16x32_bf16 v[196:199], v[76:79], v[40:43], v[196:199]
  ds_read_b64_tr_b16 v[74:75], v7 offset:33280
  v_mfma_f32_16x16x32_bf16 v[200:203], v[76:79], v[44:47], v[200:203]
  v_mfma_f32_16x16x32_bf16 v[204:207], v[76:79], v[48:51], v[204:207]
  s_waitcnt lgkmcnt(0)
  s_barrier
  s_setprio 3
  v_mfma_f32_16x16x32_bf16 v[208:211], v[80:83], v[36:39], v[208:211]
  ds_read_b128 v[52:55], v3 offset:0
  ds_read_b128 v[56:59], v3 offset:2048
  v_mfma_f32_16x16x32_bf16 v[212:215], v[80:83], v[40:43], v[212:215]
  ds_read_b128 v[60:63], v3 offset:4096
  ds_read_b128 v[64:67], v3 offset:6144
  v_mfma_f32_16x16x32_bf16 v[216:219], v[80:83], v[44:47], v[216:219]
  ds_read_b64_tr_b16 v[76:77], v4 offset:4096
  ds_read_b64_tr_b16 v[78:79], v4 offset:4608
  v_mfma_f32_16x16x32_bf16 v[220:223], v[80:83], v[48:51], v[220:223]
  v_mfma_f32_16x16x32_bf16 v[224:227], v[68:71], v[36:39], v[224:227]
  ds_read_b64_tr_b16 v[80:81], v4 offset:36864
  v_mfma_f32_16x16x32_bf16 v[228:231], v[68:71], v[40:43], v[228:231]
  ds_read_b64_tr_b16 v[82:83], v4 offset:37376
  v_mfma_f32_16x16x32_bf16 v[232:235], v[68:71], v[44:47], v[232:235]
  v_mfma_f32_16x16x32_bf16 v[236:239], v[68:71], v[48:51], v[236:239]
  v_mfma_f32_16x16x32_bf16 v[240:243], v[72:75], v[36:39], v[240:243]
  ds_read_b64_tr_b16 v[68:69], v8 offset:4096
  v_mfma_f32_16x16x32_bf16 v[244:247], v[72:75], v[40:43], v[244:247]
  ds_read_b64_tr_b16 v[70:71], v8 offset:4608
  v_mfma_f32_16x16x32_bf16 v[248:251], v[72:75], v[44:47], v[248:251]
  v_mfma_f32_16x16x32_bf16 v[252:255], v[72:75], v[48:51], v[252:255]
  s_waitcnt lgkmcnt(4)
  s_setprio 2
  v_mfma_f32_16x16x32_bf16 v[96:99], v[76:79], v[52:55], v[96:99]
  ds_read_b64_tr_b16 v[72:73], v9 offset:4096
  v_mfma_f32_16x16x32_bf16 v[100:103], v[76:79], v[56:59], v[100:103]
  ds_read_b64_tr_b16 v[74:75], v9 offset:4608
  v_mfma_f32_16x16x32_bf16 v[104:107], v[76:79], v[60:63], v[104:107]
  v_mfma_f32_16x16x32_bf16 v[108:111], v[76:79], v[64:67], v[108:111]
  s_waitcnt lgkmcnt(4)
  v_smfmac_f32_16x16x64_bf16 v[26:29], v[12:15], v[76:83], v16
  v_mfma_f32_16x16x32_bf16 v[112:115], v[80:83], v[52:55], v[112:115]
  ds_read_b64_tr_b16 v[76:77], v5 offset:4096
  v_mfma_f32_16x16x32_bf16 v[116:119], v[80:83], v[56:59], v[116:119]
  ds_read_b64_tr_b16 v[78:79], v5 offset:4608
  v_mfma_f32_16x16x32_bf16 v[120:123], v[80:83], v[60:63], v[120:123]
  v_mfma_f32_16x16x32_bf16 v[124:127], v[80:83], v[64:67], v[124:127]
  s_waitcnt lgkmcnt(4)
  v_mfma_f32_16x16x32_bf16 v[128:131], v[52:55], v[68:71], v[128:131]
  ds_read_b64_tr_b16 v[80:81], v5 offset:36864
  v_mfma_f32_16x16x32_bf16 v[132:135], v[56:59], v[68:71], v[132:135]
  ds_read_b64_tr_b16 v[82:83], v5 offset:37376
  v_mfma_f32_16x16x32_bf16 v[136:139], v[60:63], v[68:71], v[136:139]
  v_mfma_f32_16x16x32_bf16 v[140:143], v[64:67], v[68:71], v[140:143]
  s_waitcnt lgkmcnt(4)
  s_setprio 1
  s_cmp_lg_u32 s48, 1
  s_cbranch_scc1 L_k1sk_20
  v_smfmac_f32_16x16x64_bf16 v[30:33], v[12:15], v[68:75], v16
L_k1sk_20:
  v_mfma_f32_16x16x32_bf16 v[144:147], v[52:55], v[72:75], v[144:147]
  ds_read_b64_tr_b16 v[68:69], v6 offset:4096
  v_mfma_f32_16x16x32_bf16 v[148:151], v[56:59], v[72:75], v[148:151]
  ds_read_b64_tr_b16 v[70:71], v6 offset:4608
  v_mfma_f32_16x16x32_bf16 v[152:155], v[60:63], v[72:75], v[152:155]
  v_mfma_f32_16x16x32_bf16 v[156:159], v[64:67], v[72:75], v[156:159]
  s_waitcnt lgkmcnt(4)
  v_mfma_f32_16x16x32_bf16 v[160:163], v[76:79], v[52:55], v[160:163]
  ds_read_b64_tr_b16 v[72:73], v6 offset:36864
  v_mfma_f32_16x16x32_bf16 v[164:167], v[76:79], v[56:59], v[164:167]
  ds_read_b64_tr_b16 v[74:75], v6 offset:37376
  v_mfma_f32_16x16x32_bf16 v[168:171], v[76:79], v[60:63], v[168:171]
  v_mfma_f32_16x16x32_bf16 v[172:175], v[76:79], v[64:67], v[172:175]
  s_waitcnt lgkmcnt(4)
  s_setprio 0
  v_mfma_f32_16x16x32_bf16 v[176:179], v[80:83], v[52:55], v[176:179]
  ds_read_b64_tr_b16 v[76:77], v7 offset:4096
  v_mfma_f32_16x16x32_bf16 v[180:183], v[80:83], v[56:59], v[180:183]
  ds_read_b64_tr_b16 v[78:79], v7 offset:4608
  v_mfma_f32_16x16x32_bf16 v[184:187], v[80:83], v[60:63], v[184:187]
  v_mfma_f32_16x16x32_bf16 v[188:191], v[80:83], v[64:67], v[188:191]
  s_waitcnt lgkmcnt(4)
  v_mfma_f32_16x16x32_bf16 v[192:195], v[68:71], v[52:55], v[192:195]
  ds_read_b64_tr_b16 v[80:81], v7 offset:36864
  v_mfma_f32_16x16x32_bf16 v[196:199], v[68:71], v[56:59], v[196:199]
  ds_read_b64_tr_b16 v[82:83], v7 offset:37376
  v_mfma_f32_16x16x32_bf16 v[200:203], v[68:71], v[60:63], v[200:203]
  v_mfma_f32_16x16x32_bf16 v[204:207], v[68:71], v[64:67], v[204:207]
  s_waitcnt vmcnt(0) lgkmcnt(0)
  s_barrier
  s_setprio 0
  v_mfma_f32_16x16x32_bf16 v[208:211], v[72:75], v[52:55], v[208:211]
  ds_read_b128 v[36:39], v2 offset:32768
  ds_read_b128 v[40:43], v2 offset:34816
  v_mfma_f32_16x16x32_bf16 v[212:215], v[72:75], v[56:59], v[212:215]
  ds_read_b128 v[44:47], v2 offset:36864
  ds_read_b128 v[48:51], v2 offset:38912
  v_mfma_f32_16x16x32_bf16 v[216:219], v[72:75], v[60:63], v[216:219]
  ds_read_b64_tr_b16 v[68:69], v4 offset:8192
  ds_read_b64_tr_b16 v[70:71], v4 offset:8704
  v_mfma_f32_16x16x32_bf16 v[220:223], v[72:75], v[64:67], v[220:223]
  v_mfma_f32_16x16x32_bf16 v[224:227], v[76:79], v[52:55], v[224:227]
  ds_read_b64_tr_b16 v[72:73], v4 offset:40960
  v_mfma_f32_16x16x32_bf16 v[228:231], v[76:79], v[56:59], v[228:231]
  ds_read_b64_tr_b16 v[74:75], v4 offset:41472
  v_mfma_f32_16x16x32_bf16 v[232:235], v[76:79], v[60:63], v[232:235]
  v_mfma_f32_16x16x32_bf16 v[236:239], v[76:79], v[64:67], v[236:239]
  v_mfma_f32_16x16x32_bf16 v[240:243], v[80:83], v[52:55], v[240:243]
  ds_read_b64_tr_b16 v[76:77], v8 offset:8192
  v_mfma_f32_16x16x32_bf16 v[244:247], v[80:83], v[56:59], v[244:247]
  ds_read_b64_tr_b16 v[78:79], v8 offset:8704
  v_mfma_f32_16x16x32_bf16 v[248:251], v[80:83], v[60:63], v[248:251]
  v_mfma_f32_16x16x32_bf16 v[252:255], v[80:83], v[64:67], v[252:255]
  s_waitcnt lgkmcnt(4)
  v_mfma_f32_16x16x32_bf16 v[96:99], v[68:71], v[36:39], v[96:99]
  ds_read_b64_tr_b16 v[80:81], v9 offset:8192
  v_mfma_f32_16x16x32_bf16 v[100:103], v[68:71], v[40:43], v[100:103]
  ds_read_b64_tr_b16 v[82:83], v9 offset:8704
  v_mfma_f32_16x16x32_bf16 v[104:107], v[68:71], v[44:47], v[104:107]
  v_mfma_f32_16x16x32_bf16 v[108:111], v[68:71], v[48:51], v[108:111]
  s_waitcnt lgkmcnt(4)
  v_smfmac_f32_16x16x64_bf16 v[26:29], v[12:15], v[68:75], v16
  v_mfma_f32_16x16x32_bf16 v[112:115], v[72:75], v[36:39], v[112:115]
  ds_read_b64_tr_b16 v[68:69], v5 offset:8192
  v_mfma_f32_16x16x32_bf16 v[116:119], v[72:75], v[40:43], v[116:119]
  ds_read_b64_tr_b16 v[70:71], v5 offset:8704
  v_mfma_f32_16x16x32_bf16 v[120:123], v[72:75], v[44:47], v[120:123]
  v_mfma_f32_16x16x32_bf16 v[124:127], v[72:75], v[48:51], v[124:127]
  s_waitcnt lgkmcnt(4)
  v_mfma_f32_16x16x32_bf16 v[128:131], v[36:39], v[76:79], v[128:131]
  ds_read_b64_tr_b16 v[72:73], v5 offset:40960
  v_mfma_f32_16x16x32_bf16 v[132:135], v[40:43], v[76:79], v[132:135]
  ds_read_b64_tr_b16 v[74:75], v5 offset:41472
  v_mfma_f32_16x16x32_bf16 v[136:139], v[44:47], v[76:79], v[136:139]
  v_mfma_f32_16x16x32_bf16 v[140:143], v[48:51], v[76:79], v[140:143]
  s_waitcnt lgkmcnt(4)
  s_cmp_lg_u32 s48, 2
  s_cbranch_scc1 L_k1sk_21
  v_smfmac_f32_16x16x64_bf16 v[30:33], v[12:15], v[76:83], v16
L_k1sk_21:
  v_mfma_f32_16x16x32_bf16 v[144:147], v[36:39], v[80:83], v[144:147]
  ds_read_b64_tr_b16 v[76:77], v6 offset:8192
  v_mfma_f32_16x16x32_bf16 v[148:151], v[40:43], v[80:83], v[148:151]
  ds_read_b64_tr_b16 v[78:79], v6 offset:8704
  v_mfma_f32_16x16x32_bf16 v[152:155], v[44:47], v[80:83], v[152:155]
  v_mfma_f32_16x16x32_bf16 v[156:159], v[48:51], v[80:83], v[156:159]
  s_waitcnt lgkmcnt(4)
  v_mfma_f32_16x16x32_bf16 v[160:163], v[68:71], v[36:39], v[160:163]
  ds_read_b64_tr_b16 v[80:81], v6 offset:40960
  v_mfma_f32_16x16x32_bf16 v[164:167], v[68:71], v[40:43], v[164:167]
  ds_read_b64_tr_b16 v[82:83], v6 offset:41472
  v_mfma_f32_16x16x32_bf16 v[168:171], v[68:71], v[44:47], v[168:171]
  v_mfma_f32_16x16x32_bf16 v[172:175], v[68:71], v[48:51], v[172:175]
  s_waitcnt lgkmcnt(4)
  v_mfma_f32_16x16x32_bf16 v[176:179], v[72:75], v[36:39], v[176:179]
  ds_read_b64_tr_b16 v[68:69], v7 offset:8192
  v_mfma_f32_16x16x32_bf16 v[180:183], v[72:75], v[40:43], v[180:183]
  ds_read_b64_tr_b16 v[70:71], v7 offset:8704
  v_mfma_f32_16x16x32_bf16 v[184:187], v[72:75], v[44:47], v[184:187]
  v_mfma_f32_16x16x32_bf16 v[188:191], v[72:75], v[48:51], v[188:191]
  s_waitcnt lgkmcnt(4)
  v_mfma_f32_16x16x32_bf16 v[192:195], v[76:79], v[36:39], v[192:195]
  ds_read_b64_tr_b16 v[72:73], v7 offset:40960
  v_mfma_f32_16x16x32_bf16 v[196:199], v[76:79], v[40:43], v[196:199]
  ds_read_b64_tr_b16 v[74:75], v7 offset:41472
  v_mfma_f32_16x16x32_bf16 v[200:203], v[76:79], v[44:47], v[200:203]
  v_mfma_f32_16x16x32_bf16 v[204:207], v[76:79], v[48:51], v[204:207]
  s_waitcnt lgkmcnt(4)
  v_mfma_f32_16x16x32_bf16 v[208:211], v[80:83], v[36:39], v[208:211]
  ds_read_b128 v[52:55], v3 offset:32768
  ds_read_b128 v[56:59], v3 offset:34816
  v_mfma_f32_16x16x32_bf16 v[212:215], v[80:83], v[40:43], v[212:215]
  ds_read_b128 v[60:63], v3 offset:36864
  ds_read_b128 v[64:67], v3 offset:38912
  v_mfma_f32_16x16x32_bf16 v[216:219], v[80:83], v[44:47], v[216:219]
  ds_read_b64_tr_b16 v[76:77], v4 offset:12288
  ds_read_b64_tr_b16 v[78:79], v4 offset:12800
  v_mfma_f32_16x16x32_bf16 v[220:223], v[80:83], v[48:51], v[220:223]
  s_waitcnt lgkmcnt(8)
  v_mfma_f32_16x16x32_bf16 v[224:227], v[68:71], v[36:39], v[224:227]
  ds_read_b64_tr_b16 v[80:81], v4 offset:45056
  v_mfma_f32_16x16x32_bf16 v[228:231], v[68:71], v[40:43], v[228:231]
  ds_read_b64_tr_b16 v[82:83], v4 offset:45568
  v_mfma_f32_16x16x32_bf16 v[232:235], v[68:71], v[44:47], v[232:235]
  v_mfma_f32_16x16x32_bf16 v[236:239], v[68:71], v[48:51], v[236:239]
  s_waitcnt lgkmcnt(8)
  v_mfma_f32_16x16x32_bf16 v[240:243], v[72:75], v[36:39], v[240:243]
  ds_read_b64_tr_b16 v[68:69], v8 offset:12288
  v_mfma_f32_16x16x32_bf16 v[244:247], v[72:75], v[40:43], v[244:247]
  ds_read_b64_tr_b16 v[70:71], v8 offset:12800
  v_mfma_f32_16x16x32_bf16 v[248:251], v[72:75], v[44:47], v[248:251]
  v_mfma_f32_16x16x32_bf16 v[252:255], v[72:75], v[48:51], v[252:255]
  s_waitcnt lgkmcnt(4)
  v_mfma_f32_16x16x32_bf16 v[96:99], v[76:79], v[52:55], v[96:99]
  ds_read_b64_tr_b16 v[72:73], v9 offset:12288
  v_mfma_f32_16x16x32_bf16 v[100:103], v[76:79], v[56:59], v[100:103]
  ds_read_b64_tr_b16 v[74:75], v9 offset:12800
  v_mfma_f32_16x16x32_bf16 v[104:107], v[76:79], v[60:63], v[104:107]
  v_mfma_f32_16x16x32_bf16 v[108:111], v[76:79], v[64:67], v[108:111]
  s_waitcnt lgkmcnt(4)
  v_smfmac_f32_16x16x64_bf16 v[26:29], v[12:15], v[76:83], v16
  v_mfma_f32_16x16x32_bf16 v[112:115], v[80:83], v[52:55], v[112:115]
  ds_read_b64_tr_b16 v[76:77], v5 offset:12288
  v_mfma_f32_16x16x32_bf16 v[116:119], v[80:83], v[56:59], v[116:119]
  ds_read_b64_tr_b16 v[78:79], v5 offset:12800
  v_mfma_f32_16x16x32_bf16 v[120:123], v[80:83], v[60:63], v[120:123]
  v_mfma_f32_16x16x32_bf16 v[124:127], v[80:83], v[64:67], v[124:127]
  s_waitcnt lgkmcnt(4)
  v_mfma_f32_16x16x32_bf16 v[128:131], v[52:55], v[68:71], v[128:131]
  ds_read_b64_tr_b16 v[80:81], v5 offset:45056
  v_mfma_f32_16x16x32_bf16 v[132:135], v[56:59], v[68:71], v[132:135]
  ds_read_b64_tr_b16 v[82:83], v5 offset:45568
  v_mfma_f32_16x16x32_bf16 v[136:139], v[60:63], v[68:71], v[136:139]
  v_mfma_f32_16x16x32_bf16 v[140:143], v[64:67], v[68:71], v[140:143]
  s_waitcnt lgkmcnt(4)
  s_cmp_lg_u32 s48, 3
  s_cbranch_scc1 L_k1sk_22
  v_smfmac_f32_16x16x64_bf16 v[30:33], v[12:15], v[68:75], v16
L_k1sk_22:
  v_mfma_f32_16x16x32_bf16 v[144:147], v[52:55], v[72:75], v[144:147]
  ds_read_b64_tr_b16 v[68:69], v6 offset:12288
  v_mfma_f32_16x16x32_bf16 v[148:151], v[56:59], v[72:75], v[148:151]
  ds_read_b64_tr_b16 v[70:71], v6 offset:12800
  v_mfma_f32_16x16x32_bf16 v[152:155], v[60:63], v[72:75], v[152:155]
  v_mfma_f32_16x16x32_bf16 v[156:159], v[64:67], v[72:75], v[156:159]
  s_waitcnt lgkmcnt(4)
  v_mfma_f32_16x16x32_bf16 v[160:163], v[76:79], v[52:55], v[160:163]
  ds_read_b64_tr_b16 v[72:73], v6 offset:45056
  v_and_b32 v10, 15, v0
  s_lshl_b32 s3, s49, 10
  s_lshl_b32 s50, s48, 6
  v_mfma_f32_16x16x32_bf16 v[164:167], v[76:79], v[56:59], v[164:167]
  ds_read_b64_tr_b16 v[74:75], v6 offset:45568
  v_lshlrev_b32 v10, 2, v10
  s_add_u32 s3, s3, s50
  s_add_u32 s3, s3, 147456
  v_mfma_f32_16x16x32_bf16 v[168:171], v[76:79], v[60:63], v[168:171]
  v_add_u32 v10, s3, v10
  s_add_u32 s50, s50, 512
  v_mfma_f32_16x16x32_bf16 v[172:175], v[76:79], v[64:67], v[172:175]
  v_add_u32 v11, s50, v10
  s_lshl_b32 s3, s40, 2
  s_add_u32 s3, s3, 149504
  v_mov_b32 v35, s3
  s_waitcnt lgkmcnt(4)
  v_mfma_f32_16x16x32_bf16 v[176:179], v[80:83], v[52:55], v[176:179]
  ds_read_b64_tr_b16 v[76:77], v7 offset:12288
  v_add_f32 v26, v26, v27
  v_add_f32 v28, v28, v29
  v_add_f32 v30, v30, v31
  v_add_f32 v32, v32, v33
  v_mfma_f32_16x16x32_bf16 v[180:183], v[80:83], v[56:59], v[180:183]
  ds_read_b64_tr_b16 v[78:79], v7 offset:12800
  v_mfma_f32_16x16x32_bf16 v[184:187], v[80:83], v[60:63], v[184:187]
  ds_write_b32 v10, v26
  ds_write_b32 v10, v28 offset:256
  v_mfma_f32_16x16x32_bf16 v[188:191], v[80:83], v[64:67], v[188:191]
  ds_write_b32 v11, v30
  ds_write_b32 v11, v32 offset:64
  s_waitcnt lgkmcnt(8)
  v_mfma_f32_16x16x32_bf16 v[192:195], v[68:71], v[52:55], v[192:195]
  ds_read_b64_tr_b16 v[80:81], v7 offset:45056
  v_mfma_f32_16x16x32_bf16 v[196:199], v[68:71], v[56:59], v[196:199]
  ds_read_b64_tr_b16 v[82:83], v7 offset:45568
  v_mfma_f32_16x16x32_bf16 v[200:203], v[68:71], v[60:63], v[200:203]
  v_mfma_f32_16x16x32_bf16 v[204:207], v[68:71], v[64:67], v[204:207]
  s_waitcnt lgkmcnt(8)
  v_mfma_f32_16x16x32_bf16 v[208:211], v[72:75], v[52:55], v[208:211]
  v_mfma_f32_16x16x32_bf16 v[212:215], v[72:75], v[56:59], v[212:215]
  ds_write_b32 v35, v17
  v_mfma_f32_16x16x32_bf16 v[216:219], v[72:75], v[60:63], v[216:219]
  v_mfma_f32_16x16x32_bf16 v[220:223], v[72:75], v[64:67], v[220:223]
  s_waitcnt lgkmcnt(7)
  v_mfma_f32_16x16x32_bf16 v[224:227], v[76:79], v[52:55], v[224:227]
  v_mfma_f32_16x16x32_bf16 v[228:231], v[76:79], v[56:59], v[228:231]
  v_mfma_f32_16x16x32_bf16 v[232:235], v[76:79], v[60:63], v[232:235]
  v_mfma_f32_16x16x32_bf16 v[236:239], v[76:79], v[64:67], v[236:239]
  s_waitcnt lgkmcnt(1)
  v_mfma_f32_16x16x32_bf16 v[240:243], v[80:83], v[52:55], v[240:243]
  v_mfma_f32_16x16x32_bf16 v[244:247], v[80:83], v[56:59], v[244:247]
  v_mfma_f32_16x16x32_bf16 v[248:251], v[80:83], v[60:63], v[248:251]
  v_mfma_f32_16x16x32_bf16 v[252:255], v[80:83], v[64:67], v[252:255]
  s_branch L_k1_epi
L_k1_role1:
  s_bitcmp0_b32 s42, 1
  s_cbranch_scc1 L_k1_r1s
  s_add_u32 m0, s46, 0
  s_nop 0
  buffer_load_dwordx4 v10, s[16:19], s43 offen lds
  s_add_u32 s43, s43, 196608
  s_add_u32 m0, s46, 16384
  s_nop 0
  buffer_load_dwordx4 v11, s[20:23], s44 offen lds
  s_add_u32 m0, s46, 32768
  s_nop 0
  buffer_load_dwordx4 v35, s[24:27], s73 offen lds
  s_add_u32 m0, s46, 49152
  s_nop 0
  buffer_load_dwordx4 v11, s[28:31], s44 offen lds
  s_add_u32 s44, s44, 229376
  s_add_u32 m0, s46, 65536
  s_nop 0
  buffer_load_dwordx4 v35, s[32:35], s73 offen lds
  s_add_u32 s73, s73, s45
  s_add_u32 m0, s46, 4096
  s_nop 0
  buffer_load_dwordx4 v10, s[16:19], s43 offen lds
  s_add_u32 s43, s43, 196608
  s_add_u32 m0, s46, 20480
  s_nop 0
  buffer_load_dwordx4 v11, s[20:23], s44 offen lds
  s_add_u32 m0, s46, 36864
  s_nop 0
  buffer_load_dwordx4 v35, s[24:27], s73 offen lds
  s_add_u32 m0, s46, 53248
  s_nop 0
  buffer_load_dwordx4 v11, s[28:31], s44 offen lds
  s_add_u32 s44, s44, 229376
  s_add_u32 m0, s46, 69632
  s_nop 0
  buffer_load_dwordx4 v35, s[32:35], s73 offen lds
  s_add_u32 s73, s73, s45
  v_lshrrev_b32 v13, 4, v1
  v_and_b32 v34, 15, v1
  v_lshrrev_b32 v2, 1, v34
  v_xor_b32 v2, v2, v13
  v_lshlrev_b32 v2, 4, v2
  v_lshl_add_u32 v2, v34, 7, v2
  s_lshl_b32 s3, s48, 13
  s_add_u32 s3, s3, 81920
  v_add_u32 v2, s3, v2
  v_xor_b32 v3, 64, v2
  v_lshrrev_b32 v14, 2, v34
  v_lshl_add_u32 v15, v13, 3, v14
  v_lshlrev_b32 v15, 7, v15
  v_lshrrev_b32 v14, 1, v14
  v_lshl_add_u32 v15, v14, 5, v15
  v_and_b32 v14, 1, v13
  v_lshl_add_u32 v15, v14, 6, v15
  v_and_b32 v14, 3, v1
  v_lshl_add_u32 v15, v14, 3, v15
  s_lshl_b32 s3, s49, 6
  v_xor_b32 v8, s3, v15
  v_xor_b32 v9, 32, v8
  s_lshl_b32 s3, s48, 5
  v_xor_b32 v4, s3, v15
  s_add_u32 s3, s49, 1
  s_lshl_b32 s3, s3, 14
  v_add_u32 v4, s3, v4
  v_xor_b32 v5, 32, v4
  v_xor_b32 v6, 64, v4
  v_xor_b32 v7, 96, v4
  v_bfe_u32 v14, v1, 1, 1
  v_lshrrev_b32 v15, 5, v1
  v_cmp_eq_u32 vcc, v14, v15
  v_mov_b32 v14, 0x3f803f80
  s_nop 0
  v_cndmask_b32 v12, 0, v14, vcc
  v_and_b32 v14, 1, v1
  v_cmp_eq_u32 vcc, 0, v14
  v_mov_b32 v14, 0x44444444
  v_mov_b32 v15, 0xeeeeeeee
  v_cndmask_b32 v16, v15, v14, vcc
  v_mov_b32 v13, v12
  v_mov_b32 v14, v12
  v_mov_b32 v15, v12
  v_mov_b32 v17, 1
  v_lshlrev_b32 v34, 3, v34
  s_lshl_b32 s67, s41, 2
  s_add_u32 s67, s67, s48
  s_lshl_b32 s67, s67, 9
  v_mov_b32 v96, 0
  v_mov_b32 v97, 0
  v_mov_b32 v98, 0
  v_mov_b32 v99, 0
  v_mov_b32 v100, 0
  v_mov_b32 v101, 0
  v_mov_b32 v102, 0
  v_mov_b32 v103, 0
  v_mov_b32 v104, 0
  v_mov_b32 v105, 0
  v_mov_b32 v106, 0
  v_mov_b32 v107, 0
  v_mov_b32 v108, 0
  v_mov_b32 v109, 0
  v_mov_b32 v110, 0
  v_mov_b32 v111, 0
  v_mov_b32 v112, 0
  v_mov_b32 v113, 0
  v_mov_b32 v114, 0
  v_mov_b32 v115, 0
  v_mov_b32 v116, 0
  v_mov_b32 v117, 0
  v_mov_b32 v118, 0
  v_mov_b32 v119, 0
  v_mov_b32 v120, 0
  v_mov_b32 v121, 0
  v_mov_b32 v122, 0
  v_mov_b32 v123, 0
  v_mov_b32 v124, 0
  v_mov_b32 v125, 0
  v_mov_b32 v126, 0
  v_mov_b32 v127, 0
  v_mov_b32 v128, 0
  v_mov_b32 v129, 0
  v_mov_b32 v130, 0
  v_mov_b32 v131, 0
  v_mov_b32 v132, 0
  v_mov_b32 v133, 0
  v_mov_b32 v134, 0
  v_mov_b32 v135, 0
  v_mov_b32 v136, 0
  v_mov_b32 v137, 0
  v_mov_b32 v138, 0
  v_mov_b32 v139, 0
  v_mov_b32 v140, 0
  v_mov_b32 v141, 0
  v_mov_b32 v142, 0
  v_mov_b32 v143, 0
  v_mov_b32 v144, 0
  v_mov_b32 v145, 0
  v_mov_b32 v146, 0
  v_mov_b32 v147, 0
  v_mov_b32 v148, 0
  v_mov_b32 v149, 0
  v_mov_b32 v150, 0
  v_mov_b32 v151, 0
  v_mov_b32 v152, 0
  v_mov_b32 v153, 0
  v_mov_b32 v154, 0
  v_mov_b32 v155, 0
  v_mov_b32 v156, 0
  v_mov_b32 v157, 0
  v_mov_b32 v158, 0
  v_mov_b32 v159, 0
  v_mov_b32 v160, 0
  v_mov_b32 v161, 0
  v_mov_b32 v162, 0
  v_mov_b32 v163, 0
  v_mov_b32 v164, 0
  v_mov_b32 v165, 0
  v_mov_b32 v166, 0
  v_mov_b32 v167, 0
  v_mov_b32 v168, 0
  v_mov_b32 v169, 0
  v_mov_b32 v170, 0
  v_mov_b32 v171, 0
  v_mov_b32 v172, 0
  v_mov_b32 v173, 0
  v_mov_b32 v174, 0
  v_mov_b32 v175, 0
  v_mov_b32 v176, 0
  v_mov_b32 v177, 0
  v_mov_b32 v178, 0
  v_mov_b32 v179, 0
  v_mov_b32 v180, 0
  v_mov_b32 v181, 0
  v_mov_b32 v182, 0
  v_mov_b32 v183, 0
  v_mov_b32 v184, 0
  v_mov_b32 v185, 0
  v_mov_b32 v186, 0
  v_mov_b32 v187, 0
  v_mov_b32 v188, 0
  v_mov_b32 v189, 0
  v_mov_b32 v190, 0
  v_mov_b32 v191, 0
  v_mov_b32 v192, 0
  v_mov_b32 v193, 0
  v_mov_b32 v194, 0
  v_mov_b32 v195, 0
  v_mov_b32 v196, 0
  v_mov_b32 v197, 0
  v_mov_b32 v198, 0
  v_mov_b32 v199, 0
  v_mov_b32 v200, 0
  v_mov_b32 v201, 0
  v_mov_b32 v202, 0
  v_mov_b32 v203, 0
  v_mov_b32 v204, 0
  v_mov_b32 v205, 0
  v_mov_b32 v206, 0
  v_mov_b32 v207, 0
  v_mov_b32 v208, 0
  v_mov_b32 v209, 0
  v_mov_b32 v210, 0
  v_mov_b32 v211, 0
  v_mov_b32 v212, 0
  v_mov_b32 v213, 0
  v_mov_b32 v214, 0
  v_mov_b32 v215, 0
  v_mov_b32 v216, 0
  v_mov_b32 v217, 0
  v_mov_b32 v218, 0
  v_mov_b32 v219, 0
  v_mov_b32 v220, 0
  v_mov_b32 v221, 0
  v_mov_b32 v222, 0
  v_mov_b32 v223, 0
  v_mov_b32 v224, 0
  v_mov_b32 v225, 0
  v_mov_b32 v226, 0
  v_mov_b32 v227, 0
  v_mov_b32 v228, 0
  v_mov_b32 v229, 0
  v_mov_b32 v230, 0
  v_mov_b32 v231, 0
  v_mov_b32 v232, 0
  v_mov_b32 v233, 0
  v_mov_b32 v234, 0
  v_mov_b32 v235, 0
  v_mov_b32 v236, 0
  v_mov_b32 v237, 0
  v_mov_b32 v238, 0
  v_mov_b32 v239, 0
  v_mov_b32 v240, 0
  v_mov_b32 v241, 0
  v_mov_b32 v242, 0
  v_mov_b32 v243, 0
  v_mov_b32 v244, 0
  v_mov_b32 v245, 0
  v_mov_b32 v246, 0
  v_mov_b32 v247, 0
  v_mov_b32 v248, 0
  v_mov_b32 v249, 0
  v_mov_b32 v250, 0
  v_mov_b32 v251, 0
  v_mov_b32 v252, 0
  v_mov_b32 v253, 0
  v_mov_b32 v254, 0
  v_mov_b32 v255, 0
  v_mov_b32 v26, 0
  v_mov_b32 v27, 0
  v_mov_b32 v28, 0
  v_mov_b32 v29, 0
  v_mov_b32 v30, 0
  v_mov_b32 v31, 0
  v_mov_b32 v32, 0
  v_mov_b32 v33, 0
  s_waitcnt vmcnt(5) lgkmcnt(0)
  s_barrier
  ds_read_b128 v[36:39], v2 offset:0
  ds_read_b128 v[40:43], v2 offset:2048
  ds_read_b128 v[44:47], v2 offset:4096
  ds_read_b128 v[48:51], v2 offset:6144
  ds_read_b64_tr_b16 v[68:69], v4 offset:0
  ds_read_b64_tr_b16 v[70:71], v4 offset:512
  ds_read_b64_tr_b16 v[72:73], v4 offset:32768
  ds_read_b64_tr_b16 v[74:75], v4 offset:33280
  ds_read_b64_tr_b16 v[76:77], v8 offset:0
  ds_read_b64_tr_b16 v[78:79], v8 offset:512
  s_add_u32 m0, s46, 8192
  s_nop 0
  buffer_load_dwordx4 v10, s[16:19], s43 offen lds
  s_add_u32 s43, s43, 196608
  s_add_u32 m0, s46, 24576
  s_nop 0
  buffer_load_dwordx4 v11, s[20:23], s44 offen lds
  s_add_u32 m0, s46, 40960
  s_nop 0
  buffer_load_dwordx4 v35, s[24:27], s73 offen lds
  s_add_u32 m0, s46, 57344
  s_nop 0
  buffer_load_dwordx4 v11, s[28:31], s44 offen lds
  s_add_u32 s44, s44, 229376
  s_add_u32 m0, s46, 73728
  s_nop 0
  buffer_load_dwordx4 v35, s[32:35], s73 offen lds
  s_add_u32 s73, s73, s45
  s_add_u32 m0, s46, 12288
  s_nop 0
  buffer_load_dwordx4 v10, s[16:19], s43 offen lds
  s_add_u32 s43, s43, 196608
  s_add_u32 m0, s46, 28672
  s_nop 0
  buffer_load_dwordx4 v11, s[20:23], s44 offen lds
  s_mov_b32 s47, 7
  s_mov_b32 s66, 6
L_k1loop_23:
  s_waitcnt lgkmcnt(4)
  s_setprio 2
  v_mfma_f32_16x16x32_bf16 v[96:99], v[68:71], v[36:39], v[96:99]
  ds_read_b64_tr_b16 v[80:81], v9 offset:0
  v_mfma_f32_16x16x32_bf16 v[100:103], v[68:71], v[40:43], v[100:103]
  ds_read_b64_tr_b16 v[82:83], v9 offset:512
  v_mfma_f32_16x16x32_bf16 v[104:107], v[68:71], v[44:47], v[104:107]
  s_add_u32 m0, s46, 45056
  v_mfma_f32_16x16x32_bf16 v[108:111], v[68:71], v[48:51], v[108:111]
  buffer_load_dwordx4 v35, s[24:27], s73 offen lds
  s_waitcnt lgkmcnt(4)
  v_smfmac_f32_16x16x64_bf16 v[26:29], v[12:15], v[68:75], v16
  v_mfma_f32_16x16x32_bf16 v[112:115], v[72:75], v[36:39], v[112:115]
  ds_read_b64_tr_b16 v[68:69], v5 offset:0
  v_mfma_f32_16x16x32_bf16 v[116:119], v[72:75], v[40:43], v[116:119]
  ds_read_b64_tr_b16 v[70:71], v5 offset:512
  v_mfma_f32_16x16x32_bf16 v[120:123], v[72:75], v[44:47], v[120:123]
  s_add_u32 m0, s46, 61440
  v_mfma_f32_16x16x32_bf16 v[124:127], v[72:75], v[48:51], v[124:127]
  buffer_load_dwordx4 v11, s[28:31], s44 offen lds
  s_add_u32 s44, s44, 229376
  s_waitcnt lgkmcnt(4)
  v_mfma_f32_16x16x32_bf16 v[128:131], v[76:79], v[36:39], v[128:131]
  ds_read_b64_tr_b16 v[72:73], v5 offset:32768
  v_mfma_f32_16x16x32_bf16 v[132:135], v[76:79], v[40:43], v[132:135]
  ds_read_b64_tr_b16 v[74:75], v5 offset:33280
  v_mfma_f32_16x16x32_bf16 v[136:139], v[76:79], v[44:47], v[136:139]
  s_add_u32 m0, s46, 77824
  v_mfma_f32_16x16x32_bf16 v[140:143], v[76:79], v[48:51], v[140:143]
  buffer_load_dwordx4 v35, s[32:35], s73 offen lds
  s_add_u32 s73, s73, s45
  s_waitcnt lgkmcnt(4)
  s_setprio 1
  v_mfma_f32_16x16x32_bf16 v[144:147], v[80:83], v[36:39], v[144:147]
  s_cmp_lg_u32 s48, 0
  s_cbranch_scc1 L_k1sk_26
  v_smfmac_f32_16x16x64_bf16 v[30:33], v[12:15], v[76:83], v16
L_k1sk_26:
  v_mfma_f32_16x16x32_bf16 v[148:151], v[80:83], v[40:43], v[148:151]
  ds_read_b64_tr_b16 v[76:77], v6 offset:0
  ds_read_b64_tr_b16 v[78:79], v6 offset:512
  v_mfma_f32_16x16x32_bf16 v[152:155], v[80:83], v[44:47], v[152:155]
  v_mfma_f32_16x16x32_bf16 v[156:159], v[80:83], v[48:51], v[156:159]
  s_waitcnt lgkmcnt(4)
  v_mfma_f32_16x16x32_bf16 v[160:163], v[68:71], v[36:39], v[160:163]
  ds_read_b64_tr_b16 v[80:81], v6 offset:32768
  v_mfma_f32_16x16x32_bf16 v[164:167], v[68:71], v[40:43], v[164:167]
  ds_read_b64_tr_b16 v[82:83], v6 offset:33280
  v_mfma_f32_16x16x32_bf16 v[168:171], v[68:71], v[44:47], v[168:171]
  v_mfma_f32_16x16x32_bf16 v[172:175], v[68:71], v[48:51], v[172:175]
  s_waitcnt lgkmcnt(4)
  s_setprio 0
  v_mfma_f32_16x16x32_bf16 v[176:179], v[72:75], v[36:39], v[176:179]
  ds_read_b64_tr_b16 v[68:69], v7 offset:0
  v_mfma_f32_16x16x32_bf16 v[180:183], v[72:75], v[40:43], v[180:183]
  ds_read_b64_tr_b16 v[70:71], v7 offset:512
  v_mfma_f32_16x16x32_bf16 v[184:187], v[72:75], v[44:47], v[184:187]
  v_mfma_f32_16x16x32_bf16 v[188:191], v[72:75], v[48:51], v[188:191]
  s_waitcnt lgkmcnt(4)
  v_mfma_f32_16x16x32_bf16 v[192:195], v[76:79], v[36:39], v[192:195]
  ds_read_b64_tr_b16 v[72:73], v7 offset:32768
  v_mfma_f32_16x16x32_bf16 v[196:199], v[76:79], v[40:43], v[196:199]
  ds_read_b64_tr_b16 v[74:75], v7 offset:33280
  v_mfma_f32_16x16x32_bf16 v[200:203], v[76:79], v[44:47], v[200:203]
  v_mfma_f32_16x16x32_bf16 v[204:207], v[76:79], v[48:51], v[204:207]
  s_waitcnt vmcnt(10) lgkmcnt(0)
  s_barrier
  s_setprio 3
  v_mfma_f32_16x16x32_bf16 v[208:211], v[80:83], v[36:39], v[208:211]
  ds_read_b128 v[52:55], v3 offset:0
  ds_read_b128 v[56:59], v3 offset:2048
  v_mfma_f32_16x16x32_bf16 v[212:215], v[80:83], v[40:43], v[212:215]
  ds_read_b128 v[60:63], v3 offset:4096
  ds_read_b128 v[64:67], v3 offset:6144
  v_mfma_f32_16x16x32_bf16 v[216:219], v[80:83], v[44:47], v[216:219]
  ds_read_b64_tr_b16 v[76:77], v4 offset:4096
  ds_read_b64_tr_b16 v[78:79], v4 offset:4608
  v_mfma_f32_16x16x32_bf16 v[220:223], v[80:83], v[48:51], v[220:223]
  v_mfma_f32_16x16x32_bf16 v[224:227], v[68:71], v[36:39], v[224:227]
  ds_read_b64_tr_b16 v[80:81], v4 offset:36864
  v_mfma_f32_16x16x32_bf16 v[228:231], v[68:71], v[40:43], v[228:231]
  ds_read_b64_tr_b16 v[82:83], v4 offset:37376
  v_mfma_f32_16x16x32_bf16 v[232:235], v[68:71], v[44:47], v[232:235]
  s_add_u32 m0, s46, 0
  v_mfma_f32_16x16x32_bf16 v[236:239], v[68:71], v[48:51], v[236:239]
  buffer_load_dwordx4 v10, s[16:19], s43 offen lds
  s_add_u32 s43, s43, 196608
  v_mfma_f32_16x16x32_bf16 v[240:243], v[72:75], v[36:39], v[240:243]
  ds_read_b64_tr_b16 v[68:69], v8 offset:4096
  v_mfma_f32_16x16x32_bf16 v[244:247], v[72:75], v[40:43], v[244:247]
  ds_read_b64_tr_b16 v[70:71], v8 offset:4608
  v_mfma_f32_16x16x32_bf16 v[248:251], v[72:75], v[44:47], v[248:251]
  s_add_u32 m0, s46, 16384
  v_mfma_f32_16x16x32_bf16 v[252:255], v[72:75], v[48:51], v[252:255]
  buffer_load_dwordx4 v11, s[20:23], s44 offen lds
  s_waitcnt lgkmcnt(4)
  s_setprio 2
  v_mfma_f32_16x16x32_bf16 v[96:99], v[76:79], v[52:55], v[96:99]
  ds_read_b64_tr_b16 v[72:73], v9 offset:4096
  v_mfma_f32_16x16x32_bf16 v[100:103], v[76:79], v[56:59], v[100:103]
  ds_read_b64_tr_b16 v[74:75], v9 offset:4608
  v_mfma_f32_16x16x32_bf16 v[104:107], v[76:79], v[60:63], v[104:107]
  s_add_u32 m0, s46, 32768
  v_mfma_f32_16x16x32_bf16 v[108:111], v[76:79], v[64:67], v[108:111]
  buffer_load_dwordx4 v35, s[24:27], s73 offen lds
  s_waitcnt lgkmcnt(4)
  v_smfmac_f32_16x16x64_bf16 v[26:29], v[12:15], v[76:83], v16
  v_mfma_f32_16x16x32_bf16 v[112:115], v[80:83], v[52:55], v[112:115]
  ds_read_b64_tr_b16 v[76:77], v5 offset:4096
  v_mfma_f32_16x16x32_bf16 v[116:119], v[80:83], v[56:59], v[116:119]
  ds_read_b64_tr_b16 v[78:79], v5 offset:4608
  v_mfma_f32_16x16x32_bf16 v[120:123], v[80:83], v[60:63], v[120:123]
  s_add_u32 m0, s46, 49152
  v_mfma_f32_16x16x32_bf16 v[124:127], v[80:83], v[64:67], v[124:127]
  buffer_load_dwordx4 v11, s[28:31], s44 offen lds
  s_add_u32 s44, s44, 229376
  s_waitcnt lgkmcnt(4)
  v_mfma_f32_16x16x32_bf16 v[128:131], v[68:71], v[52:55], v[128:131]
  ds_read_b64_tr_b16 v[80:81], v5 offset:36864
  v_mfma_f32_16x16x32_bf16 v[132:135], v[68:71], v[56:59], v[132:135]
  ds_read_b64_tr_b16 v[82:83], v5 offset:37376
  v_mfma_f32_16x16x32_bf16 v[136:139], v[68:71], v[60:63], v[136:139]
  s_add_u32 m0, s46, 65536
  v_mfma_f32_16x16x32_bf16 v[140:143], v[68:71], v[64:67], v[140:143]
  buffer_load_dwordx4 v35, s[32:35], s73 offen lds
  s_add_u32 s73, s73, s45
  s_waitcnt lgkmcnt(4)
  s_setprio 1
  v_mfma_f32_16x16x32_bf16 v[144:147], v[72:75], v[52:55], v[144:147]
  s_cmp_lg_u32 s48, 1
  s_cbranch_scc1 L_k1sk_27
  v_smfmac_f32_16x16x64_bf16 v[30:33], v[12:15], v[68:75], v16
L_k1sk_27:
  v_mfma_f32_16x16x32_bf16 v[148:151], v[72:75], v[56:59], v[148:151]
  ds_read_b64_tr_b16 v[68:69], v6 offset:4096
  ds_read_b64_tr_b16 v[70:71], v6 offset:4608
  v_mfma_f32_16x16x32_bf16 v[152:155], v[72:75], v[60:63], v[152:155]
  v_mfma_f32_16x16x32_bf16 v[156:159], v[72:75], v[64:67], v[156:159]
  s_waitcnt lgkmcnt(4)
  v_mfma_f32_16x16x32_bf16 v[160:163], v[76:79], v[52:55], v[160:163]
  ds_read_b64_tr_b16 v[72:73], v6 offset:36864
  v_mfma_f32_16x16x32_bf16 v[164:167], v[76:79], v[56:59], v[164:167]
  ds_read_b64_tr_b16 v[74:75], v6 offset:37376
  v_mfma_f32_16x16x32_bf16 v[168:171], v[76:79], v[60:63], v[168:171]
  v_mfma_f32_16x16x32_bf16 v[172:175], v[76:79], v[64:67], v[172:175]
  s_waitcnt lgkmcnt(4)
  s_setprio 0
  v_mfma_f32_16x16x32_bf16 v[176:179], v[80:83], v[52:55], v[176:179]
  ds_read_b64_tr_b16 v[76:77], v7 offset:4096
  v_mfma_f32_16x16x32_bf16 v[180:183], v[80:83], v[56:59], v[180:183]
  ds_read_b64_tr_b16 v[78:79], v7 offset:4608
  v_mfma_f32_16x16x32_bf16 v[184:187], v[80:83], v[60:63], v[184:187]
  v_mfma_f32_16x16x32_bf16 v[188:191], v[80:83], v[64:67], v[188:191]
  s_waitcnt lgkmcnt(4)
  v_mfma_f32_16x16x32_bf16 v[192:195], v[68:71], v[52:55], v[192:195]
  ds_read_b64_tr_b16 v[80:81], v7 offset:36864
  v_mfma_f32_16x16x32_bf16 v[196:199], v[68:71], v[56:59], v[196:199]
  ds_read_b64_tr_b16 v[82:83], v7 offset:37376
  v_mfma_f32_16x16x32_bf16 v[200:203], v[68:71], v[60:63], v[200:203]
  v_mfma_f32_16x16x32_bf16 v[204:207], v[68:71], v[64:67], v[204:207]
  s_waitcnt vmcnt(10) lgkmcnt(0)
  s_barrier
  s_setprio 3
  v_mfma_f32_16x16x32_bf16 v[208:211], v[72:75], v[52:55], v[208:211]
  ds_read_b128 v[36:39], v2 offset:32768
  ds_read_b128 v[40:43], v2 offset:34816
  v_mfma_f32_16x16x32_bf16 v[212:215], v[72:75], v[56:59], v[212:215]
  ds_read_b128 v[44:47], v2 offset:36864
  ds_read_b128 v[48:51], v2 offset:38912
  v_mfma_f32_16x16x32_bf16 v[216:219], v[72:75], v[60:63], v[216:219]
  ds_read_b64_tr_b16 v[68:69], v4 offset:8192
  ds_read_b64_tr_b16 v[70:71], v4 offset:8704
  v_mfma_f32_16x16x32_bf16 v[220:223], v[72:75], v[64:67], v[220:223]
  v_mfma_f32_16x16x32_bf16 v[224:227], v[76:79], v[52:55], v[224:227]
  ds_read_b64_tr_b16 v[72:73], v4 offset:40960
  v_mfma_f32_16x16x32_bf16 v[228:231], v[76:79], v[56:59], v[228:231]
  ds_read_b64_tr_b16 v[74:75], v4 offset:41472
  v_mfma_f32_16x16x32_bf16 v[232:235], v[76:79], v[60:63], v[232:235]
  s_add_u32 m0, s46, 4096
  v_mfma_f32_16x16x32_bf16 v[236:239], v[76:79], v[64:67], v[236:239]
  buffer_load_dwordx4 v10, s[16:19], s43 offen lds
  s_add_u32 s43, s43, 196608
  v_mfma_f32_16x16x32_bf16 v[240:243], v[80:83], v[52:55], v[240:243]
  ds_read_b64_tr_b16 v[76:77], v8 offset:8192
  v_mfma_f32_16x16x32_bf16 v[244:247], v[80:83], v[56:59], v[244:247]
  ds_read_b64_tr_b16 v[78:79], v8 offset:8704
  v_mfma_f32_16x16x32_bf16 v[248:251], v[80:83], v[60:63], v[248:251]
  s_add_u32 m0, s46, 20480
  v_mfma_f32_16x16x32_bf16 v[252:255], v[80:83], v[64:67], v[252:255]
  buffer_load_dwordx4 v11, s[20:23], s44 offen lds
  s_waitcnt lgkmcnt(4)
  s_setprio 2
  v_mfma_f32_16x16x32_bf16 v[96:99], v[68:71], v[36:39], v[96:99]
  ds_read_b64_tr_b16 v[80:81], v9 offset:8192
  v_mfma_f32_16x16x32_bf16 v[100:103], v[68:71], v[40:43], v[100:103]
  ds_read_b64_tr_b16 v[82:83], v9 offset:8704
  v_mfma_f32_16x16x32_bf16 v[104:107], v[68:71], v[44:47], v[104:107]
  s_add_u32 m0, s46, 36864
  v_mfma_f32_16x16x32_bf16 v[108:111], v[68:71], v[48:51], v[108:111]
  buffer_load_dwordx4 v35, s[24:27], s73 offen lds
  s_waitcnt lgkmcnt(4)
  v_smfmac_f32_16x16x64_bf16 v[26:29], v[12:15], v[68:75], v16
  v_mfma_f32_16x16x32_bf16 v[112:115], v[72:75], v[36:39], v[112:115]
  ds_read_b64_tr_b16 v[68:69], v5 offset:8192
  v_mfma_f32_16x16x32_bf16 v[116:119], v[72:75], v[40:43], v[116:119]
  ds_read_b64_tr_b16 v[70:71], v5 offset:8704
  v_mfma_f32_16x16x32_bf16 v[120:123], v[72:75], v[44:47], v[120:123]
  s_add_u32 m0, s46, 53248
  v_mfma_f32_16x16x32_bf16 v[124:127], v[72:75], v[48:51], v[124:127]
  buffer_load_dwordx4 v11, s[28:31], s44 offen lds
  s_add_u32 s44, s44, 229376
  s_waitcnt lgkmcnt(4)
  v_mfma_f32_16x16x32_bf16 v[128:131], v[76:79], v[36:39], v[128:131]
  ds_read_b64_tr_b16 v[72:73], v5 offset:40960
  v_mfma_f32_16x16x32_bf16 v[132:135], v[76:79], v[40:43], v[132:135]
  ds_read_b64_tr_b16 v[74:75], v5 offset:41472
  v_mfma_f32_16x16x32_bf16 v[136:139], v[76:79], v[44:47], v[136:139]
  s_add_u32 m0, s46, 69632
  v_mfma_f32_16x16x32_bf16 v[140:143], v[76:79], v[48:51], v[140:143]
  buffer_load_dwordx4 v35, s[32:35], s73 offen lds
  s_add_u32 s73, s73, s45
  s_waitcnt lgkmcnt(4)
  s_setprio 1
  v_mfma_f32_16x16x32_bf16 v[144:147], v[80:83], v[36:39], v[144:147]
  s_cmp_lg_u32 s48, 2
  s_cbranch_scc1 L_k1sk_28
  v_smfmac_f32_16x16x64_bf16 v[30:33], v[12:15], v[76:83], v16
L_k1sk_28:
  v_mfma_f32_16x16x32_bf16 v[148:151], v[80:83], v[40:43], v[148:151]
  ds_read_b64_tr_b16 v[76:77], v6 offset:8192
  ds_read_b64_tr_b16 v[78:79], v6 offset:8704
  v_mfma_f32_16x16x32_bf16 v[152:155], v[80:83], v[44:47], v[152:155]
  v_mfma_f32_16x16x32_bf16 v[156:159], v[80:83], v[48:51], v[156:159]
  s_waitcnt lgkmcnt(4)
  v_mfma_f32_16x16x32_bf16 v[160:163], v[68:71], v[36:39], v[160:163]
  ds_read_b64_tr_b16 v[80:81], v6 offset:40960
  v_mfma_f32_16x16x32_bf16 v[164:167], v[68:71], v[40:43], v[164:167]
  ds_read_b64_tr_b16 v[82:83], v6 offset:41472
  v_mfma_f32_16x16x32_bf16 v[168:171], v[68:71], v[44:47], v[168:171]
  v_mfma_f32_16x16x32_bf16 v[172:175], v[68:71], v[48:51], v[172:175]
  s_waitcnt lgkmcnt(4)
  s_setprio 0
  v_mfma_f32_16x16x32_bf16 v[176:179], v[72:75], v[36:39], v[176:179]
  ds_read_b64_tr_b16 v[68:69], v7 offset:8192
  v_mfma_f32_16x16x32_bf16 v[180:183], v[72:75], v[40:43], v[180:183]
  ds_read_b64_tr_b16 v[70:71], v7 offset:8704
  v_mfma_f32_16x16x32_bf16 v[184:187], v[72:75], v[44:47], v[184:187]
  v_mfma_f32_16x16x32_bf16 v[188:191], v[72:75], v[48:51], v[188:191]
  s_waitcnt lgkmcnt(4)
  v_mfma_f32_16x16x32_bf16 v[192:195], v[76:79], v[36:39], v[192:195]
  ds_read_b64_tr_b16 v[72:73], v7 offset:40960
  v_mfma_f32_16x16x32_bf16 v[196:199], v[76:79], v[40:43], v[196:199]
  ds_read_b64_tr_b16 v[74:75], v7 offset:41472
  v_mfma_f32_16x16x32_bf16 v[200:203], v[76:79], v[44:47], v[200:203]
  v_mfma_f32_16x16x32_bf16 v[204:207], v[76:79], v[48:51], v[204:207]
  s_waitcnt vmcnt(10) lgkmcnt(0)
  s_barrier
  s_setprio 3
  v_mfma_f32_16x16x32_bf16 v[208:211], v[80:83], v[36:39], v[208:211]
  ds_read_b128 v[52:55], v3 offset:32768
  ds_read_b128 v[56:59], v3 offset:34816
  v_mfma_f32_16x16x32_bf16 v[212:215], v[80:83], v[40:43], v[212:215]
  ds_read_b128 v[60:63], v3 offset:36864
  ds_read_b128 v[64:67], v3 offset:38912
  v_mfma_f32_16x16x32_bf16 v[216:219], v[80:83], v[44:47], v[216:219]
  ds_read_b64_tr_b16 v[76:77], v4 offset:12288
  ds_read_b64_tr_b16 v[78:79], v4 offset:12800
  v_mfma_f32_16x16x32_bf16 v[220:223], v[80:83], v[48:51], v[220:223]
  v_mfma_f32_16x16x32_bf16 v[224:227], v[68:71], v[36:39], v[224:227]
  ds_read_b64_tr_b16 v[80:81], v4 offset:45056
  v_mfma_f32_16x16x32_bf16 v[228:231], v[68:71], v[40:43], v[228:231]
  ds_read_b64_tr_b16 v[82:83], v4 offset:45568
  v_mfma_f32_16x16x32_bf16 v[232:235], v[68:71], v[44:47], v[232:235]
  s_add_u32 m0, s46, 8192
  v_mfma_f32_16x16x32_bf16 v[236:239], v[68:71], v[48:51], v[236:239]
  buffer_load_dwordx4 v10, s[16:19], s43 offen lds
  s_add_u32 s43, s43, 196608
  v_mfma_f32_16x16x32_bf16 v[240:243], v[72:75], v[36:39], v[240:243]
  ds_read_b64_tr_b16 v[68:69], v8 offset:12288
  v_mfma_f32_16x16x32_bf16 v[244:247], v[72:75], v[40:43], v[244:247]
  ds_read_b64_tr_b16 v[70:71], v8 offset:12800
  v_mfma_f32_16x16x32_bf16 v[248:251], v[72:75], v[44:47], v[248:251]
  s_add_u32 m0, s46, 24576
  v_mfma_f32_16x16x32_bf16 v[252:255], v[72:75], v[48:51], v[252:255]
  buffer_load_dwordx4 v11, s[20:23], s44 offen lds
  s_waitcnt lgkmcnt(4)
  s_setprio 2
  v_mfma_f32_16x16x32_bf16 v[96:99], v[76:79], v[52:55], v[96:99]
  ds_read_b64_tr_b16 v[72:73], v9 offset:12288
  v_mfma_f32_16x16x32_bf16 v[100:103], v[76:79], v[56:59], v[100:103]
  ds_read_b64_tr_b16 v[74:75], v9 offset:12800
  v_mfma_f32_16x16x32_bf16 v[104:107], v[76:79], v[60:63], v[104:107]
  s_add_u32 m0, s46, 40960
  v_mfma_f32_16x16x32_bf16 v[108:111], v[76:79], v[64:67], v[108:111]
  buffer_load_dwordx4 v35, s[24:27], s73 offen lds
  s_waitcnt lgkmcnt(4)
  v_smfmac_f32_16x16x64_bf16 v[26:29], v[12:15], v[76:83], v16
  v_mfma_f32_16x16x32_bf16 v[112:115], v[80:83], v[52:55], v[112:115]
  ds_read_b64_tr_b16 v[76:77], v5 offset:12288
  v_mfma_f32_16x16x32_bf16 v[116:119], v[80:83], v[56:59], v[116:119]
  ds_read_b64_tr_b16 v[78:79], v5 offset:12800
  v_mfma_f32_16x16x32_bf16 v[120:123], v[80:83], v[60:63], v[120:123]
  s_add_u32 m0, s46, 57344
  v_mfma_f32_16x16x32_bf16 v[124:127], v[80:83], v[64:67], v[124:127]
  buffer_load_dwordx4 v11, s[28:31], s44 offen lds
  s_add_u32 s44, s44, 229376
  s_waitcnt lgkmcnt(4)
  v_mfma_f32_16x16x32_bf16 v[128:131], v[68:71], v[52:55], v[128:131]
  ds_read_b64_tr_b16 v[80:81], v5 offset:45056
  v_mfma_f32_16x16x32_bf16 v[132:135], v[68:71], v[56:59], v[132:135]
  ds_read_b64_tr_b16 v[82:83], v5 offset:45568
  v_mfma_f32_16x16x32_bf16 v[136:139], v[68:71], v[60:63], v[136:139]
  s_add_u32 m0, s46, 73728
  v_mfma_f32_16x16x32_bf16 v[140:143], v[68:71], v[64:67], v[140:143]
  buffer_load_dwordx4 v35, s[32:35], s73 offen lds
  s_add_u32 s73, s73, s45
  s_waitcnt lgkmcnt(4)
  s_setprio 1
  v_mfma_f32_16x16x32_bf16 v[144:147], v[72:75], v[52:55], v[144:147]
  s_cmp_lg_u32 s48, 3
  s_cbranch_scc1 L_k1sk_29
  v_smfmac_f32_16x16x64_bf16 v[30:33], v[12:15], v[68:75], v16
L_k1sk_29:
  v_mfma_f32_16x16x32_bf16 v[148:151], v[72:75], v[56:59], v[148:151]
  ds_read_b64_tr_b16 v[68:69], v6 offset:12288
  ds_read_b64_tr_b16 v[70:71], v6 offset:12800
  v_mfma_f32_16x16x32_bf16 v[152:155], v[72:75], v[60:63], v[152:155]
  v_mfma_f32_16x16x32_bf16 v[156:159], v[72:75], v[64:67], v[156:159]
  s_waitcnt lgkmcnt(4)
  v_mfma_f32_16x16x32_bf16 v[160:163], v[76:79], v[52:55], v[160:163]
  ds_read_b64_tr_b16 v[72:73], v6 offset:45056
  v_mfma_f32_16x16x32_bf16 v[164:167], v[76:79], v[56:59], v[164:167]
  ds_read_b64_tr_b16 v[74:75], v6 offset:45568
  v_mfma_f32_16x16x32_bf16 v[168:171], v[76:79], v[60:63], v[168:171]
  v_mfma_f32_16x16x32_bf16 v[172:175], v[76:79], v[64:67], v[172:175]
  s_waitcnt lgkmcnt(4)
  s_setprio 0
  v_mfma_f32_16x16x32_bf16 v[176:179], v[80:83], v[52:55], v[176:179]
  ds_read_b64_tr_b16 v[76:77], v7 offset:12288
  v_mfma_f32_16x16x32_bf16 v[180:183], v[80:83], v[56:59], v[180:183]
  ds_read_b64_tr_b16 v[78:79], v7 offset:12800
  v_mfma_f32_16x16x32_bf16 v[184:187], v[80:83], v[60:63], v[184:187]
  v_mfma_f32_16x16x32_bf16 v[188:191], v[80:83], v[64:67], v[188:191]
  s_waitcnt lgkmcnt(4)
  v_mfma_f32_16x16x32_bf16 v[192:195], v[68:71], v[52:55], v[192:195]
  ds_read_b64_tr_b16 v[80:81], v7 offset:45056
  v_mfma_f32_16x16x32_bf16 v[196:199], v[68:71], v[56:59], v[196:199]
  ds_read_b64_tr_b16 v[82:83], v7 offset:45568
  v_mfma_f32_16x16x32_bf16 v[200:203], v[68:71], v[60:63], v[200:203]
  v_mfma_f32_16x16x32_bf16 v[204:207], v[68:71], v[64:67], v[204:207]
  s_waitcnt vmcnt(10) lgkmcnt(0)
  s_barrier
  s_setprio 3
  v_mfma_f32_16x16x32_bf16 v[208:211], v[72:75], v[52:55], v[208:211]
  ds_read_b128 v[36:39], v2 offset:0
  ds_read_b128 v[40:43], v2 offset:2048
  v_mfma_f32_16x16x32_bf16 v[212:215], v[72:75], v[56:59], v[212:215]
  ds_read_b128 v[44:47], v2 offset:4096
  ds_read_b128 v[48:51], v2 offset:6144
  v_mfma_f32_16x16x32_bf16 v[216:219], v[72:75], v[60:63], v[216:219]
  ds_read_b64_tr_b16 v[68:69], v4 offset:0
  ds_read_b64_tr_b16 v[70:71], v4 offset:512
  v_mfma_f32_16x16x32_bf16 v[220:223], v[72:75], v[64:67], v[220:223]
  v_mfma_f32_16x16x32_bf16 v[224:227], v[76:79], v[52:55], v[224:227]
  ds_read_b64_tr_b16 v[72:73], v4 offset:32768
  v_mfma_f32_16x16x32_bf16 v[228:231], v[76:79], v[56:59], v[228:231]
  ds_read_b64_tr_b16 v[74:75], v4 offset:33280
  v_mfma_f32_16x16x32_bf16 v[232:235], v[76:79], v[60:63], v[232:235]
  s_add_u32 m0, s46, 12288
  v_mfma_f32_16x16x32_bf16 v[236:239], v[76:79], v[64:67], v[236:239]
  buffer_load_dwordx4 v10, s[16:19], s43 offen lds
  s_add_u32 s43, s43, 196608
  v_mfma_f32_16x16x32_bf16 v[240:243], v[80:83], v[52:55], v[240:243]
  ds_read_b64_tr_b16 v[76:77], v8 offset:0
  v_mfma_f32_16x16x32_bf16 v[244:247], v[80:83], v[56:59], v[244:247]
  ds_read_b64_tr_b16 v[78:79], v8 offset:512
  v_mfma_f32_16x16x32_bf16 v[248:251], v[80:83], v[60:63], v[248:251]
  s_add_u32 m0, s46, 28672
  v_mfma_f32_16x16x32_bf16 v[252:255], v[80:83], v[64:67], v[252:255]
  buffer_load_dwordx4 v11, s[20:23], s44 offen lds
  s_sub_u32 s47, s47, 1
  s_cmp_lg_u32 s47, s66
  s_cbranch_scc1 L_k1loop_23
  s_cmp_eq_u32 s47, 0
  s_cbranch_scc1 L_k1tail_24
  s_cmp_eq_u32 s47, 1
  s_cbranch_scc1 L_k1poll_25
  s_mov_b32 s66, 1
  s_branch L_k1loop_23
L_k1poll_25:
  s_mov_b32 s66, 0
  buffer_load_dword v1, off, s[68:71], s72 sc1
  s_branch L_k1loop_23
L_k1tail_24:
  v_readfirstlane_b32 s61, v1
  s_lshl_b32 s3, s2, 3
  s_add_u32 s3, s3, s40
  s_lshl_b32 s3, s3, 9
  s_add_u32 s3, s3, 1048576
  s_cmp_eq_u32 s61, 32
  s_cselect_b32 s67, s67, s3
  buffer_load_dwordx2 v[18:19], v34, s[36:39], s67 offen offset:0 sc1
  buffer_load_dwordx2 v[20:21], v34, s[36:39], s67 offen offset:128 sc1
  buffer_load_dwordx2 v[22:23], v34, s[36:39], s67 offen offset:256 sc1
  buffer_load_dwordx2 v[24:25], v34, s[36:39], s67 offen offset:384 sc1
  s_waitcnt lgkmcnt(4)
  s_setprio 2
  v_mfma_f32_16x16x32_bf16 v[96:99], v[68:71], v[36:39], v[96:99]
  ds_read_b64_tr_b16 v[80:81], v9 offset:0
  v_mfma_f32_16x16x32_bf16 v[100:103], v[68:71], v[40:43], v[100:103]
  ds_read_b64_tr_b16 v[82:83], v9 offset:512
  v_mfma_f32_16x16x32_bf16 v[104:107], v[68:71], v[44:47], v[104:107]
  s_add_u32 m0, s46, 45056
  v_mfma_f32_16x16x32_bf16 v[108:111], v[68:71], v[48:51], v[108:111]
  buffer_load_dwordx4 v35, s[24:27], s73 offen lds
  s_waitcnt lgkmcnt(4)
  v_smfmac_f32_16x16x64_bf16 v[26:29], v[12:15], v[68:75], v16
  v_mfma_f32_16x16x32_bf16 v[112:115], v[72:75], v[36:39], v[112:115]
  ds_read_b64_tr_b16 v[68:69], v5 offset:0
  v_mfma_f32_16x16x32_bf16 v[116:119], v[72:75], v[40:43], v[116:119]
  ds_read_b64_tr_b16 v[70:71], v5 offset:512
  v_mfma_f32_16x16x32_bf16 v[120:123], v[72:75], v[44:47], v[120:123]
  s_add_u32 m0, s46, 61440
  v_mfma_f32_16x16x32_bf16 v[124:127], v[72:75], v[48:51], v[124:127]
  buffer_load_dwordx4 v11, s[28:31], s44 offen lds
  s_add_u32 s44, s44, 229376
  s_waitcnt lgkmcnt(4)
  v_mfma_f32_16x16x32_bf16 v[128:131], v[76:79], v[36:39], v[128:131]
  ds_read_b64_tr_b16 v[72:73], v5 offset:32768
  v_mfma_f32_16x16x32_bf16 v[132:135], v[76:79], v[40:43], v[132:135]
  ds_read_b64_tr_b16 v[74:75], v5 offset:33280
  v_mfma_f32_16x16x32_bf16 v[136:139], v[76:79], v[44:47], v[136:139]
  s_add_u32 m0, s46, 77824
  v_mfma_f32_16x16x32_bf16 v[140:143], v[76:79], v[48:51], v[140:143]
  buffer_load_dwordx4 v35, s[32:35], s73 offen lds
  s_add_u32 s73, s73, s45
  s_waitcnt lgkmcnt(4)
  s_setprio 1
  v_mfma_f32_16x16x32_bf16 v[144:147], v[80:83], v[36:39], v[144:147]
  s_cmp_lg_u32 s48, 0
  s_cbranch_scc1 L_k1sk_30
  v_smfmac_f32_16x16x64_bf16 v[30:33], v[12:15], v[76:83], v16
L_k1sk_30:
  v_mfma_f32_16x16x32_bf16 v[148:151], v[80:83], v[40:43], v[148:151]
  ds_read_b64_tr_b16 v[76:77], v6 offset:0
  ds_read_b64_tr_b16 v[78:79], v6 offset:512
  v_mfma_f32_16x16x32_bf16 v[152:155], v[80:83], v[44:47], v[152:155]
  v_mfma_f32_16x16x32_bf16 v[156:159], v[80:83], v[48:51], v[156:159]
  s_waitcnt lgkmcnt(4)
  v_mfma_f32_16x16x32_bf16 v[160:163], v[68:71], v[36:39], v[160:163]
  ds_read_b64_tr_b16 v[80:81], v6 offset:32768
  v_mfma_f32_16x16x32_bf16 v[164:167], v[68:71], v[40:43], v[164:167]
  ds_read_b64_tr_b16 v[82:83], v6 offset:33280
  v_mfma_f32_16x16x32_bf16 v[168:171], v[68:71], v[44:47], v[168:171]
  v_mfma_f32_16x16x32_bf16 v[172:175], v[68:71], v[48:51], v[172:175]
  s_waitcnt lgkmcnt(4)
  s_setprio 0
  v_mfma_f32_16x16x32_bf16 v[176:179], v[72:75], v[36:39], v[176:179]
  ds_read_b64_tr_b16 v[68:69], v7 offset:0
  v_mfma_f32_16x16x32_bf16 v[180:183], v[72:75], v[40:43], v[180:183]
  ds_read_b64_tr_b16 v[70:71], v7 offset:512
  v_mfma_f32_16x16x32_bf16 v[184:187], v[72:75], v[44:47], v[184:187]
  v_mfma_f32_16x16x32_bf16 v[188:191], v[72:75], v[48:51], v[188:191]
  s_waitcnt lgkmcnt(4)
  v_mfma_f32_16x16x32_bf16 v[192:195], v[76:79], v[36:39], v[192:195]
  ds_read_b64_tr_b16 v[72:73], v7 offset:32768
  v_mfma_f32_16x16x32_bf16 v[196:199], v[76:79], v[40:43], v[196:199]
  ds_read_b64_tr_b16 v[74:75], v7 offset:33280
  v_mfma_f32_16x16x32_bf16 v[200:203], v[76:79], v[44:47], v[200:203]
  v_mfma_f32_16x16x32_bf16 v[204:207], v[76:79], v[48:51], v[204:207]
  s_waitcnt vmcnt(14) lgkmcnt(0)
  s_barrier
  s_setprio 3
  v_mfma_f32_16x16x32_bf16 v[208:211], v[80:83], v[36:39], v[208:211]
  ds_read_b128 v[52:55], v3 offset:0
  ds_read_b128 v[56:59], v3 offset:2048
  v_mfma_f32_16x16x32_bf16 v[212:215], v[80:83], v[40:43], v[212:215]
  ds_read_b128 v[60:63], v3 offset:4096
  ds_read_b128 v[64:67], v3 offset:6144
  v_mfma_f32_16x16x32_bf16 v[216:219], v[80:83], v[44:47], v[216:219]
  ds_read_b64_tr_b16 v[76:77], v4 offset:4096
  ds_read_b64_tr_b16 v[78:79], v4 offset:4608
  v_mfma_f32_16x16x32_bf16 v[220:223], v[80:83], v[48:51], v[220:223]
  v_mfma_f32_16x16x32_bf16 v[224:227], v[68:71], v[36:39], v[224:227]
  ds_read_b64_tr_b16 v[80:81], v4 offset:36864
  v_mfma_f32_16x16x32_bf16 v[228:231], v[68:71], v[40:43], v[228:231]
  ds_read_b64_tr_b16 v[82:83], v4 offset:37376
  v_mfma_f32_16x16x32_bf16 v[232:235], v[68:71], v[44:47], v[232:235]
  v_mfma_f32_16x16x32_bf16 v[236:239], v[68:71], v[48:51], v[236:239]
  v_mfma_f32_16x16x32_bf16 v[240:243], v[72:75], v[36:39], v[240:243]
  ds_read_b64_tr_b16 v[68:69], v8 offset:4096
  v_mfma_f32_16x16x32_bf16 v[244:247], v[72:75], v[40:43], v[244:247]
  ds_read_b64_tr_b16 v[70:71], v8 offset:4608
  v_mfma_f32_16x16x32_bf16 v[248:251], v[72:75], v[44:47], v[248:251]
  v_mfma_f32_16x16x32_bf16 v[252:255], v[72:75], v[48:51], v[252:255]
  s_waitcnt lgkmcnt(4)
  s_setprio 2
  v_mfma_f32_16x16x32_bf16 v[96:99], v[76:79], v[52:55], v[96:99]
  ds_read_b64_tr_b16 v[72:73], v9 offset:4096
  v_mfma_f32_16x16x32_bf16 v[100:103], v[76:79], v[56:59], v[100:103]
  ds_read_b64_tr_b16 v[74:75], v9 offset:4608
  v_mfma_f32_16x16x32_bf16 v[104:107], v[76:79], v[60:63], v[104:107]
  v_mfma_f32_16x16x32_bf16 v[108:111], v[76:79], v[64:67], v[108:111]
  s_waitcnt lgkmcnt(4)
  v_smfmac_f32_16x16x64_bf16 v[26:29], v[12:15], v[76:83], v16
  v_mfma_f32_16x16x32_bf16 v[112:115], v[80:83], v[52:55], v[112:115]
  ds_read_b64_tr_b16 v[76:77], v5 offset:4096
  v_mfma_f32_16x16x32_bf16 v[116:119], v[80:83], v[56:59], v[116:119]
  ds_read_b64_tr_b16 v[78:79], v5 offset:4608
  v_mfma_f32_16x16x32_bf16 v[120:123], v[80:83], v[60:63], v[120:123]
  v_mfma_f32_16x16x32_bf16 v[124:127], v[80:83], v[64:67], v[124:127]
  s_waitcnt lgkmcnt(4)
  v_mfma_f32_16x16x32_bf16 v[128:131], v[68:71], v[52:55], v[128:131]
  ds_read_b64_tr_b16 v[80:81], v5 offset:36864
  v_mfma_f32_16x16x32_bf16 v[132:135], v[68:71], v[56:59], v[132:135]
  ds_read_b64_tr_b16 v[82:83], v5 offset:37376
  v_mfma_f32_16x16x32_bf16 v[136:139], v[68:71], v[60:63], v[136:139]
  v_mfma_f32_16x16x32_bf16 v[140:143], v[68:71], v[64:67], v[140:143]
  s_waitcnt lgkmcnt(4)
  s_setprio 1
  v_mfma_f32_16x16x32_bf16 v[144:147], v[72:75], v[52:55], v[144:147]
  s_cmp_lg_u32 s48, 1
  s_cbranch_scc1 L_k1sk_31
  v_smfmac_f32_16x16x64_bf16 v[30:33], v[12:15], v[68:75], v16
L_k1sk_31:
  v_mfma_f32_16x16x32_bf16 v[148:151], v[72:75], v[56:59], v[148:151]
  ds_read_b64_tr_b16 v[68:69], v6 offset:4096
  ds_read_b64_tr_b16 v[70:71], v6 offset:4608
  v_mfma_f32_16x16x32_bf16 v[152:155], v[72:75], v[60:63], v[152:155]
  v_mfma_f32_16x16x32_bf16 v[156:159], v[72:75], v[64:67], v[156:159]
  s_waitcnt lgkmcnt(4)
  v_mfma_f32_16x16x32_bf16 v[160:163], v[76:79], v[52:55], v[160:163]
  ds_read_b64_tr_b16 v[72:73], v6 offset:36864
  v_mfma_f32_16x16x32_bf16 v[164:167], v[76:79], v[56:59], v[164:167]
  ds_read_b64_tr_b16 v[74:75], v6 offset:37376
  v_mfma_f32_16x16x32_bf16 v[168:171], v[76:79], v[60:63], v[168:171]
  v_mfma_f32_16x16x32_bf16 v[172:175], v[76:79], v[64:67], v[172:175]
  s_waitcnt lgkmcnt(4)
  s_setprio 0
  v_mfma_f32_16x16x32_bf16 v[176:179], v[80:83], v[52:55], v[176:179]
  ds_read_b64_tr_b16 v[76:77], v7 offset:4096
  v_mfma_f32_16x16x32_bf16 v[180:183], v[80:83], v[56:59], v[180:183]
  ds_read_b64_tr_b16 v[78:79], v7 offset:4608
  v_mfma_f32_16x16x32_bf16 v[184:187], v[80:83], v[60:63], v[184:187]
  v_mfma_f32_16x16x32_bf16 v[188:191], v[80:83], v[64:67], v[188:191]
  s_waitcnt lgkmcnt(4)
  v_mfma_f32_16x16x32_bf16 v[192:195], v[68:71], v[52:55], v[192:195]
  ds_read_b64_tr_b16 v[80:81], v7 offset:36864
  v_mfma_f32_16x16x32_bf16 v[196:199], v[68:71], v[56:59], v[196:199]
  ds_read_b64_tr_b16 v[82:83], v7 offset:37376
  v_mfma_f32_16x16x32_bf16 v[200:203], v[68:71], v[60:63], v[200:203]
  v_mfma_f32_16x16x32_bf16 v[204:207], v[68:71], v[64:67], v[204:207]
  s_waitcnt vmcnt(0) lgkmcnt(0)
  s_barrier
  s_setprio 3
  v_mfma_f32_16x16x32_bf16 v[208:211], v[72:75], v[52:55], v[208:211]
  ds_read_b128 v[36:39], v2 offset:32768
  ds_read_b128 v[40:43], v2 offset:34816
  v_mfma_f32_16x16x32_bf16 v[212:215], v[72:75], v[56:59], v[212:215]
  ds_read_b128 v[44:47], v2 offset:36864
  ds_read_b128 v[48:51], v2 offset:38912
  v_mfma_f32_16x16x32_bf16 v[216:219], v[72:75], v[60:63], v[216:219]
  ds_read_b64_tr_b16 v[68:69], v4 offset:8192
  ds_read_b64_tr_b16 v[70:71], v4 offset:8704
  v_mfma_f32_16x16x32_bf16 v[220:223], v[72:75], v[64:67], v[220:223]
  v_mfma_f32_16x16x32_bf16 v[224:227], v[76:79], v[52:55], v[224:227]
  ds_read_b64_tr_b16 v[72:73], v4 offset:40960
  v_mfma_f32_16x16x32_bf16 v[228:231], v[76:79], v[56:59], v[228:231]
  ds_read_b64_tr_b16 v[74:75], v4 offset:41472
  v_mfma_f32_16x16x32_bf16 v[232:235], v[76:79], v[60:63], v[232:235]
  v_mfma_f32_16x16x32_bf16 v[236:239], v[76:79], v[64:67], v[236:239]
  v_mfma_f32_16x16x32_bf16 v[240:243], v[80:83], v[52:55], v[240:243]
  ds_read_b64_tr_b16 v[76:77], v8 offset:8192
  v_mfma_f32_16x16x32_bf16 v[244:247], v[80:83], v[56:59], v[244:247]
  ds_read_b64_tr_b16 v[78:79], v8 offset:8704
  v_mfma_f32_16x16x32_bf16 v[248:251], v[80:83], v[60:63], v[248:251]
  v_mfma_f32_16x16x32_bf16 v[252:255], v[80:83], v[64:67], v[252:255]
  s_waitcnt lgkmcnt(4)
  v_mfma_f32_16x16x32_bf16 v[96:99], v[68:71], v[36:39], v[96:99]
  ds_read_b64_tr_b16 v[80:81], v9 offset:8192
  v_mfma_f32_16x16x32_bf16 v[100:103], v[68:71], v[40:43], v[100:103]
  ds_read_b64_tr_b16 v[82:83], v9 offset:8704
  v_mfma_f32_16x16x32_bf16 v[104:107], v[68:71], v[44:47], v[104:107]
  v_mfma_f32_16x16x32_bf16 v[108:111], v[68:71], v[48:51], v[108:111]
  s_waitcnt lgkmcnt(4)
  v_smfmac_f32_16x16x64_bf16 v[26:29], v[12:15], v[68:75], v16
  v_mfma_f32_16x16x32_bf16 v[112:115], v[72:75], v[36:39], v[112:115]
  ds_read_b64_tr_b16 v[68:69], v5 offset:8192
  v_mfma_f32_16x16x32_bf16 v[116:119], v[72:75], v[40:43], v[116:119]
  ds_read_b64_tr_b16 v[70:71], v5 offset:8704
  v_mfma_f32_16x16x32_bf16 v[120:123], v[72:75], v[44:47], v[120:123]
  v_mfma_f32_16x16x32_bf16 v[124:127], v[72:75], v[48:51], v[124:127]
  s_waitcnt lgkmcnt(4)
  v_mfma_f32_16x16x32_bf16 v[128:131], v[76:79], v[36:39], v[128:131]
  ds_read_b64_tr_b16 v[72:73], v5 offset:40960
  v_mfma_f32_16x16x32_bf16 v[132:135], v[76:79], v[40:43], v[132:135]
  ds_read_b64_tr_b16 v[74:75], v5 offset:41472
  v_mfma_f32_16x16x32_bf16 v[136:139], v[76:79], v[44:47], v[136:139]
  v_mfma_f32_16x16x32_bf16 v[140:143], v[76:79], v[48:51], v[140:143]
  s_waitcnt lgkmcnt(4)
  v_mfma_f32_16x16x32_bf16 v[144:147], v[80:83], v[36:39], v[144:147]
  s_cmp_lg_u32 s48, 2
  s_cbranch_scc1 L_k1sk_32
  v_smfmac_f32_16x16x64_bf16 v[30:33], v[12:15], v[76:83], v16
L_k1sk_32:
  v_mfma_f32_16x16x32_bf16 v[148:151], v[80:83], v[40:43], v[148:151]
  ds_read_b64_tr_b16 v[76:77], v6 offset:8192
  ds_read_b64_tr_b16 v[78:79], v6 offset:8704
  v_mfma_f32_16x16x32_bf16 v[152:155], v[80:83], v[44:47], v[152:155]
  v_mfma_f32_16x16x32_bf16 v[156:159], v[80:83], v[48:51], v[156:159]
  s_waitcnt lgkmcnt(4)
  v_mfma_f32_16x16x32_bf16 v[160:163], v[68:71], v[36:39], v[160:163]
  ds_read_b64_tr_b16 v[80:81], v6 offset:40960
  v_mfma_f32_16x16x32_bf16 v[164:167], v[68:71], v[40:43], v[164:167]
  ds_read_b64_tr_b16 v[82:83], v6 offset:41472
  v_mfma_f32_16x16x32_bf16 v[168:171], v[68:71], v[44:47], v[168:171]
  v_mfma_f32_16x16x32_bf16 v[172:175], v[68:71], v[48:51], v[172:175]
  s_waitcnt lgkmcnt(4)
  v_mfma_f32_16x16x32_bf16 v[176:179], v[72:75], v[36:39], v[176:179]
  ds_read_b64_tr_b16 v[68:69], v7 offset:8192
  v_mfma_f32_16x16x32_bf16 v[180:183], v[72:75], v[40:43], v[180:183]
  ds_read_b64_tr_b16 v[70:71], v7 offset:8704
  v_mfma_f32_16x16x32_bf16 v[184:187], v[72:75], v[44:47], v[184:187]
  v_mfma_f32_16x16x32_bf16 v[188:191], v[72:75], v[48:51], v[188:191]
  s_waitcnt lgkmcnt(4)
  v_mfma_f32_16x16x32_bf16 v[192:195], v[76:79], v[36:39], v[192:195]
  ds_read_b64_tr_b16 v[72:73], v7 offset:40960
  v_mfma_f32_16x16x32_bf16 v[196:199], v[76:79], v[40:43], v[196:199]
  ds_read_b64_tr_b16 v[74:75], v7 offset:41472
  v_mfma_f32_16x16x32_bf16 v[200:203], v[76:79], v[44:47], v[200:203]
  v_mfma_f32_16x16x32_bf16 v[204:207], v[76:79], v[48:51], v[204:207]
  s_waitcnt lgkmcnt(4)
  v_mfma_f32_16x16x32_bf16 v[208:211], v[80:83], v[36:39], v[208:211]
  ds_read_b128 v[52:55], v3 offset:32768
  ds_read_b128 v[56:59], v3 offset:34816
  v_mfma_f32_16x16x32_bf16 v[212:215], v[80:83], v[40:43], v[212:215]
  ds_read_b128 v[60:63], v3 offset:36864
  ds_read_b128 v[64:67], v3 offset:38912
  v_mfma_f32_16x16x32_bf16 v[216:219], v[80:83], v[44:47], v[216:219]
  ds_read_b64_tr_b16 v[76:77], v4 offset:12288
  ds_read_b64_tr_b16 v[78:79], v4 offset:12800
  v_mfma_f32_16x16x32_bf16 v[220:223], v[80:83], v[48:51], v[220:223]
  s_waitcnt lgkmcnt(8)
  v_mfma_f32_16x16x32_bf16 v[224:227], v[68:71], v[36:39], v[224:227]
  ds_read_b64_tr_b16 v[80:81], v4 offset:45056
  v_mfma_f32_16x16x32_bf16 v[228:231], v[68:71], v[40:43], v[228:231]
  ds_read_b64_tr_b16 v[82:83], v4 offset:45568
  v_mfma_f32_16x16x32_bf16 v[232:235], v[68:71], v[44:47], v[232:235]
  v_mfma_f32_16x16x32_bf16 v[236:239], v[68:71], v[48:51], v[236:239]
  s_waitcnt lgkmcnt(8)
  v_mfma_f32_16x16x32_bf16 v[240:243], v[72:75], v[36:39], v[240:243]
  ds_read_b64_tr_b16 v[68:69], v8 offset:12288
  v_mfma_f32_16x16x32_bf16 v[244:247], v[72:75], v[40:43], v[244:247]
  ds_read_b64_tr_b16 v[70:71], v8 offset:12800
  v_mfma_f32_16x16x32_bf16 v[248:251], v[72:75], v[44:47], v[248:251]
  v_mfma_f32_16x16x32_bf16 v[252:255], v[72:75], v[48:51], v[252:255]
  s_waitcnt lgkmcnt(4)
  v_mfma_f32_16x16x32_bf16 v[96:99], v[76:79], v[52:55], v[96:99]
  ds_read_b64_tr_b16 v[72:73], v9 offset:12288
  v_mfma_f32_16x16x32_bf16 v[100:103], v[76:79], v[56:59], v[100:103]
  ds_read_b64_tr_b16 v[74:75], v9 offset:12800
  v_mfma_f32_16x16x32_bf16 v[104:107], v[76:79], v[60:63], v[104:107]
  v_mfma_f32_16x16x32_bf16 v[108:111], v[76:79], v[64:67], v[108:111]
  s_waitcnt lgkmcnt(4)
  v_smfmac_f32_16x16x64_bf16 v[26:29], v[12:15], v[76:83], v16
  v_mfma_f32_16x16x32_bf16 v[112:115], v[80:83], v[52:55], v[112:115]
  ds_read_b64_tr_b16 v[76:77], v5 offset:12288
  v_mfma_f32_16x16x32_bf16 v[116:119], v[80:83], v[56:59], v[116:119]
  ds_read_b64_tr_b16 v[78:79], v5 offset:12800
  v_mfma_f32_16x16x32_bf16 v[120:123], v[80:83], v[60:63], v[120:123]
  v_mfma_f32_16x16x32_bf16 v[124:127], v[80:83], v[64:67], v[124:127]
  s_waitcnt lgkmcnt(4)
  v_mfma_f32_16x16x32_bf16 v[128:131], v[68:71], v[52:55], v[128:131]
  ds_read_b64_tr_b16 v[80:81], v5 offset:45056
  v_mfma_f32_16x16x32_bf16 v[132:135], v[68:71], v[56:59], v[132:135]
  ds_read_b64_tr_b16 v[82:83], v5 offset:45568
  v_mfma_f32_16x16x32_bf16 v[136:139], v[68:71], v[60:63], v[136:139]
  v_mfma_f32_16x16x32_bf16 v[140:143], v[68:71], v[64:67], v[140:143]
  s_waitcnt lgkmcnt(4)
  v_mfma_f32_16x16x32_bf16 v[144:147], v[72:75], v[52:55], v[144:147]
  s_cmp_lg_u32 s48, 3
  s_cbranch_scc1 L_k1sk_33
  v_smfmac_f32_16x16x64_bf16 v[30:33], v[12:15], v[68:75], v16
L_k1sk_33:
  v_mfma_f32_16x16x32_bf16 v[148:151], v[72:75], v[56:59], v[148:151]
  ds_read_b64_tr_b16 v[68:69], v6 offset:12288
  ds_read_b64_tr_b16 v[70:71], v6 offset:12800
  v_mfma_f32_16x16x32_bf16 v[152:155], v[72:75], v[60:63], v[152:155]
  v_mfma_f32_16x16x32_bf16 v[156:159], v[72:75], v[64:67], v[156:159]
  s_waitcnt lgkmcnt(4)
  v_mfma_f32_16x16x32_bf16 v[160:163], v[76:79], v[52:55], v[160:163]
  ds_read_b64_tr_b16 v[72:73], v6 offset:45056
  v_and_b32 v10, 15, v0
  s_lshl_b32 s3, s49, 10
  s_lshl_b32 s50, s48, 6
  v_mfma_f32_16x16x32_bf16 v[164:167], v[76:79], v[56:59], v[164:167]
  ds_read_b64_tr_b16 v[74:75], v6 offset:45568
  v_lshlrev_b32 v10, 2, v10
  s_add_u32 s3, s3, s50
  s_add_u32 s3, s3, 147456
  v_mfma_f32_16x16x32_bf16 v[168:171], v[76:79], v[60:63], v[168:171]
  v_add_u32 v10, s3, v10
  s_add_u32 s50, s50, 512
  v_mfma_f32_16x16x32_bf16 v[172:175], v[76:79], v[64:67], v[172:175]
  v_add_u32 v11, s50, v10
  s_lshl_b32 s3, s40, 2
  s_add_u32 s3, s3, 149504
  v_mov_b32 v35, s3
  s_waitcnt lgkmcnt(4)
  v_mfma_f32_16x16x32_bf16 v[176:179], v[80:83], v[52:55], v[176:179]
  ds_read_b64_tr_b16 v[76:77], v7 offset:12288
  v_add_f32 v26, v26, v27
  v_add_f32 v28, v28, v29
  v_add_f32 v30, v30, v31
  v_add_f32 v32, v32, v33
  v_mfma_f32_16x16x32_bf16 v[180:183], v[80:83], v[56:59], v[180:183]
  ds_read_b64_tr_b16 v[78:79], v7 offset:12800
  v_mfma_f32_16x16x32_bf16 v[184:187], v[80:83], v[60:63], v[184:187]
  ds_write_b32 v10, v26
  ds_write_b32 v10, v28 offset:256
  v_mfma_f32_16x16x32_bf16 v[188:191], v[80:83], v[64:67], v[188:191]
  ds_write_b32 v11, v30
  ds_write_b32 v11, v32 offset:64
  s_waitcnt lgkmcnt(8)
  v_mfma_f32_16x16x32_bf16 v[192:195], v[68:71], v[52:55], v[192:195]
  ds_read_b64_tr_b16 v[80:81], v7 offset:45056
  v_mfma_f32_16x16x32_bf16 v[196:199], v[68:71], v[56:59], v[196:199]
  ds_read_b64_tr_b16 v[82:83], v7 offset:45568
  v_mfma_f32_16x16x32_bf16 v[200:203], v[68:71], v[60:63], v[200:203]
  v_mfma_f32_16x16x32_bf16 v[204:207], v[68:71], v[64:67], v[204:207]
  s_waitcnt lgkmcnt(8)
  v_mfma_f32_16x16x32_bf16 v[208:211], v[72:75], v[52:55], v[208:211]
  v_mfma_f32_16x16x32_bf16 v[212:215], v[72:75], v[56:59], v[212:215]
  ds_write_b32 v35, v17
  v_mfma_f32_16x16x32_bf16 v[216:219], v[72:75], v[60:63], v[216:219]
  v_mfma_f32_16x16x32_bf16 v[220:223], v[72:75], v[64:67], v[220:223]
  s_waitcnt lgkmcnt(7)
  v_mfma_f32_16x16x32_bf16 v[224:227], v[76:79], v[52:55], v[224:227]
  v_mfma_f32_16x16x32_bf16 v[228:231], v[76:79], v[56:59], v[228:231]
  v_mfma_f32_16x16x32_bf16 v[232:235], v[76:79], v[60:63], v[232:235]
  v_mfma_f32_16x16x32_bf16 v[236:239], v[76:79], v[64:67], v[236:239]
  s_waitcnt lgkmcnt(1)
  v_mfma_f32_16x16x32_bf16 v[240:243], v[80:83], v[52:55], v[240:243]
  v_mfma_f32_16x16x32_bf16 v[244:247], v[80:83], v[56:59], v[244:247]
  v_mfma_f32_16x16x32_bf16 v[248:251], v[80:83], v[60:63], v[248:251]
  v_mfma_f32_16x16x32_bf16 v[252:255], v[80:83], v[64:67], v[252:255]
  s_branch L_k1_epi
L_k1_r1s:
  s_add_u32 m0, s46, 0
  s_nop 0
  buffer_load_dwordx4 v10, s[16:19], s43 offen lds
  s_add_u32 s43, s43, 196608
  s_add_u32 m0, s46, 16384
  s_nop 0
  buffer_load_dwordx4 v11, s[20:23], s44 offen lds
  s_add_u32 m0, s46, 32768
  s_nop 0
  buffer_load_dwordx4 v35, s[24:27], s73 offen lds
  s_add_u32 m0, s46, 49152
  s_nop 0
  buffer_load_dwordx4 v11, s[28:31], s44 offen lds
  s_add_u32 s44, s44, 229376
  s_add_u32 m0, s46, 65536
  s_nop 0
  buffer_load_dwordx4 v35, s[32:35], s73 offen lds
  s_add_u32 s73, s73, s45
  s_add_u32 m0, s46, 4096
  s_nop 0
  buffer_load_dwordx4 v10, s[16:19], s43 offen lds
  s_add_u32 s43, s43, 196608
  s_add_u32 m0, s46, 20480
  s_nop 0
  buffer_load_dwordx4 v11, s[20:23], s44 offen lds
  s_add_u32 m0, s46, 36864
  s_nop 0
  buffer_load_dwordx4 v35, s[24:27], s73 offen lds
  s_add_u32 m0, s46, 53248
  s_nop 0
  buffer_load_dwordx4 v11, s[28:31], s44 offen lds
  s_add_u32 s44, s44, 229376
  s_add_u32 m0, s46, 69632
  s_nop 0
  buffer_load_dwordx4 v35, s[32:35], s73 offen lds
  s_add_u32 s73, s73, s45
  v_lshrrev_b32 v13, 4, v1
  v_and_b32 v34, 15, v1
  v_lshrrev_b32 v2, 1, v34
  v_xor_b32 v2, v2, v13
  v_lshlrev_b32 v2, 4, v2
  v_lshl_add_u32 v2, v34, 7, v2
  s_lshl_b32 s3, s48, 13
  s_add_u32 s3, s3, 81920
  v_add_u32 v2, s3, v2
  v_xor_b32 v3, 64, v2
  v_lshrrev_b32 v14, 2, v34
  v_lshl_add_u32 v15, v13, 3, v14
  v_lshlrev_b32 v15, 7, v15
  v_lshrrev_b32 v14, 1, v14
  v_lshl_add_u32 v15, v14, 5, v15
  v_and_b32 v14, 1, v13
  v_lshl_add_u32 v15, v14, 6, v15
  v_and_b32 v14, 3, v1
  v_lshl_add_u32 v15, v14, 3, v15
  s_lshl_b32 s3, s49, 6
  v_xor_b32 v8, s3, v15
  v_xor_b32 v9, 32, v8
  s_lshl_b32 s3, s48, 5
  v_xor_b32 v4, s3, v15
  s_add_u32 s3, s49, 1
  s_lshl_b32 s3, s3, 14
  v_add_u32 v4, s3, v4
  v_xor_b32 v5, 32, v4
  v_xor_b32 v6, 64, v4
  v_xor_b32 v7, 96, v4
  v_bfe_u32 v14, v1, 1, 1
  v_lshrrev_b32 v15, 5, v1
  v_cmp_eq_u32 vcc, v14, v15
  v_mov_b32 v14, 0x3f803f80
  s_nop 0
  v_cndmask_b32 v12, 0, v14, vcc
  v_and_b32 v14, 1, v1
  v_cmp_eq_u32 vcc, 0, v14
  v_mov_b32 v14, 0x44444444
  v_mov_b32 v15, 0xeeeeeeee
  v_cndmask_b32 v16, v15, v14, vcc
  v_mov_b32 v13, v12
  v_mov_b32 v14, v12
  v_mov_b32 v15, v12
  v_mov_b32 v17, 1
  v_lshlrev_b32 v34, 3, v34
  s_lshl_b32 s67, s41, 2
  s_add_u32 s67, s67, s48
  s_lshl_b32 s67, s67, 9
  v_mov_b32 v96, 0
  v_mov_b32 v97, 0
  v_mov_b32 v98, 0
  v_mov_b32 v99, 0
  v_mov_b32 v100, 0
  v_mov_b32 v101, 0
  v_mov_b32 v102, 0
  v_mov_b32 v103, 0
  v_mov_b32 v104, 0
  v_mov_b32 v105, 0
  v_mov_b32 v106, 0
  v_mov_b32 v107, 0
  v_mov_b32 v108, 0
  v_mov_b32 v109, 0
  v_mov_b32 v110, 0
  v_mov_b32 v111, 0
  v_mov_b32 v112, 0
  v_mov_b32 v113, 0
  v_mov_b32 v114, 0
  v_mov_b32 v115, 0
  v_mov_b32 v116, 0
  v_mov_b32 v117, 0
  v_mov_b32 v118, 0
  v_mov_b32 v119, 0
  v_mov_b32 v120, 0
  v_mov_b32 v121, 0
  v_mov_b32 v122, 0
  v_mov_b32 v123, 0
  v_mov_b32 v124, 0
  v_mov_b32 v125, 0
  v_mov_b32 v126, 0
  v_mov_b32 v127, 0
  v_mov_b32 v128, 0
  v_mov_b32 v129, 0
  v_mov_b32 v130, 0
  v_mov_b32 v131, 0
  v_mov_b32 v132, 0
  v_mov_b32 v133, 0
  v_mov_b32 v134, 0
  v_mov_b32 v135, 0
  v_mov_b32 v136, 0
  v_mov_b32 v137, 0
  v_mov_b32 v138, 0
  v_mov_b32 v139, 0
  v_mov_b32 v140, 0
  v_mov_b32 v141, 0
  v_mov_b32 v142, 0
  v_mov_b32 v143, 0
  v_mov_b32 v144, 0
  v_mov_b32 v145, 0
  v_mov_b32 v146, 0
  v_mov_b32 v147, 0
  v_mov_b32 v148, 0
  v_mov_b32 v149, 0
  v_mov_b32 v150, 0
  v_mov_b32 v151, 0
  v_mov_b32 v152, 0
  v_mov_b32 v153, 0
  v_mov_b32 v154, 0
  v_mov_b32 v155, 0
  v_mov_b32 v156, 0
  v_mov_b32 v157, 0
  v_mov_b32 v158, 0
  v_mov_b32 v159, 0
  v_mov_b32 v160, 0
  v_mov_b32 v161, 0
  v_mov_b32 v162, 0
  v_mov_b32 v163, 0
  v_mov_b32 v164, 0
  v_mov_b32 v165, 0
  v_mov_b32 v166, 0
  v_mov_b32 v167, 0
  v_mov_b32 v168, 0
  v_mov_b32 v169, 0
  v_mov_b32 v170, 0
  v_mov_b32 v171, 0
  v_mov_b32 v172, 0
  v_mov_b32 v173, 0
  v_mov_b32 v174, 0
  v_mov_b32 v175, 0
  v_mov_b32 v176, 0
  v_mov_b32 v177, 0
  v_mov_b32 v178, 0
  v_mov_b32 v179, 0
  v_mov_b32 v180, 0
  v_mov_b32 v181, 0
  v_mov_b32 v182, 0
  v_mov_b32 v183, 0
  v_mov_b32 v184, 0
  v_mov_b32 v185, 0
  v_mov_b32 v186, 0
  v_mov_b32 v187, 0
  v_mov_b32 v188, 0
  v_mov_b32 v189, 0
  v_mov_b32 v190, 0
  v_mov_b32 v191, 0
  v_mov_b32 v192, 0
  v_mov_b32 v193, 0
  v_mov_b32 v194, 0
  v_mov_b32 v195, 0
  v_mov_b32 v196, 0
  v_mov_b32 v197, 0
  v_mov_b32 v198, 0
  v_mov_b32 v199, 0
  v_mov_b32 v200, 0
  v_mov_b32 v201, 0
  v_mov_b32 v202, 0
  v_mov_b32 v203, 0
  v_mov_b32 v204, 0
  v_mov_b32 v205, 0
  v_mov_b32 v206, 0
  v_mov_b32 v207, 0
  v_mov_b32 v208, 0
  v_mov_b32 v209, 0
  v_mov_b32 v210, 0
  v_mov_b32 v211, 0
  v_mov_b32 v212, 0
  v_mov_b32 v213, 0
  v_mov_b32 v214, 0
  v_mov_b32 v215, 0
  v_mov_b32 v216, 0
  v_mov_b32 v217, 0
  v_mov_b32 v218, 0
  v_mov_b32 v219, 0
  v_mov_b32 v220, 0
  v_mov_b32 v221, 0
  v_mov_b32 v222, 0
  v_mov_b32 v223, 0
  v_mov_b32 v224, 0
  v_mov_b32 v225, 0
  v_mov_b32 v226, 0
  v_mov_b32 v227, 0
  v_mov_b32 v228, 0
  v_mov_b32 v229, 0
  v_mov_b32 v230, 0
  v_mov_b32 v231, 0
  v_mov_b32 v232, 0
  v_mov_b32 v233, 0
  v_mov_b32 v234, 0
  v_mov_b32 v235, 0
  v_mov_b32 v236, 0
  v_mov_b32 v237, 0
  v_mov_b32 v238, 0
  v_mov_b32 v239, 0
  v_mov_b32 v240, 0
  v_mov_b32 v241, 0
  v_mov_b32 v242, 0
  v_mov_b32 v243, 0
  v_mov_b32 v244, 0
  v_mov_b32 v245, 0
  v_mov_b32 v246, 0
  v_mov_b32 v247, 0
  v_mov_b32 v248, 0
  v_mov_b32 v249, 0
  v_mov_b32 v250, 0
  v_mov_b32 v251, 0
  v_mov_b32 v252, 0
  v_mov_b32 v253, 0
  v_mov_b32 v254, 0
  v_mov_b32 v255, 0
  v_mov_b32 v26, 0
  v_mov_b32 v27, 0
  v_mov_b32 v28, 0
  v_mov_b32 v29, 0
  v_mov_b32 v30, 0
  v_mov_b32 v31, 0
  v_mov_b32 v32, 0
  v_mov_b32 v33, 0
  s_waitcnt vmcnt(5) lgkmcnt(0)
  s_barrier
  ds_read_b128 v[36:39], v2 offset:0
  ds_read_b128 v[40:43], v2 offset:2048
  ds_read_b128 v[44:47], v2 offset:4096
  ds_read_b128 v[48:51], v2 offset:6144
  ds_read_b64_tr_b16 v[68:69], v4 offset:0
  ds_read_b64_tr_b16 v[70:71], v4 offset:512
  ds_read_b64_tr_b16 v[72:73], v4 offset:32768
  ds_read_b64_tr_b16 v[74:75], v4 offset:33280
  ds_read_b64_tr_b16 v[76:77], v8 offset:0
  ds_read_b64_tr_b16 v[78:79], v8 offset:512
  s_add_u32 m0, s46, 8192
  s_nop 0
  buffer_load_dwordx4 v10, s[16:19], s43 offen lds
  s_add_u32 s43, s43, 196608
  s_add_u32 m0, s46, 24576
  s_nop 0
  buffer_load_dwordx4 v11, s[20:23], s44 offen lds
  s_add_u32 m0, s46, 40960
  s_nop 0
  buffer_load_dwordx4 v35, s[24:27], s73 offen lds
  s_add_u32 m0, s46, 57344
  s_nop 0
  buffer_load_dwordx4 v11, s[28:31], s44 offen lds
  s_add_u32 s44, s44, 229376
  s_add_u32 m0, s46, 73728
  s_nop 0
  buffer_load_dwordx4 v35, s[32:35], s73 offen lds
  s_add_u32 s73, s73, s45
  s_add_u32 m0, s46, 12288
  s_nop 0
  buffer_load_dwordx4 v10, s[16:19], s43 offen lds
  s_add_u32 s43, s43, 196608
  s_add_u32 m0, s46, 28672
  s_nop 0
  buffer_load_dwordx4 v11, s[20:23], s44 offen lds
  s_mov_b32 s47, 7
  s_mov_b32 s66, 6
L_k1loop_34:
  s_waitcnt lgkmcnt(4)
  s_setprio 2
  v_mfma_f32_16x16x32_bf16 v[96:99], v[68:71], v[36:39], v[96:99]
  ds_read_b64_tr_b16 v[80:81], v9 offset:0
  v_mfma_f32_16x16x32_bf16 v[100:103], v[68:71], v[40:43], v[100:103]
  ds_read_b64_tr_b16 v[82:83], v9 offset:512
  v_mfma_f32_16x16x32_bf16 v[104:107], v[68:71], v[44:47], v[104:107]
  s_add_u32 m0, s46, 45056
  v_mfma_f32_16x16x32_bf16 v[108:111], v[68:71], v[48:51], v[108:111]
  buffer_load_dwordx4 v35, s[24:27], s73 offen lds
  s_waitcnt lgkmcnt(4)
  v_smfmac_f32_16x16x64_bf16 v[26:29], v[12:15], v[68:75], v16
  v_mfma_f32_16x16x32_bf16 v[112:115], v[72:75], v[36:39], v[112:115]
  ds_read_b64_tr_b16 v[68:69], v5 offset:0
  v_mfma_f32_16x16x32_bf16 v[116:119], v[72:75], v[40:43], v[116:119]
  ds_read_b64_tr_b16 v[70:71], v5 offset:512
  v_mfma_f32_16x16x32_bf16 v[120:123], v[72:75], v[44:47], v[120:123]
  s_add_u32 m0, s46, 61440
  v_mfma_f32_16x16x32_bf16 v[124:127], v[72:75], v[48:51], v[124:127]
  buffer_load_dwordx4 v11, s[28:31], s44 offen lds
  s_add_u32 s44, s44, 229376
  s_waitcnt lgkmcnt(4)
  v_mfma_f32_16x16x32_bf16 v[128:131], v[36:39], v[76:79], v[128:131]
  ds_read_b64_tr_b16 v[72:73], v5 offset:32768
  v_mfma_f32_16x16x32_bf16 v[132:135], v[40:43], v[76:79], v[132:135]
  ds_read_b64_tr_b16 v[74:75], v5 offset:33280
  v_mfma_f32_16x16x32_bf16 v[136:139], v[44:47], v[76:79], v[136:139]
  s_add_u32 m0, s46, 77824
  v_mfma_f32_16x16x32_bf16 v[140:143], v[48:51], v[76:79], v[140:143]
  buffer_load_dwordx4 v35, s[32:35], s73 offen lds
  s_add_u32 s73, s73, s45
  s_waitcnt lgkmcnt(4)
  s_setprio 1
  v_mfma_f32_16x16x32_bf16 v[144:147], v[36:39], v[80:83], v[144:147]
  s_cmp_lg_u32 s48, 0
  s_cbranch_scc1 L_k1sk_37
  v_smfmac_f32_16x16x64_bf16 v[30:33], v[12:15], v[76:83], v16
L_k1sk_37:
  v_mfma_f32_16x16x32_bf16 v[148:151], v[40:43], v[80:83], v[148:151]
  ds_read_b64_tr_b16 v[76:77], v6 offset:0
  ds_read_b64_tr_b16 v[78:79], v6 offset:512
  v_mfma_f32_16x16x32_bf16 v[152:155], v[44:47], v[80:83], v[152:155]
  v_mfma_f32_16x16x32_bf16 v[156:159], v[48:51], v[80:83], v[156:159]
  s_waitcnt lgkmcnt(4)
  v_mfma_f32_16x16x32_bf16 v[160:163], v[68:71], v[36:39], v[160:163]
  ds_read_b64_tr_b16 v[80:81], v6 offset:32768
  v_mfma_f32_16x16x32_bf16 v[164:167], v[68:71], v[40:43], v[164:167]
  ds_read_b64_tr_b16 v[82:83], v6 offset:33280
  v_mfma_f32_16x16x32_bf16 v[168:171], v[68:71], v[44:47], v[168:171]
  v_mfma_f32_16x16x32_bf16 v[172:175], v[68:71], v[48:51], v[172:175]
  s_waitcnt lgkmcnt(4)
  s_setprio 0
  v_mfma_f32_16x16x32_bf16 v[176:179], v[72:75], v[36:39], v[176:179]
  ds_read_b64_tr_b16 v[68:69], v7 offset:0
  v_mfma_f32_16x16x32_bf16 v[180:183], v[72:75], v[40:43], v[180:183]
  ds_read_b64_tr_b16 v[70:71], v7 offset:512
  v_mfma_f32_16x16x32_bf16 v[184:187], v[72:75], v[44:47], v[184:187]
  v_mfma_f32_16x16x32_bf16 v[188:191], v[72:75], v[48:51], v[188:191]
  s_waitcnt lgkmcnt(4)
  v_mfma_f32_16x16x32_bf16 v[192:195], v[76:79], v[36:39], v[192:195]
  ds_read_b64_tr_b16 v[72:73], v7 offset:32768
  v_mfma_f32_16x16x32_bf16 v[196:199], v[76:79], v[40:43], v[196:199]
  ds_read_b64_tr_b16 v[74:75], v7 offset:33280
  v_mfma_f32_16x16x32_bf16 v[200:203], v[76:79], v[44:47], v[200:203]
  v_mfma_f32_16x16x32_bf16 v[204:207], v[76:79], v[48:51], v[204:207]
  s_waitcnt vmcnt(10) lgkmcnt(0)
  s_barrier
  s_setprio 3
  v_mfma_f32_16x16x32_bf16 v[208:211], v[80:83], v[36:39], v[208:211]
  ds_read_b128 v[52:55], v3 offset:0
  ds_read_b128 v[56:59], v3 offset:2048
  v_mfma_f32_16x16x32_bf16 v[212:215], v[80:83], v[40:43], v[212:215]
  ds_read_b128 v[60:63], v3 offset:4096
  ds_read_b128 v[64:67], v3 offset:6144
  v_mfma_f32_16x16x32_bf16 v[216:219], v[80:83], v[44:47], v[216:219]
  ds_read_b64_tr_b16 v[76:77], v4 offset:4096
  ds_read_b64_tr_b16 v[78:79], v4 offset:4608
  v_mfma_f32_16x16x32_bf16 v[220:223], v[80:83], v[48:51], v[220:223]
  v_mfma_f32_16x16x32_bf16 v[224:227], v[68:71], v[36:39], v[224:227]
  ds_read_b64_tr_b16 v[80:81], v4 offset:36864
  v_mfma_f32_16x16x32_bf16 v[228:231], v[68:71], v[40:43], v[228:231]
  ds_read_b64_tr_b16 v[82:83], v4 offset:37376
  v_mfma_f32_16x16x32_bf16 v[232:235], v[68:71], v[44:47], v[232:235]
  s_add_u32 m0, s46, 0
  v_mfma_f32_16x16x32_bf16 v[236:239], v[68:71], v[48:51], v[236:239]
  buffer_load_dwordx4 v10, s[16:19], s43 offen lds
  s_add_u32 s43, s43, 196608
  v_mfma_f32_16x16x32_bf16 v[240:243], v[72:75], v[36:39], v[240:243]
  ds_read_b64_tr_b16 v[68:69], v8 offset:4096
  v_mfma_f32_16x16x32_bf16 v[244:247], v[72:75], v[40:43], v[244:247]
  ds_read_b64_tr_b16 v[70:71], v8 offset:4608
  v_mfma_f32_16x16x32_bf16 v[248:251], v[72:75], v[44:47], v[248:251]
  s_add_u32 m0, s46, 16384
  v_mfma_f32_16x16x32_bf16 v[252:255], v[72:75], v[48:51], v[252:255]
  buffer_load_dwordx4 v11, s[20:23], s44 offen lds
  s_waitcnt lgkmcnt(4)
  s_setprio 2
  v_mfma_f32_16x16x32_bf16 v[96:99], v[76:79], v[52:55], v[96:99]
  ds_read_b64_tr_b16 v[72:73], v9 offset:4096
  v_mfma_f32_16x16x32_bf16 v[100:103], v[76:79], v[56:59], v[100:103]
  ds_read_b64_tr_b16 v[74:75], v9 offset:4608
  v_mfma_f32_16x16x32_bf16 v[104:107], v[76:79], v[60:63], v[104:107]
  s_add_u32 m0, s46, 32768
  v_mfma_f32_16x16x32_bf16 v[108:111], v[76:79], v[64:67], v[108:111]
  buffer_load_dwordx4 v35, s[24:27], s73 offen lds
  s_waitcnt lgkmcnt(4)
  v_smfmac_f32_16x16x64_bf16 v[26:29], v[12:15], v[76:83], v16
  v_mfma_f32_16x16x32_bf16 v[112:115], v[80:83], v[52:55], v[112:115]
  ds_read_b64_tr_b16 v[76:77], v5 offset:4096
  v_mfma_f32_16x16x32_bf16 v[116:119], v[80:83], v[56:59], v[116:119]
  ds_read_b64_tr_b16 v[78:79], v5 offset:4608
  v_mfma_f32_16x16x32_bf16 v[120:123], v[80:83], v[60:63], v[120:123]
  s_add_u32 m0, s46, 49152
  v_mfma_f32_16x16x32_bf16 v[124:127], v[80:83], v[64:67], v[124:127]
  buffer_load_dwordx4 v11, s[28:31], s44 offen lds
  s_add_u32 s44, s44, 229376
  s_waitcnt lgkmcnt(4)
  v_mfma_f32_16x16x32_bf16 v[128:131], v[52:55], v[68:71], v[128:131]
  ds_read_b64_tr_b16 v[80:81], v5 offset:36864
  v_mfma_f32_16x16x32_bf16 v[132:135], v[56:59], v[68:71], v[132:135]
  ds_read_b64_tr_b16 v[82:83], v5 offset:37376
  v_mfma_f32_16x16x32_bf16 v[136:139], v[60:63], v[68:71], v[136:139]
  s_add_u32 m0, s46, 65536
  v_mfma_f32_16x16x32_bf16 v[140:143], v[64:67], v[68:71], v[140:143]
  buffer_load_dwordx4 v35, s[32:35], s73 offen lds
  s_add_u32 s73, s73, s45
  s_waitcnt lgkmcnt(4)
  s_setprio 1
  v_mfma_f32_16x16x32_bf16 v[144:147], v[52:55], v[72:75], v[144:147]
  s_cmp_lg_u32 s48, 1
  s_cbranch_scc1 L_k1sk_38
  v_smfmac_f32_16x16x64_bf16 v[30:33], v[12:15], v[68:75], v16
L_k1sk_38:
  v_mfma_f32_16x16x32_bf16 v[148:151], v[56:59], v[72:75], v[148:151]
  ds_read_b64_tr_b16 v[68:69], v6 offset:4096
  ds_read_b64_tr_b16 v[70:71], v6 offset:4608
  v_mfma_f32_16x16x32_bf16 v[152:155], v[60:63], v[72:75], v[152:155]
  v_mfma_f32_16x16x32_bf16 v[156:159], v[64:67], v[72:75], v[156:159]
  s_waitcnt lgkmcnt(4)
  v_mfma_f32_16x16x32_bf16 v[160:163], v[76:79], v[52:55], v[160:163]
  ds_read_b64_tr_b16 v[72:73], v6 offset:36864
  v_mfma_f32_16x16x32_bf16 v[164:167], v[76:79], v[56:59], v[164:167]
  ds_read_b64_tr_b16 v[74:75], v6 offset:37376
  v_mfma_f32_16x16x32_bf16 v[168:171], v[76:79], v[60:63], v[168:171]
  v_mfma_f32_16x16x32_bf16 v[172:175], v[76:79], v[64:67], v[172:175]
  s_waitcnt lgkmcnt(4)
  s_setprio 0
  v_mfma_f32_16x16x32_bf16 v[176:179], v[80:83], v[52:55], v[176:179]
  ds_read_b64_tr_b16 v[76:77], v7 offset:4096
  v_mfma_f32_16x16x32_bf16 v[180:183], v[80:83], v[56:59], v[180:183]
  ds_read_b64_tr_b16 v[78:79], v7 offset:4608
  v_mfma_f32_16x16x32_bf16 v[184:187], v[80:83], v[60:63], v[184:187]
  v_mfma_f32_16x16x32_bf16 v[188:191], v[80:83], v[64:67], v[188:191]
  s_waitcnt lgkmcnt(4)
  v_mfma_f32_16x16x32_bf16 v[192:195], v[68:71], v[52:55], v[192:195]
  ds_read_b64_tr_b16 v[80:81], v7 offset:36864
  v_mfma_f32_16x16x32_bf16 v[196:199], v[68:71], v[56:59], v[196:199]
  ds_read_b64_tr_b16 v[82:83], v7 offset:37376
  v_mfma_f32_16x16x32_bf16 v[200:203], v[68:71], v[60:63], v[200:203]
  v_mfma_f32_16x16x32_bf16 v[204:207], v[68:71], v[64:67], v[204:207]
  s_waitcnt vmcnt(10) lgkmcnt(0)
  s_barrier
  s_setprio 3
  v_mfma_f32_16x16x32_bf16 v[208:211], v[72:75], v[52:55], v[208:211]
  ds_read_b128 v[36:39], v2 offset:32768
  ds_read_b128 v[40:43], v2 offset:34816
  v_mfma_f32_16x16x32_bf16 v[212:215], v[72:75], v[56:59], v[212:215]
  ds_read_b128 v[44:47], v2 offset:36864
  ds_read_b128 v[48:51], v2 offset:38912
  v_mfma_f32_16x16x32_bf16 v[216:219], v[72:75], v[60:63], v[216:219]
  ds_read_b64_tr_b16 v[68:69], v4 offset:8192
  ds_read_b64_tr_b16 v[70:71], v4 offset:8704
  v_mfma_f32_16x16x32_bf16 v[220:223], v[72:75], v[64:67], v[220:223]
  v_mfma_f32_16x16x32_bf16 v[224:227], v[76:79], v[52:55], v[224:227]
  ds_read_b64_tr_b16 v[72:73], v4 offset:40960
  v_mfma_f32_16x16x32_bf16 v[228:231], v[76:79], v[56:59], v[228:231]
  ds_read_b64_tr_b16 v[74:75], v4 offset:41472
  v_mfma_f32_16x16x32_bf16 v[232:235], v[76:79], v[60:63], v[232:235]
  s_add_u32 m0, s46, 4096
  v_mfma_f32_16x16x32_bf16 v[236:239], v[76:79], v[64:67], v[236:239]
  buffer_load_dwordx4 v10, s[16:19], s43 offen lds
  s_add_u32 s43, s43, 196608
  v_mfma_f32_16x16x32_bf16 v[240:243], v[80:83], v[52:55], v[240:243]
  ds_read_b64_tr_b16 v[76:77], v8 offset:8192
  v_mfma_f32_16x16x32_bf16 v[244:247], v[80:83], v[56:59], v[244:247]
  ds_read_b64_tr_b16 v[78:79], v8 offset:8704
  v_mfma_f32_16x16x32_bf16 v[248:251], v[80:83], v[60:63], v[248:251]
  s_add_u32 m0, s46, 20480
  v_mfma_f32_16x16x32_bf16 v[252:255], v[80:83], v[64:67], v[252:255]
  buffer_load_dwordx4 v11, s[20:23], s44 offen lds
  s_waitcnt lgkmcnt(4)
  s_setprio 2
  v_mfma_f32_16x16x32_bf16 v[96:99], v[68:71], v[36:39], v[96:99]
  ds_read_b64_tr_b16 v[80:81], v9 offset:8192
  v_mfma_f32_16x16x32_bf16 v[100:103], v[68:71], v[40:43], v[100:103]
  ds_read_b64_tr_b16 v[82:83], v9 offset:8704
  v_mfma_f32_16x16x32_bf16 v[104:107], v[68:71], v[44:47], v[104:107]
  s_add_u32 m0, s46, 36864
  v_mfma_f32_16x16x32_bf16 v[108:111], v[68:71], v[48:51], v[108:111]
  buffer_load_dwordx4 v35, s[24:27], s73 offen lds
  s_waitcnt lgkmcnt(4)
  v_smfmac_f32_16x16x64_bf16 v[26:29], v[12:15], v[68:75], v16
  v_mfma_f32_16x16x32_bf16 v[112:115], v[72:75], v[36:39], v[112:115]
  ds_read_b64_tr_b16 v[68:69], v5 offset:8192
  v_mfma_f32_16x16x32_bf16 v[116:119], v[72:75], v[40:43], v[116:119]
  ds_read_b64_tr_b16 v[70:71], v5 offset:8704
  v_mfma_f32_16x16x32_bf16 v[120:123], v[72:75], v[44:47], v[120:123]
  s_add_u32 m0, s46, 53248
  v_mfma_f32_16x16x32_bf16 v[124:127], v[72:75], v[48:51], v[124:127]
  buffer_load_dwordx4 v11, s[28:31], s44 offen lds
  s_add_u32 s44, s44, 229376
  s_waitcnt lgkmcnt(4)
  v_mfma_f32_16x16x32_bf16 v[128:131], v[36:39], v[76:79], v[128:131]
  ds_read_b64_tr_b16 v[72:73], v5 offset:40960
  v_mfma_f32_16x16x32_bf16 v[132:135], v[40:43], v[76:79], v[132:135]
  ds_read_b64_tr_b16 v[74:75], v5 offset:41472
  v_mfma_f32_16x16x32_bf16 v[136:139], v[44:47], v[76:79], v[136:139]
  s_add_u32 m0, s46, 69632
  v_mfma_f32_16x16x32_bf16 v[140:143], v[48:51], v[76:79], v[140:143]
  buffer_load_dwordx4 v35, s[32:35], s73 offen lds
  s_add_u32 s73, s73, s45
  s_waitcnt lgkmcnt(4)
  s_setprio 1
  v_mfma_f32_16x16x32_bf16 v[144:147], v[36:39], v[80:83], v[144:147]
  s_cmp_lg_u32 s48, 2
  s_cbranch_scc1 L_k1sk_39
  v_smfmac_f32_16x16x64_bf16 v[30:33], v[12:15], v[76:83], v16
L_k1sk_39:
  v_mfma_f32_16x16x32_bf16 v[148:151], v[40:43], v[80:83], v[148:151]
  ds_read_b64_tr_b16 v[76:77], v6 offset:8192
  ds_read_b64_tr_b16 v[78:79], v6 offset:8704
  v_mfma_f32_16x16x32_bf16 v[152:155], v[44:47], v[80:83], v[152:155]
  v_mfma_f32_16x16x32_bf16 v[156:159], v[48:51], v[80:83], v[156:159]
  s_waitcnt lgkmcnt(4)
  v_mfma_f32_16x16x32_bf16 v[160:163], v[68:71], v[36:39], v[160:163]
  ds_read_b64_tr_b16 v[80:81], v6 offset:40960
  v_mfma_f32_16x16x32_bf16 v[164:167], v[68:71], v[40:43], v[164:167]
  ds_read_b64_tr_b16 v[82:83], v6 offset:41472
  v_mfma_f32_16x16x32_bf16 v[168:171], v[68:71], v[44:47], v[168:171]
  v_mfma_f32_16x16x32_bf16 v[172:175], v[68:71], v[48:51], v[172:175]
  s_waitcnt lgkmcnt(4)
  s_setprio 0
  v_mfma_f32_16x16x32_bf16 v[176:179], v[72:75], v[36:39], v[176:179]
  ds_read_b64_tr_b16 v[68:69], v7 offset:8192
  v_mfma_f32_16x16x32_bf16 v[180:183], v[72:75], v[40:43], v[180:183]
  ds_read_b64_tr_b16 v[70:71], v7 offset:8704
  v_mfma_f32_16x16x32_bf16 v[184:187], v[72:75], v[44:47], v[184:187]
  v_mfma_f32_16x16x32_bf16 v[188:191], v[72:75], v[48:51], v[188:191]
  s_waitcnt lgkmcnt(4)
  v_mfma_f32_16x16x32_bf16 v[192:195], v[76:79], v[36:39], v[192:195]
  ds_read_b64_tr_b16 v[72:73], v7 offset:40960
  v_mfma_f32_16x16x32_bf16 v[196:199], v[76:79], v[40:43], v[196:199]
  ds_read_b64_tr_b16 v[74:75], v7 offset:41472
  v_mfma_f32_16x16x32_bf16 v[200:203], v[76:79], v[44:47], v[200:203]
  v_mfma_f32_16x16x32_bf16 v[204:207], v[76:79], v[48:51], v[204:207]
  s_waitcnt vmcnt(10) lgkmcnt(0)
  s_barrier
  s_setprio 3
  v_mfma_f32_16x16x32_bf16 v[208:211], v[80:83], v[36:39], v[208:211]
  ds_read_b128 v[52:55], v3 offset:32768
  ds_read_b128 v[56:59], v3 offset:34816
  v_mfma_f32_16x16x32_bf16 v[212:215], v[80:83], v[40:43], v[212:215]
  ds_read_b128 v[60:63], v3 offset:36864
  ds_read_b128 v[64:67], v3 offset:38912
  v_mfma_f32_16x16x32_bf16 v[216:219], v[80:83], v[44:47], v[216:219]
  ds_read_b64_tr_b16 v[76:77], v4 offset:12288
  ds_read_b64_tr_b16 v[78:79], v4 offset:12800
  v_mfma_f32_16x16x32_bf16 v[220:223], v[80:83], v[48:51], v[220:223]
  v_mfma_f32_16x16x32_bf16 v[224:227], v[68:71], v[36:39], v[224:227]
  ds_read_b64_tr_b16 v[80:81], v4 offset:45056
  v_mfma_f32_16x16x32_bf16 v[228:231], v[68:71], v[40:43], v[228:231]
  ds_read_b64_tr_b16 v[82:83], v4 offset:45568
  v_mfma_f32_16x16x32_bf16 v[232:235], v[68:71], v[44:47], v[232:235]
  s_add_u32 m0, s46, 8192
  v_mfma_f32_16x16x32_bf16 v[236:239], v[68:71], v[48:51], v[236:239]
  buffer_load_dwordx4 v10, s[16:19], s43 offen lds
  s_add_u32 s43, s43, 196608
  v_mfma_f32_16x16x32_bf16 v[240:243], v[72:75], v[36:39], v[240:243]
  ds_read_b64_tr_b16 v[68:69], v8 offset:12288
  v_mfma_f32_16x16x32_bf16 v[244:247], v[72:75], v[40:43], v[244:247]
  ds_read_b64_tr_b16 v[70:71], v8 offset:12800
  v_mfma_f32_16x16x32_bf16 v[248:251], v[72:75], v[44:47], v[248:251]
  s_add_u32 m0, s46, 24576
  v_mfma_f32_16x16x32_bf16 v[252:255], v[72:75], v[48:51], v[252:255]
  buffer_load_dwordx4 v11, s[20:23], s44 offen lds
  s_waitcnt lgkmcnt(4)
  s_setprio 2
  v_mfma_f32_16x16x32_bf16 v[96:99], v[76:79], v[52:55], v[96:99]
  ds_read_b64_tr_b16 v[72:73], v9 offset:12288
  v_mfma_f32_16x16x32_bf16 v[100:103], v[76:79], v[56:59], v[100:103]
  ds_read_b64_tr_b16 v[74:75], v9 offset:12800
  v_mfma_f32_16x16x32_bf16 v[104:107], v[76:79], v[60:63], v[104:107]
  s_add_u32 m0, s46, 40960
  v_mfma_f32_16x16x32_bf16 v[108:111], v[76:79], v[64:67], v[108:111]
  buffer_load_dwordx4 v35, s[24:27], s73 offen lds
  s_waitcnt lgkmcnt(4)
  v_smfmac_f32_16x16x64_bf16 v[26:29], v[12:15], v[76:83], v16
  v_mfma_f32_16x16x32_bf16 v[112:115], v[80:83], v[52:55], v[112:115]
  ds_read_b64_tr_b16 v[76:77], v5 offset:12288
  v_mfma_f32_16x16x32_bf16 v[116:119], v[80:83], v[56:59], v[116:119]
  ds_read_b64_tr_b16 v[78:79], v5 offset:12800
  v_mfma_f32_16x16x32_bf16 v[120:123], v[80:83], v[60:63], v[120:123]
  s_add_u32 m0, s46, 57344
  v_mfma_f32_16x16x32_bf16 v[124:127], v[80:83], v[64:67], v[124:127]
  buffer_load_dwordx4 v11, s[28:31], s44 offen lds
  s_add_u32 s44, s44, 229376
  s_waitcnt lgkmcnt(4)
  v_mfma_f32_16x16x32_bf16 v[128:131], v[52:55], v[68:71], v[128:131]
  ds_read_b64_tr_b16 v[80:81], v5 offset:45056
  v_mfma_f32_16x16x32_bf16 v[132:135], v[56:59], v[68:71], v[132:135]
  ds_read_b64_tr_b16 v[82:83], v5 offset:45568
  v_mfma_f32_16x16x32_bf16 v[136:139], v[60:63], v[68:71], v[136:139]
  s_add_u32 m0, s46, 73728
  v_mfma_f32_16x16x32_bf16 v[140:143], v[64:67], v[68:71], v[140:143]
  buffer_load_dwordx4 v35, s[32:35], s73 offen lds
  s_add_u32 s73, s73, s45
  s_waitcnt lgkmcnt(4)
  s_setprio 1
  v_mfma_f32_16x16x32_bf16 v[144:147], v[52:55], v[72:75], v[144:147]
  s_cmp_lg_u32 s48, 3
  s_cbranch_scc1 L_k1sk_40
  v_smfmac_f32_16x16x64_bf16 v[30:33], v[12:15], v[68:75], v16
L_k1sk_40:
  v_mfma_f32_16x16x32_bf16 v[148:151], v[56:59], v[72:75], v[148:151]
  ds_read_b64_tr_b16 v[68:69], v6 offset:12288
  ds_read_b64_tr_b16 v[70:71], v6 offset:12800
  v_mfma_f32_16x16x32_bf16 v[152:155], v[60:63], v[72:75], v[152:155]
  v_mfma_f32_16x16x32_bf16 v[156:159], v[64:67], v[72:75], v[156:159]
  s_waitcnt lgkmcnt(4)
  v_mfma_f32_16x16x32_bf16 v[160:163], v[76:79], v[52:55], v[160:163]
  ds_read_b64_tr_b16 v[72:73], v6 offset:45056
  v_mfma_f32_16x16x32_bf16 v[164:167], v[76:79], v[56:59], v[164:167]
  ds_read_b64_tr_b16 v[74:75], v6 offset:45568
  v_mfma_f32_16x16x32_bf16 v[168:171], v[76:79], v[60:63], v[168:171]
  v_mfma_f32_16x16x32_bf16 v[172:175], v[76:79], v[64:67], v[172:175]
  s_waitcnt lgkmcnt(4)
  s_setprio 0
  v_mfma_f32_16x16x32_bf16 v[176:179], v[80:83], v[52:55], v[176:179]
  ds_read_b64_tr_b16 v[76:77], v7 offset:12288
  v_mfma_f32_16x16x32_bf16 v[180:183], v[80:83], v[56:59], v[180:183]
  ds_read_b64_tr_b16 v[78:79], v7 offset:12800
  v_mfma_f32_16x16x32_bf16 v[184:187], v[80:83], v[60:63], v[184:187]
  v_mfma_f32_16x16x32_bf16 v[188:191], v[80:83], v[64:67], v[188:191]
  s_waitcnt lgkmcnt(4)
  v_mfma_f32_16x16x32_bf16 v[192:195], v[68:71], v[52:55], v[192:195]
  ds_read_b64_tr_b16 v[80:81], v7 offset:45056
  v_mfma_f32_16x16x32_bf16 v[196:199], v[68:71], v[56:59], v[196:199]
  ds_read_b64_tr_b16 v[82:83], v7 offset:45568
  v_mfma_f32_16x16x32_bf16 v[200:203], v[68:71], v[60:63], v[200:203]
  v_mfma_f32_16x16x32_bf16 v[204:207], v[68:71], v[64:67], v[204:207]
  s_waitcnt vmcnt(10) lgkmcnt(0)
  s_barrier
  s_setprio 3
  v_mfma_f32_16x16x32_bf16 v[208:211], v[72:75], v[52:55], v[208:211]
  ds_read_b128 v[36:39], v2 offset:0
  ds_read_b128 v[40:43], v2 offset:2048
  v_mfma_f32_16x16x32_bf16 v[212:215], v[72:75], v[56:59], v[212:215]
  ds_read_b128 v[44:47], v2 offset:4096
  ds_read_b128 v[48:51], v2 offset:6144
  v_mfma_f32_16x16x32_bf16 v[216:219], v[72:75], v[60:63], v[216:219]
  ds_read_b64_tr_b16 v[68:69], v4 offset:0
  ds_read_b64_tr_b16 v[70:71], v4 offset:512
  v_mfma_f32_16x16x32_bf16 v[220:223], v[72:75], v[64:67], v[220:223]
  v_mfma_f32_16x16x32_bf16 v[224:227], v[76:79], v[52:55], v[224:227]
  ds_read_b64_tr_b16 v[72:73], v4 offset:32768
  v_mfma_f32_16x16x32_bf16 v[228:231], v[76:79], v[56:59], v[228:231]
  ds_read_b64_tr_b16 v[74:75], v4 offset:33280
  v_mfma_f32_16x16x32_bf16 v[232:235], v[76:79], v[60:63], v[232:235]
  s_add_u32 m0, s46, 12288
  v_mfma_f32_16x16x32_bf16 v[236:239], v[76:79], v[64:67], v[236:239]
  buffer_load_dwordx4 v10, s[16:19], s43 offen lds
  s_add_u32 s43, s43, 196608
  v_mfma_f32_16x16x32_bf16 v[240:243], v[80:83], v[52:55], v[240:243]
  ds_read_b64_tr_b16 v[76:77], v8 offset:0
  v_mfma_f32_16x16x32_bf16 v[244:247], v[80:83], v[56:59], v[244:247]
  ds_read_b64_tr_b16 v[78:79], v8 offset:512
  v_mfma_f32_16x16x32_bf16 v[248:251], v[80:83], v[60:63], v[248:251]
  s_add_u32 m0, s46, 28672
  v_mfma_f32_16x16x32_bf16 v[252:255], v[80:83], v[64:67], v[252:255]
  buffer_load_dwordx4 v11, s[20:23], s44 offen lds
  s_sub_u32 s47, s47, 1
  s_cmp_lg_u32 s47, s66
  s_cbranch_scc1 L_k1loop_34
  s_cmp_eq_u32 s47, 0
  s_cbranch_scc1 L_k1tail_35
  s_cmp_eq_u32 s47, 1
  s_cbranch_scc1 L_k1poll_36
  s_mov_b32 s66, 1
  s_branch L_k1loop_34
L_k1poll_36:
  s_mov_b32 s66, 0
  buffer_load_dword v1, off, s[68:71], s72 sc1
  s_branch L_k1loop_34
L_k1tail_35:
  v_readfirstlane_b32 s61, v1
  s_lshl_b32 s3, s2, 3
  s_add_u32 s3, s3, s40
  s_lshl_b32 s3, s3, 9
  s_add_u32 s3, s3, 1048576
  s_cmp_eq_u32 s61, 32
  s_cselect_b32 s67, s67, s3
  buffer_load_dwordx2 v[18:19], v34, s[36:39], s67 offen offset:0 sc1
  buffer_load_dwordx2 v[20:21], v34, s[36:39], s67 offen offset:128 sc1
  buffer_load_dwordx2 v[22:23], v34, s[36:39], s67 offen offset:256 sc1
  buffer_load_dwordx2 v[24:25], v34, s[36:39], s67 offen offset:384 sc1
  s_waitcnt lgkmcnt(4)
  s_setprio 2
  v_mfma_f32_16x16x32_bf16 v[96:99], v[68:71], v[36:39], v[96:99]
  ds_read_b64_tr_b16 v[80:81], v9 offset:0
  v_mfma_f32_16x16x32_bf16 v[100:103], v[68:71], v[40:43], v[100:103]
  ds_read_b64_tr_b16 v[82:83], v9 offset:512
  v_mfma_f32_16x16x32_bf16 v[104:107], v[68:71], v[44:47], v[104:107]
  s_add_u32 m0, s46, 45056
  v_mfma_f32_16x16x32_bf16 v[108:111], v[68:71], v[48:51], v[108:111]
  buffer_load_dwordx4 v35, s[24:27], s73 offen lds
  s_waitcnt lgkmcnt(4)
  v_smfmac_f32_16x16x64_bf16 v[26:29], v[12:15], v[68:75], v16
  v_mfma_f32_16x16x32_bf16 v[112:115], v[72:75], v[36:39], v[112:115]
  ds_read_b64_tr_b16 v[68:69], v5 offset:0
  v_mfma_f32_16x16x32_bf16 v[116:119], v[72:75], v[40:43], v[116:119]
  ds_read_b64_tr_b16 v[70:71], v5 offset:512
  v_mfma_f32_16x16x32_bf16 v[120:123], v[72:75], v[44:47], v[120:123]
  s_add_u32 m0, s46, 61440
  v_mfma_f32_16x16x32_bf16 v[124:127], v[72:75], v[48:51], v[124:127]
  buffer_load_dwordx4 v11, s[28:31], s44 offen lds
  s_add_u32 s44, s44, 229376
  s_waitcnt lgkmcnt(4)
  v_mfma_f32_16x16x32_bf16 v[128:131], v[36:39], v[76:79], v[128:131]
  ds_read_b64_tr_b16 v[72:73], v5 offset:32768
  v_mfma_f32_16x16x32_bf16 v[132:135], v[40:43], v[76:79], v[132:135]
  ds_read_b64_tr_b16 v[74:75], v5 offset:33280
  v_mfma_f32_16x16x32_bf16 v[136:139], v[44:47], v[76:79], v[136:139]
  s_add_u32 m0, s46, 77824
  v_mfma_f32_16x16x32_bf16 v[140:143], v[48:51], v[76:79], v[140:143]
  buffer_load_dwordx4 v35, s[32:35], s73 offen lds
  s_add_u32 s73, s73, s45
  s_waitcnt lgkmcnt(4)
  s_setprio 1
  v_mfma_f32_16x16x32_bf16 v[144:147], v[36:39], v[80:83], v[144:147]
  s_cmp_lg_u32 s48, 0
  s_cbranch_scc1 L_k1sk_41
  v_smfmac_f32_16x16x64_bf16 v[30:33], v[12:15], v[76:83], v16
L_k1sk_41:
  v_mfma_f32_16x16x32_bf16 v[148:151], v[40:43], v[80:83], v[148:151]
  ds_read_b64_tr_b16 v[76:77], v6 offset:0
  ds_read_b64_tr_b16 v[78:79], v6 offset:512
  v_mfma_f32_16x16x32_bf16 v[152:155], v[44:47], v[80:83], v[152:155]
  v_mfma_f32_16x16x32_bf16 v[156:159], v[48:51], v[80:83], v[156:159]
  s_waitcnt lgkmcnt(4)
  v_mfma_f32_16x16x32_bf16 v[160:163], v[68:71], v[36:39], v[160:163]
  ds_read_b64_tr_b16 v[80:81], v6 offset:32768
  v_mfma_f32_16x16x32_bf16 v[164:167], v[68:71], v[40:43], v[164:167]
  ds_read_b64_tr_b16 v[82:83], v6 offset:33280
  v_mfma_f32_16x16x32_bf16 v[168:171], v[68:71], v[44:47], v[168:171]
  v_mfma_f32_16x16x32_bf16 v[172:175], v[68:71], v[48:51], v[172:175]
  s_waitcnt lgkmcnt(4)
  s_setprio 0
  v_mfma_f32_16x16x32_bf16 v[176:179], v[72:75], v[36:39], v[176:179]
  ds_read_b64_tr_b16 v[68:69], v7 offset:0
  v_mfma_f32_16x16x32_bf16 v[180:183], v[72:75], v[40:43], v[180:183]
  ds_read_b64_tr_b16 v[70:71], v7 offset:512
  v_mfma_f32_16x16x32_bf16 v[184:187], v[72:75], v[44:47], v[184:187]
  v_mfma_f32_16x16x32_bf16 v[188:191], v[72:75], v[48:51], v[188:191]
  s_waitcnt lgkmcnt(4)
  v_mfma_f32_16x16x32_bf16 v[192:195], v[76:79], v[36:39], v[192:195]
  ds_read_b64_tr_b16 v[72:73], v7 offset:32768
  v_mfma_f32_16x16x32_bf16 v[196:199], v[76:79], v[40:43], v[196:199]
  ds_read_b64_tr_b16 v[74:75], v7 offset:33280
  v_mfma_f32_16x16x32_bf16 v[200:203], v[76:79], v[44:47], v[200:203]
  v_mfma_f32_16x16x32_bf16 v[204:207], v[76:79], v[48:51], v[204:207]
  s_waitcnt vmcnt(14) lgkmcnt(0)
  s_barrier
  s_setprio 3
  v_mfma_f32_16x16x32_bf16 v[208:211], v[80:83], v[36:39], v[208:211]
  ds_read_b128 v[52:55], v3 offset:0
  ds_read_b128 v[56:59], v3 offset:2048
  v_mfma_f32_16x16x32_bf16 v[212:215], v[80:83], v[40:43], v[212:215]
  ds_read_b128 v[60:63], v3 offset:4096
  ds_read_b128 v[64:67], v3 offset:6144
  v_mfma_f32_16x16x32_bf16 v[216:219], v[80:83], v[44:47], v[216:219]
  ds_read_b64_tr_b16 v[76:77], v4 offset:4096
  ds_read_b64_tr_b16 v[78:79], v4 offset:4608
  v_mfma_f32_16x16x32_bf16 v[220:223], v[80:83], v[48:51], v[220:223]
  v_mfma_f32_16x16x32_bf16 v[224:227], v[68:71], v[36:39], v[224:227]
  ds_read_b64_tr_b16 v[80:81], v4 offset:36864
  v_mfma_f32_16x16x32_bf16 v[228:231], v[68:71], v[40:43], v[228:231]
  ds_read_b64_tr_b16 v[82:83], v4 offset:37376
  v_mfma_f32_16x16x32_bf16 v[232:235], v[68:71], v[44:47], v[232:235]
  v_mfma_f32_16x16x32_bf16 v[236:239], v[68:71], v[48:51], v[236:239]
  v_mfma_f32_16x16x32_bf16 v[240:243], v[72:75], v[36:39], v[240:243]
  ds_read_b64_tr_b16 v[68:69], v8 offset:4096
  v_mfma_f32_16x16x32_bf16 v[244:247], v[72:75], v[40:43], v[244:247]
  ds_read_b64_tr_b16 v[70:71], v8 offset:4608
  v_mfma_f32_16x16x32_bf16 v[248:251], v[72:75], v[44:47], v[248:251]
  v_mfma_f32_16x16x32_bf16 v[252:255], v[72:75], v[48:51], v[252:255]
  s_waitcnt lgkmcnt(4)
  s_setprio 2
  v_mfma_f32_16x16x32_bf16 v[96:99], v[76:79], v[52:55], v[96:99]
  ds_read_b64_tr_b16 v[72:73], v9 offset:4096
  v_mfma_f32_16x16x32_bf16 v[100:103], v[76:79], v[56:59], v[100:103]
  ds_read_b64_tr_b16 v[74:75], v9 offset:4608
  v_mfma_f32_16x16x32_bf16 v[104:107], v[76:79], v[60:63], v[104:107]
  v_mfma_f32_16x16x32_bf16 v[108:111], v[76:79], v[64:67], v[108:111]
  s_waitcnt lgkmcnt(4)
  v_smfmac_f32_16x16x64_bf16 v[26:29], v[12:15], v[76:83], v16
  v_mfma_f32_16x16x32_bf16 v[112:115], v[80:83], v[52:55], v[112:115]
  ds_read_b64_tr_b16 v[76:77], v5 offset:4096
  v_mfma_f32_16x16x32_bf16 v[116:119], v[80:83], v[56:59], v[116:119]
  ds_read_b64_tr_b16 v[78:79], v5 offset:4608
  v_mfma_f32_16x16x32_bf16 v[120:123], v[80:83], v[60:63], v[120:123]
  v_mfma_f32_16x16x32_bf16 v[124:127], v[80:83], v[64:67], v[124:127]
  s_waitcnt lgkmcnt(4)
  v_mfma_f32_16x16x32_bf16 v[128:131], v[52:55], v[68:71], v[128:131]
  ds_read_b64_tr_b16 v[80:81], v5 offset:36864
  v_mfma_f32_16x16x32_bf16 v[132:135], v[56:59], v[68:71], v[132:135]
  ds_read_b64_tr_b16 v[82:83], v5 offset:37376
  v_mfma_f32_16x16x32_bf16 v[136:139], v[60:63], v[68:71], v[136:139]
  v_mfma_f32_16x16x32_bf16 v[140:143], v[64:67], v[68:71], v[140:143]
  s_waitcnt lgkmcnt(4)
  s_setprio 1
  v_mfma_f32_16x16x32_bf16 v[144:147], v[52:55], v[72:75], v[144:147]
  s_cmp_lg_u32 s48, 1
  s_cbranch_scc1 L_k1sk_42
  v_smfmac_f32_16x16x64_bf16 v[30:33], v[12:15], v[68:75], v16
L_k1sk_42:
  v_mfma_f32_16x16x32_bf16 v[148:151], v[56:59], v[72:75], v[148:151]
  ds_read_b64_tr_b16 v[68:69], v6 offset:4096
  ds_read_b64_tr_b16 v[70:71], v6 offset:4608
  v_mfma_f32_16x16x32_bf16 v[152:155], v[60:63], v[72:75], v[152:155]
  v_mfma_f32_16x16x32_bf16 v[156:159], v[64:67], v[72:75], v[156:159]
  s_waitcnt lgkmcnt(4)
  v_mfma_f32_16x16x32_bf16 v[160:163], v[76:79], v[52:55], v[160:163]
  ds_read_b64_tr_b16 v[72:73], v6 offset:36864
  v_mfma_f32_16x16x32_bf16 v[164:167], v[76:79], v[56:59], v[164:167]
  ds_read_b64_tr_b16 v[74:75], v6 offset:37376
  v_mfma_f32_16x16x32_bf16 v[168:171], v[76:79], v[60:63], v[168:171]
  v_mfma_f32_16x16x32_bf16 v[172:175], v[76:79], v[64:67], v[172:175]
  s_waitcnt lgkmcnt(4)
  s_setprio 0
  v_mfma_f32_16x16x32_bf16 v[176:179], v[80:83], v[52:55], v[176:179]
  ds_read_b64_tr_b16 v[76:77], v7 offset:4096
  v_mfma_f32_16x16x32_bf16 v[180:183], v[80:83], v[56:59], v[180:183]
  ds_read_b64_tr_b16 v[78:79], v7 offset:4608
  v_mfma_f32_16x16x32_bf16 v[184:187], v[80:83], v[60:63], v[184:187]
  v_mfma_f32_16x16x32_bf16 v[188:191], v[80:83], v[64:67], v[188:191]
  s_waitcnt lgkmcnt(4)
  v_mfma_f32_16x16x32_bf16 v[192:195], v[68:71], v[52:55], v[192:195]
  ds_read_b64_tr_b16 v[80:81], v7 offset:36864
  v_mfma_f32_16x16x32_bf16 v[196:199], v[68:71], v[56:59], v[196:199]
  ds_read_b64_tr_b16 v[82:83], v7 offset:37376
  v_mfma_f32_16x16x32_bf16 v[200:203], v[68:71], v[60:63], v[200:203]
  v_mfma_f32_16x16x32_bf16 v[204:207], v[68:71], v[64:67], v[204:207]
  s_waitcnt vmcnt(0) lgkmcnt(0)
  s_barrier
  s_setprio 3
  v_mfma_f32_16x16x32_bf16 v[208:211], v[72:75], v[52:55], v[208:211]
  ds_read_b128 v[36:39], v2 offset:32768
  ds_read_b128 v[40:43], v2 offset:34816
  v_mfma_f32_16x16x32_bf16 v[212:215], v[72:75], v[56:59], v[212:215]
  ds_read_b128 v[44:47], v2 offset:36864
  ds_read_b128 v[48:51], v2 offset:38912
  v_mfma_f32_16x16x32_bf16 v[216:219], v[72:75], v[60:63], v[216:219]
  ds_read_b64_tr_b16 v[68:69], v4 offset:8192
  ds_read_b64_tr_b16 v[70:71], v4 offset:8704
  v_mfma_f32_16x16x32_bf16 v[220:223], v[72:75], v[64:67], v[220:223]
  v_mfma_f32_16x16x32_bf16 v[224:227], v[76:79], v[52:55], v[224:227]
  ds_read_b64_tr_b16 v[72:73], v4 offset:40960
  v_mfma_f32_16x16x32_bf16 v[228:231], v[76:79], v[56:59], v[228:231]
  ds_read_b64_tr_b16 v[74:75], v4 offset:41472
  v_mfma_f32_16x16x32_bf16 v[232:235], v[76:79], v[60:63], v[232:235]
  v_mfma_f32_16x16x32_bf16 v[236:239], v[76:79], v[64:67], v[236:239]
  v_mfma_f32_16x16x32_bf16 v[240:243], v[80:83], v[52:55], v[240:243]
  ds_read_b64_tr_b16 v[76:77], v8 offset:8192
  v_mfma_f32_16x16x32_bf16 v[244:247], v[80:83], v[56:59], v[244:247]
  ds_read_b64_tr_b16 v[78:79], v8 offset:8704
  v_mfma_f32_16x16x32_bf16 v[248:251], v[80:83], v[60:63], v[248:251]
  v_mfma_f32_16x16x32_bf16 v[252:255], v[80:83], v[64:67], v[252:255]
  s_waitcnt lgkmcnt(4)
  v_mfma_f32_16x16x32_bf16 v[96:99], v[68:71], v[36:39], v[96:99]
  ds_read_b64_tr_b16 v[80:81], v9 offset:8192
  v_mfma_f32_16x16x32_bf16 v[100:103], v[68:71], v[40:43], v[100:103]
  ds_read_b64_tr_b16 v[82:83], v9 offset:8704
  v_mfma_f32_16x16x32_bf16 v[104:107], v[68:71], v[44:47], v[104:107]
  v_mfma_f32_16x16x32_bf16 v[108:111], v[68:71], v[48:51], v[108:111]
  s_waitcnt lgkmcnt(4)
  v_smfmac_f32_16x16x64_bf16 v[26:29], v[12:15], v[68:75], v16
  v_mfma_f32_16x16x32_bf16 v[112:115], v[72:75], v[36:39], v[112:115]
  ds_read_b64_tr_b16 v[68:69], v5 offset:8192
  v_mfma_f32_16x16x32_bf16 v[116:119], v[72:75], v[40:43], v[116:119]
  ds_read_b64_tr_b16 v[70:71], v5 offset:8704
  v_mfma_f32_16x16x32_bf16 v[120:123], v[72:75], v[44:47], v[120:123]
  v_mfma_f32_16x16x32_bf16 v[124:127], v[72:75], v[48:51], v[124:127]
  s_waitcnt lgkmcnt(4)
  v_mfma_f32_16x16x32_bf16 v[128:131], v[36:39], v[76:79], v[128:131]
  ds_read_b64_tr_b16 v[72:73], v5 offset:40960
  v_mfma_f32_16x16x32_bf16 v[132:135], v[40:43], v[76:79], v[132:135]
  ds_read_b64_tr_b16 v[74:75], v5 offset:41472
  v_mfma_f32_16x16x32_bf16 v[136:139], v[44:47], v[76:79], v[136:139]
  v_mfma_f32_16x16x32_bf16 v[140:143], v[48:51], v[76:79], v[140:143]
  s_waitcnt lgkmcnt(4)
  v_mfma_f32_16x16x32_bf16 v[144:147], v[36:39], v[80:83], v[144:147]
  s_cmp_lg_u32 s48, 2
  s_cbranch_scc1 L_k1sk_43
  v_smfmac_f32_16x16x64_bf16 v[30:33], v[12:15], v[76:83], v16
L_k1sk_43:
  v_mfma_f32_16x16x32_bf16 v[148:151], v[40:43], v[80:83], v[148:151]
  ds_read_b64_tr_b16 v[76:77], v6 offset:8192
  ds_read_b64_tr_b16 v[78:79], v6 offset:8704
  v_mfma_f32_16x16x32_bf16 v[152:155], v[44:47], v[80:83], v[152:155]
  v_mfma_f32_16x16x32_bf16 v[156:159], v[48:51], v[80:83], v[156:159]
  s_waitcnt lgkmcnt(4)
  v_mfma_f32_16x16x32_bf16 v[160:163], v[68:71], v[36:39], v[160:163]
  ds_read_b64_tr_b16 v[80:81], v6 offset:40960
  v_mfma_f32_16x16x32_bf16 v[164:167], v[68:71], v[40:43], v[164:167]
  ds_read_b64_tr_b16 v[82:83], v6 offset:41472
  v_mfma_f32_16x16x32_bf16 v[168:171], v[68:71], v[44:47], v[168:171]
  v_mfma_f32_16x16x32_bf16 v[172:175], v[68:71], v[48:51], v[172:175]
  s_waitcnt lgkmcnt(4)
  v_mfma_f32_16x16x32_bf16 v[176:179], v[72:75], v[36:39], v[176:179]
  ds_read_b64_tr_b16 v[68:69], v7 offset:8192
  v_mfma_f32_16x16x32_bf16 v[180:183], v[72:75], v[40:43], v[180:183]
  ds_read_b64_tr_b16 v[70:71], v7 offset:8704
  v_mfma_f32_16x16x32_bf16 v[184:187], v[72:75], v[44:47], v[184:187]
  v_mfma_f32_16x16x32_bf16 v[188:191], v[72:75], v[48:51], v[188:191]
  s_waitcnt lgkmcnt(4)
  v_mfma_f32_16x16x32_bf16 v[192:195], v[76:79], v[36:39], v[192:195]
  ds_read_b64_tr_b16 v[72:73], v7 offset:40960
  v_mfma_f32_16x16x32_bf16 v[196:199], v[76:79], v[40:43], v[196:199]
  ds_read_b64_tr_b16 v[74:75], v7 offset:41472
  v_mfma_f32_16x16x32_bf16 v[200:203], v[76:79], v[44:47], v[200:203]
  v_mfma_f32_16x16x32_bf16 v[204:207], v[76:79], v[48:51], v[204:207]
  s_waitcnt lgkmcnt(4)
  v_mfma_f32_16x16x32_bf16 v[208:211], v[80:83], v[36:39], v[208:211]
  ds_read_b128 v[52:55], v3 offset:32768
  ds_read_b128 v[56:59], v3 offset:34816
  v_mfma_f32_16x16x32_bf16 v[212:215], v[80:83], v[40:43], v[212:215]
  ds_read_b128 v[60:63], v3 offset:36864
  ds_read_b128 v[64:67], v3 offset:38912
  v_mfma_f32_16x16x32_bf16 v[216:219], v[80:83], v[44:47], v[216:219]
  ds_read_b64_tr_b16 v[76:77], v4 offset:12288
  ds_read_b64_tr_b16 v[78:79], v4 offset:12800
  v_mfma_f32_16x16x32_bf16 v[220:223], v[80:83], v[48:51], v[220:223]
  s_waitcnt lgkmcnt(8)
  v_mfma_f32_16x16x32_bf16 v[224:227], v[68:71], v[36:39], v[224:227]
  ds_read_b64_tr_b16 v[80:81], v4 offset:45056
  v_mfma_f32_16x16x32_bf16 v[228:231], v[68:71], v[40:43], v[228:231]
  ds_read_b64_tr_b16 v[82:83], v4 offset:45568
  v_mfma_f32_16x16x32_bf16 v[232:235], v[68:71], v[44:47], v[232:235]
  v_mfma_f32_16x16x32_bf16 v[236:239], v[68:71], v[48:51], v[236:239]
  s_waitcnt lgkmcnt(8)
  v_mfma_f32_16x16x32_bf16 v[240:243], v[72:75], v[36:39], v[240:243]
  ds_read_b64_tr_b16 v[68:69], v8 offset:12288
  v_mfma_f32_16x16x32_bf16 v[244:247], v[72:75], v[40:43], v[244:247]
  ds_read_b64_tr_b16 v[70:71], v8 offset:12800
  v_mfma_f32_16x16x32_bf16 v[248:251], v[72:75], v[44:47], v[248:251]
  v_mfma_f32_16x16x32_bf16 v[252:255], v[72:75], v[48:51], v[252:255]
  s_waitcnt lgkmcnt(4)
  v_mfma_f32_16x16x32_bf16 v[96:99], v[76:79], v[52:55], v[96:99]
  ds_read_b64_tr_b16 v[72:73], v9 offset:12288
  v_mfma_f32_16x16x32_bf16 v[100:103], v[76:79], v[56:59], v[100:103]
  ds_read_b64_tr_b16 v[74:75], v9 offset:12800
  v_mfma_f32_16x16x32_bf16 v[104:107], v[76:79], v[60:63], v[104:107]
  v_mfma_f32_16x16x32_bf16 v[108:111], v[76:79], v[64:67], v[108:111]
  s_waitcnt lgkmcnt(4)
  v_smfmac_f32_16x16x64_bf16 v[26:29], v[12:15], v[76:83], v16
  v_mfma_f32_16x16x32_bf16 v[112:115], v[80:83], v[52:55], v[112:115]
  ds_read_b64_tr_b16 v[76:77], v5 offset:12288
  v_mfma_f32_16x16x32_bf16 v[116:119], v[80:83], v[56:59], v[116:119]
  ds_read_b64_tr_b16 v[78:79], v5 offset:12800
  v_mfma_f32_16x16x32_bf16 v[120:123], v[80:83], v[60:63], v[120:123]
  v_mfma_f32_16x16x32_bf16 v[124:127], v[80:83], v[64:67], v[124:127]
  s_waitcnt lgkmcnt(4)
  v_mfma_f32_16x16x32_bf16 v[128:131], v[52:55], v[68:71], v[128:131]
  ds_read_b64_tr_b16 v[80:81], v5 offset:45056
  v_mfma_f32_16x16x32_bf16 v[132:135], v[56:59], v[68:71], v[132:135]
  ds_read_b64_tr_b16 v[82:83], v5 offset:45568
  v_mfma_f32_16x16x32_bf16 v[136:139], v[60:63], v[68:71], v[136:139]
  v_mfma_f32_16x16x32_bf16 v[140:143], v[64:67], v[68:71], v[140:143]
  s_waitcnt lgkmcnt(4)
  v_mfma_f32_16x16x32_bf16 v[144:147], v[52:55], v[72:75], v[144:147]
  s_cmp_lg_u32 s48, 3
  s_cbranch_scc1 L_k1sk_44
  v_smfmac_f32_16x16x64_bf16 v[30:33], v[12:15], v[68:75], v16
L_k1sk_44:
  v_mfma_f32_16x16x32_bf16 v[148:151], v[56:59], v[72:75], v[148:151]
  ds_read_b64_tr_b16 v[68:69], v6 offset:12288
  ds_read_b64_tr_b16 v[70:71], v6 offset:12800
  v_mfma_f32_16x16x32_bf16 v[152:155], v[60:63], v[72:75], v[152:155]
  v_mfma_f32_16x16x32_bf16 v[156:159], v[64:67], v[72:75], v[156:159]
  s_waitcnt lgkmcnt(4)
  v_mfma_f32_16x16x32_bf16 v[160:163], v[76:79], v[52:55], v[160:163]
  ds_read_b64_tr_b16 v[72:73], v6 offset:45056
  v_and_b32 v10, 15, v0
  s_lshl_b32 s3, s49, 10
  s_lshl_b32 s50, s48, 6
  v_mfma_f32_16x16x32_bf16 v[164:167], v[76:79], v[56:59], v[164:167]
  ds_read_b64_tr_b16 v[74:75], v6 offset:45568
  v_lshlrev_b32 v10, 2, v10
  s_add_u32 s3, s3, s50
  s_add_u32 s3, s3, 147456
  v_mfma_f32_16x16x32_bf16 v[168:171], v[76:79], v[60:63], v[168:171]
  v_add_u32 v10, s3, v10
  s_add_u32 s50, s50, 512
  v_mfma_f32_16x16x32_bf16 v[172:175], v[76:79], v[64:67], v[172:175]
  v_add_u32 v11, s50, v10
  s_lshl_b32 s3, s40, 2
  s_add_u32 s3, s3, 149504
  v_mov_b32 v35, s3
  s_waitcnt lgkmcnt(4)
  v_mfma_f32_16x16x32_bf16 v[176:179], v[80:83], v[52:55], v[176:179]
  ds_read_b64_tr_b16 v[76:77], v7 offset:12288
  v_add_f32 v26, v26, v27
  v_add_f32 v28, v28, v29
  v_add_f32 v30, v30, v31
  v_add_f32 v32, v32, v33
  v_mfma_f32_16x16x32_bf16 v[180:183], v[80:83], v[56:59], v[180:183]
  ds_read_b64_tr_b16 v[78:79], v7 offset:12800
  v_mfma_f32_16x16x32_bf16 v[184:187], v[80:83], v[60:63], v[184:187]
  ds_write_b32 v10, v26
  ds_write_b32 v10, v28 offset:256
  v_mfma_f32_16x16x32_bf16 v[188:191], v[80:83], v[64:67], v[188:191]
  ds_write_b32 v11, v30
  ds_write_b32 v11, v32 offset:64
  s_waitcnt lgkmcnt(8)
  v_mfma_f32_16x16x32_bf16 v[192:195], v[68:71], v[52:55], v[192:195]
  ds_read_b64_tr_b16 v[80:81], v7 offset:45056
  v_mfma_f32_16x16x32_bf16 v[196:199], v[68:71], v[56:59], v[196:199]
  ds_read_b64_tr_b16 v[82:83], v7 offset:45568
  v_mfma_f32_16x16x32_bf16 v[200:203], v[68:71], v[60:63], v[200:203]
  v_mfma_f32_16x16x32_bf16 v[204:207], v[68:71], v[64:67], v[204:207]
  s_waitcnt lgkmcnt(8)
  v_mfma_f32_16x16x32_bf16 v[208:211], v[72:75], v[52:55], v[208:211]
  v_mfma_f32_16x16x32_bf16 v[212:215], v[72:75], v[56:59], v[212:215]
  ds_write_b32 v35, v17
  v_mfma_f32_16x16x32_bf16 v[216:219], v[72:75], v[60:63], v[216:219]
  v_mfma_f32_16x16x32_bf16 v[220:223], v[72:75], v[64:67], v[220:223]
  s_waitcnt lgkmcnt(7)
  v_mfma_f32_16x16x32_bf16 v[224:227], v[76:79], v[52:55], v[224:227]
  v_mfma_f32_16x16x32_bf16 v[228:231], v[76:79], v[56:59], v[228:231]
  v_mfma_f32_16x16x32_bf16 v[232:235], v[76:79], v[60:63], v[232:235]
  v_mfma_f32_16x16x32_bf16 v[236:239], v[76:79], v[64:67], v[236:239]
  s_waitcnt lgkmcnt(1)
  v_mfma_f32_16x16x32_bf16 v[240:243], v[80:83], v[52:55], v[240:243]
  v_mfma_f32_16x16x32_bf16 v[244:247], v[80:83], v[56:59], v[244:247]
  v_mfma_f32_16x16x32_bf16 v[248:251], v[80:83], v[60:63], v[248:251]
  v_mfma_f32_16x16x32_bf16 v[252:255], v[80:83], v[64:67], v[252:255]
L_k1_epi:
  v_and_b32 v1, 63, v0
  v_and_b32 v35, 0xfffffff0, v35
L_k1_spin:
  ds_read_b128 v[2:5], v35
  s_waitcnt lgkmcnt(0)
  v_add3_u32 v2, v2, v3, v4
  v_add_u32 v2, v2, v5
  s_nop 0
  v_readfirstlane_b32 s50, v2
  s_cmp_lt_u32 s50, 4
  s_cbranch_scc1 L_k1_spin
  s_cmp_eq_u32 s61, 32
  s_cbranch_scc1 L_k1_have
  v_lshrrev_b32 v91, 5, v1
  v_and_b32 v90, 31, v1
  v_lshlrev_b32 v90, 4, v90
  v_lshl_add_u32 v90, v91, 11, v90
  s_lshl_b32 s3, s48, 17
  v_add_u32 v90, s3, v90
  v_lshlrev_b32 v91, 3, v91
  s_mov_b32 s47, 32
L_k1_slow:
  buffer_load_dwordx4 v[36:39], v90, s[12:15], 0 offen offset:0
  buffer_load_dwordx4 v[40:43], v90, s[12:15], 0 offen offset:512
  buffer_load_dwordx4 v[44:47], v90, s[12:15], 0 offen offset:1024
  buffer_load_dwordx4 v[48:51], v90, s[12:15], 0 offen offset:1536
  s_waitcnt vmcnt(0)
  v_lshlrev_b32 v52, 16, v36
  v_and_b32 v53, 0xffff0000, v36
  v_lshlrev_b32 v54, 16, v37
  v_and_b32 v55, 0xffff0000, v37
  v_lshlrev_b32 v56, 16, v38
  v_and_b32 v57, 0xffff0000, v38
  v_lshlrev_b32 v58, 16, v39
  v_and_b32 v59, 0xffff0000, v39
  v_lshlrev_b32 v60, 16, v40
  v_and_b32 v61, 0xffff0000, v40
  v_lshlrev_b32 v62, 16, v41
  v_and_b32 v63, 0xffff0000, v41
  v_lshlrev_b32 v64, 16, v42
  v_and_b32 v65, 0xffff0000, v42
  v_lshlrev_b32 v66, 16, v43
  v_and_b32 v67, 0xffff0000, v43
  v_lshlrev_b32 v68, 16, v44
  v_and_b32 v69, 0xffff0000, v44
  v_lshlrev_b32 v70, 16, v45
  v_and_b32 v71, 0xffff0000, v45
  v_lshlrev_b32 v72, 16, v46
  v_and_b32 v73, 0xffff0000, v46
  v_lshlrev_b32 v74, 16, v47
  v_and_b32 v75, 0xffff0000, v47
  v_lshlrev_b32 v76, 16, v48
  v_and_b32 v77, 0xffff0000, v48
  v_lshlrev_b32 v78, 16, v49
  v_and_b32 v79, 0xffff0000, v49
  v_lshlrev_b32 v80, 16, v50
  v_and_b32 v81, 0xffff0000, v50
  v_lshlrev_b32 v82, 16, v51
  v_and_b32 v83, 0xffff0000, v51
  v_pk_add_f32 v[84:85], v[52:53], v[54:55]
  v_pk_add_f32 v[86:87], v[56:57], v[58:59]
  v_pk_add_f32 v[84:85], v[84:85], v[60:61]
  v_pk_add_f32 v[86:87], v[86:87], v[62:63]
  v_pk_add_f32 v[84:85], v[84:85], v[64:65]
  v_pk_add_f32 v[86:87], v[86:87], v[66:67]
  v_pk_add_f32 v[84:85], v[84:85], v[68:69]
  v_pk_add_f32 v[86:87], v[86:87], v[70:71]
  v_pk_add_f32 v[84:85], v[84:85], v[72:73]
  v_pk_add_f32 v[86:87], v[86:87], v[74:75]
  v_pk_add_f32 v[84:85], v[84:85], v[76:77]
  v_pk_add_f32 v[86:87], v[86:87], v[78:79]
  v_pk_add_f32 v[84:85], v[84:85], v[80:81]
  v_pk_add_f32 v[86:87], v[86:87], v[82:83]
  v_pk_add_f32 v[84:85], v[84:85], v[86:87]
  v_add_f32 v84, v84, v85
  s_nop 1
  v_add_f32_dpp v84, v84, v84 quad_perm:[1,0,3,2] row_mask:0xf bank_mask:0xf
  s_nop 1
  v_add_f32_dpp v84, v84, v84 quad_perm:[2,3,0,1] row_mask:0xf bank_mask:0xf
  s_nop 1
  v_add_f32_dpp v84, v84, v84 row_half_mirror row_mask:0xf bank_mask:0xf
  s_nop 1
  v_add_f32_dpp v84, v84, v84 row_mirror row_mask:0xf bank_mask:0xf
  s_nop 1
  v_mov_b32 v85, v84
  s_nop 1
  v_permlane16_swap_b32 v84, v85
  s_nop 1
  v_add_f32 v84, v84, v85
  v_mul_f32 v84, 0xba800000, v84
  v_pk_add_f32 v[52:53], v[52:53], v[84:85] op_sel_hi:[1,0]
  v_pk_add_f32 v[54:55], v[54:55], v[84:85] op_sel_hi:[1,0]
  v_pk_add_f32 v[56:57], v[56:57], v[84:85] op_sel_hi:[1,0]
  v_pk_add_f32 v[58:59], v[58:59], v[84:85] op_sel_hi:[1,0]
  v_pk_add_f32 v[60:61], v[60:61], v[84:85] op_sel_hi:[1,0]
  v_pk_add_f32 v[62:63], v[62:63], v[84:85] op_sel_hi:[1,0]
  v_pk_add_f32 v[64:65], v[64:65], v[84:85] op_sel_hi:[1,0]
  v_pk_add_f32 v[66:67], v[66:67], v[84:85] op_sel_hi:[1,0]
  v_pk_add_f32 v[68:69], v[68:69], v[84:85] op_sel_hi:[1,0]
  v_pk_add_f32 v[70:71], v[70:71], v[84:85] op_sel_hi:[1,0]
  v_pk_add_f32 v[72:73], v[72:73], v[84:85] op_sel_hi:[1,0]
  v_pk_add_f32 v[74:75], v[74:75], v[84:85] op_sel_hi:[1,0]
  v_pk_add_f32 v[76:77], v[76:77], v[84:85] op_sel_hi:[1,0]
  v_pk_add_f32 v[78:79], v[78:79], v[84:85] op_sel_hi:[1,0]
  v_pk_add_f32 v[80:81], v[80:81], v[84:85] op_sel_hi:[1,0]
  v_pk_add_f32 v[82:83], v[82:83], v[84:85] op_sel_hi:[1,0]
  v_pk_mul_f32 v[86:87], v[52:53], v[52:53]
  v_pk_mul_f32 v[88:89], v[54:55], v[54:55]
  v_pk_fma_f32 v[86:87], v[56:57], v[56:57], v[86:87]
  v_pk_fma_f32 v[88:89], v[58:59], v[58:59], v[88:89]
  v_pk_fma_f32 v[86:87], v[60:61], v[60:61], v[86:87]
  v_pk_fma_f32 v[88:89], v[62:63], v[62:63], v[88:89]
  v_pk_fma_f32 v[86:87], v[64:65], v[64:65], v[86:87]
  v_pk_fma_f32 v[88:89], v[66:67], v[66:67], v[88:89]
  v_pk_fma_f32 v[86:87], v[68:69], v[68:69], v[86:87]
  v_pk_fma_f32 v[88:89], v[70:71], v[70:71], v[88:89]
  v_pk_fma_f32 v[86:87], v[72:73], v[72:73], v[86:87]
  v_pk_fma_f32 v[88:89], v[74:75], v[74:75], v[88:89]
  v_pk_fma_f32 v[86:87], v[76:77], v[76:77], v[86:87]
  v_pk_fma_f32 v[88:89], v[78:79], v[78:79], v[88:89]
  v_pk_fma_f32 v[86:87], v[80:81], v[80:81], v[86:87]
  v_pk_fma_f32 v[88:89], v[82:83], v[82:83], v[88:89]
  v_pk_add_f32 v[86:87], v[86:87], v[88:89]
  v_add_f32 v86, v86, v87
  s_nop 1
  v_add_f32_dpp v86, v86, v86 quad_perm:[1,0,3,2] row_mask:0xf bank_mask:0xf
  s_nop 1
  v_add_f32_dpp v86, v86, v86 quad_perm:[2,3,0,1] row_mask:0xf bank_mask:0xf
  s_nop 1
  v_add_f32_dpp v86, v86, v86 row_half_mirror row_mask:0xf bank_mask:0xf
  s_nop 1
  v_add_f32_dpp v86, v86, v86 row_mirror row_mask:0xf bank_mask:0xf
  s_nop 1
  v_mov_b32 v87, v86
  s_nop 1
  v_permlane16_swap_b32 v86, v87
  s_nop 1
  v_add_f32 v86, v86, v87
  v_mov_b32 v85, 0x3727c5ac
  v_fmac_f32 v85, 0x3a800000, v86
  v_rsq_f32 v85, v85
  s_mov_b32 exec_lo, 1
  s_mov_b32 exec_hi, 1
  buffer_store_dwordx2 v[84:85], v91, s[36:39], s67 offen sc1
  s_mov_b64 exec, -1
  v_add_u32 v90, 0x1000, v90
  v_add_u32 v91, 16, v91
  s_sub_u32 s47, s47, 1
  s_cmp_lg_u32 s47, 0
  s_cbranch_scc1 L_k1_slow
  s_waitcnt vmcnt(0)
  v_and_b32 v34, 15, v1
  v_lshlrev_b32 v34, 3, v34
  buffer_load_dwordx2 v[18:19], v34, s[36:39], s67 offen offset:0 sc1
  buffer_load_dwordx2 v[20:21], v34, s[36:39], s67 offen offset:128 sc1
  buffer_load_dwordx2 v[22:23], v34, s[36:39], s67 offen offset:256 sc1
  buffer_load_dwordx2 v[24:25], v34, s[36:39], s67 offen offset:384 sc1
  s_waitcnt vmcnt(0)
L_k1_have:
  v_lshrrev_b32 v29, 4, v1
  s_lshl_b32 s3, s49, 10
  s_add_u32 s3, s3, 147456
  s_lshl_b32 s50, s48, 6
  s_add_u32 s50, s50, s3
  v_lshl_add_u32 v30, v29, 4, s50
  ds_read_b128 v[64:67], v30 offset:0
  ds_read_b128 v[68:71], v30 offset:256
  v_xor_b32 v31, 64, v30
  ds_read_b128 v[72:75], v31 offset:0
  ds_read_b128 v[76:79], v31 offset:256
  v_xor_b32 v31, 128, v30
  ds_read_b128 v[80:83], v31 offset:0
  ds_read_b128 v[84:87], v31 offset:256
  v_xor_b32 v31, 192, v30
  ds_read_b128 v[88:91], v31 offset:0
  ds_read_b128 v[92:95], v31 offset:256
  v_lshrrev_b32 v26, 1, v29
  v_lshlrev_b32 v26, 10, v26
  v_and_b32 v31, 1, v29
  v_lshl_add_u32 v26, v31, 9, v26
  v_and_b32 v31, 7, v1
  v_lshl_add_u32 v27, v31, 4, v26
  v_bfe_u32 v31, v1, 3, 1
  v_lshl_add_u32 v26, v31, 7, v27
  v_lshl_add_u32 v27, v31, 8, v27
  s_lshl_b32 s50, s41, 3
  s_lshl_b32 s51, s48, 1
  s_add_u32 s50, s50, s51
  s_bitcmp0_b32 s42, 1
  s_cbranch_scc0 L_k1_nov
  v_lshlrev_b32 v31, 5, v29
  buffer_load_dwordx4 v[32:35], v31, s[36:39], s67 offen offset:0 sc1
  buffer_load_dwordx4 v[36:39], v31, s[36:39], s67 offen offset:16 sc1
  buffer_load_dwordx4 v[40:43], v31, s[36:39], s67 offen offset:128 sc1
  buffer_load_dwordx4 v[44:47], v31, s[36:39], s67 offen offset:144 sc1
  buffer_load_dwordx4 v[48:51], v31, s[36:39], s67 offen offset:256 sc1
  buffer_load_dwordx4 v[52:55], v31, s[36:39], s67 offen offset:272 sc1
  buffer_load_dwordx4 v[56:59], v31, s[36:39], s67 offen offset:384 sc1
  buffer_load_dwordx4 v[60:63], v31, s[36:39], s67 offen offset:400 sc1
L_k1_nov:
  s_and_b32 s3, s42, 3
  s_add_u32 s3, s3, s49
  s_cmp_eq_u32 s3, 4
  s_cbranch_scc1 L_k1_epiB
  s_mul_i32 s52, s50, 224
  s_lshl_b32 s3, s63, 2
  s_add_u32 s52, s52, s3
  s_and_b32 s3, s48, 2
  s_add_u32 s52, s52, s3
  s_lshl_b32 s52, s52, 10
  s_add_u32 s52, s52, 16777216
  s_xor_b32 s53, s52, 2048
  s_add_u32 s54, s52, 229376
  s_add_u32 s55, s53, 229376
  v_mul_f32 v14, v19, v19
  v_mul_f32 v15, v21, v21
  v_mul_f32 v16, v23, v23
  v_mul_f32 v17, v25, v25
  s_waitcnt lgkmcnt(0)
  s_bitcmp1_b32 s48, 0
  s_cbranch_scc1 L_k1_epiA1
  v_pk_fma_f32 v[96:97], v[64:65], v[18:19], v[96:97] op_sel_hi:[1,0,1]
  v_pk_fma_f32 v[98:99], v[66:67], v[18:19], v[98:99] op_sel_hi:[1,0,1]
  v_pk_fma_f32 v[112:113], v[68:69], v[18:19], v[112:113] op_sel_hi:[1,0,1]
  v_pk_fma_f32 v[114:115], v[70:71], v[18:19], v[114:115] op_sel_hi:[1,0,1]
  v_pk_mul_f32 v[96:97], v[96:97], v[112:113]
  v_pk_mul_f32 v[98:99], v[98:99], v[114:115]
  v_mul_f32 v96, v96, v14
  v_mul_f32 v97, v97, v14
  v_mul_f32 v98, v98, v14
  v_mul_f32 v99, v99, v14
  v_cvt_pk_bf16_f32 v2, v96, v97
  v_cvt_pk_bf16_f32 v3, v98, v99
  v_pk_fma_f32 v[160:161], v[72:73], v[18:19], v[160:161] op_sel_hi:[1,0,1]
  v_pk_fma_f32 v[162:163], v[74:75], v[18:19], v[162:163] op_sel_hi:[1,0,1]
  v_pk_fma_f32 v[176:177], v[76:77], v[18:19], v[176:177] op_sel_hi:[1,0,1]
  v_pk_fma_f32 v[178:179], v[78:79], v[18:19], v[178:179] op_sel_hi:[1,0,1]
  v_pk_mul_f32 v[160:161], v[160:161], v[176:177]
  v_pk_mul_f32 v[162:163], v[162:163], v[178:179]
  v_mul_f32 v160, v160, v14
  v_mul_f32 v161, v161, v14
  v_mul_f32 v162, v162, v14
  v_mul_f32 v163, v163, v14
  v_cvt_pk_bf16_f32 v4, v160, v161
  v_cvt_pk_bf16_f32 v5, v162, v163
  buffer_store_dwordx4 v[2:5], v26, s[36:39], s52 offen offset:0 sc1
  v_pk_fma_f32 v[100:101], v[64:65], v[20:21], v[100:101] op_sel_hi:[1,0,1]
  v_pk_fma_f32 v[102:103], v[66:67], v[20:21], v[102:103] op_sel_hi:[1,0,1]
  v_pk_fma_f32 v[116:117], v[68:69], v[20:21], v[116:117] op_sel_hi:[1,0,1]
  v_pk_fma_f32 v[118:119], v[70:71], v[20:21], v[118:119] op_sel_hi:[1,0,1]
  v_pk_mul_f32 v[100:101], v[100:101], v[116:117]
  v_pk_mul_f32 v[102:103], v[102:103], v[118:119]
  v_mul_f32 v100, v100, v15
  v_mul_f32 v101, v101, v15
  v_mul_f32 v102, v102, v15
  v_mul_f32 v103, v103, v15
  v_cvt_pk_bf16_f32 v6, v100, v101
  v_cvt_pk_bf16_f32 v7, v102, v103
  v_pk_fma_f32 v[164:165], v[72:73], v[20:21], v[164:165] op_sel_hi:[1,0,1]
  v_pk_fma_f32 v[166:167], v[74:75], v[20:21], v[166:167] op_sel_hi:[1,0,1]
  v_pk_fma_f32 v[180:181], v[76:77], v[20:21], v[180:181] op_sel_hi:[1,0,1]
  v_pk_fma_f32 v[182:183], v[78:79], v[20:21], v[182:183] op_sel_hi:[1,0,1]
  v_pk_mul_f32 v[164:165], v[164:165], v[180:181]
  v_pk_mul_f32 v[166:167], v[166:167], v[182:183]
  v_mul_f32 v164, v164, v15
  v_mul_f32 v165, v165, v15
  v_mul_f32 v166, v166, v15
  v_mul_f32 v167, v167, v15
  v_cvt_pk_bf16_f32 v8, v164, v165
  v_cvt_pk_bf16_f32 v9, v166, v167
  buffer_store_dwordx4 v[6:9], v26, s[36:39], s52 offen offset:256 sc1
  v_pk_fma_f32 v[104:105], v[64:65], v[22:23], v[104:105] op_sel_hi:[1,0,1]
  v_pk_fma_f32 v[106:107], v[66:67], v[22:23], v[106:107] op_sel_hi:[1,0,1]
  v_pk_fma_f32 v[120:121], v[68:69], v[22:23], v[120:121] op_sel_hi:[1,0,1]
  v_pk_fma_f32 v[122:123], v[70:71], v[22:23], v[122:123] op_sel_hi:[1,0,1]
  v_pk_mul_f32 v[104:105], v[104:105], v[120:121]
  v_pk_mul_f32 v[106:107], v[106:107], v[122:123]
  v_mul_f32 v104, v104, v16
  v_mul_f32 v105, v105, v16
  v_mul_f32 v106, v106, v16
  v_mul_f32 v107, v107, v16
  v_cvt_pk_bf16_f32 v10, v104, v105
  v_cvt_pk_bf16_f32 v11, v106, v107
  v_pk_fma_f32 v[168:169], v[72:73], v[22:23], v[168:169] op_sel_hi:[1,0,1]
  v_pk_fma_f32 v[170:171], v[74:75], v[22:23], v[170:171] op_sel_hi:[1,0,1]
  v_pk_fma_f32 v[184:185], v[76:77], v[22:23], v[184:185] op_sel_hi:[1,0,1]
  v_pk_fma_f32 v[186:187], v[78:79], v[22:23], v[186:187] op_sel_hi:[1,0,1]
  v_pk_mul_f32 v[168:169], v[168:169], v[184:185]
  v_pk_mul_f32 v[170:171], v[170:171], v[186:187]
  v_mul_f32 v168, v168, v16
  v_mul_f32 v169, v169, v16
  v_mul_f32 v170, v170, v16
  v_mul_f32 v171, v171, v16
  v_cvt_pk_bf16_f32 v12, v168, v169
  v_cvt_pk_bf16_f32 v13, v170, v171
  buffer_store_dwordx4 v[10:13], v26, s[36:39], s54 offen offset:0 sc1
  v_pk_fma_f32 v[108:109], v[64:65], v[24:25], v[108:109] op_sel_hi:[1,0,1]
  v_pk_fma_f32 v[110:111], v[66:67], v[24:25], v[110:111] op_sel_hi:[1,0,1]
  v_pk_fma_f32 v[124:125], v[68:69], v[24:25], v[124:125] op_sel_hi:[1,0,1]
  v_pk_fma_f32 v[126:127], v[70:71], v[24:25], v[126:127] op_sel_hi:[1,0,1]
  v_pk_mul_f32 v[108:109], v[108:109], v[124:125]
  v_pk_mul_f32 v[110:111], v[110:111], v[126:127]
  v_mul_f32 v108, v108, v17
  v_mul_f32 v109, v109, v17
  v_mul_f32 v110, v110, v17
  v_mul_f32 v111, v111, v17
  v_cvt_pk_bf16_f32 v2, v108, v109
  v_cvt_pk_bf16_f32 v3, v110, v111
  v_pk_fma_f32 v[172:173], v[72:73], v[24:25], v[172:173] op_sel_hi:[1,0,1]
  v_pk_fma_f32 v[174:175], v[74:75], v[24:25], v[174:175] op_sel_hi:[1,0,1]
  v_pk_fma_f32 v[188:189], v[76:77], v[24:25], v[188:189] op_sel_hi:[1,0,1]
  v_pk_fma_f32 v[190:191], v[78:79], v[24:25], v[190:191] op_sel_hi:[1,0,1]
  v_pk_mul_f32 v[172:173], v[172:173], v[188:189]
  v_pk_mul_f32 v[174:175], v[174:175], v[190:191]
  v_mul_f32 v172, v172, v17
  v_mul_f32 v173, v173, v17
  v_mul_f32 v174, v174, v17
  v_mul_f32 v175, v175, v17
  v_cvt_pk_bf16_f32 v4, v172, v173
  v_cvt_pk_bf16_f32 v5, v174, v175
  buffer_store_dwordx4 v[2:5], v26, s[36:39], s54 offen offset:256 sc1
  v_pk_fma_f32 v[192:193], v[80:81], v[18:19], v[192:193] op_sel_hi:[1,0,1]
  v_pk_fma_f32 v[194:195], v[82:83], v[18:19], v[194:195] op_sel_hi:[1,0,1]
  v_pk_fma_f32 v[208:209], v[84:85], v[18:19], v[208:209] op_sel_hi:[1,0,1]
  v_pk_fma_f32 v[210:211], v[86:87], v[18:19], v[210:211] op_sel_hi:[1,0,1]
  v_pk_mul_f32 v[192:193], v[192:193], v[208:209]
  v_pk_mul_f32 v[194:195], v[194:195], v[210:211]
  v_mul_f32 v192, v192, v14
  v_mul_f32 v193, v193, v14
  v_mul_f32 v194, v194, v14
  v_mul_f32 v195, v195, v14
  v_cvt_pk_bf16_f32 v6, v192, v193
  v_cvt_pk_bf16_f32 v7, v194, v195
  v_pk_fma_f32 v[224:225], v[88:89], v[18:19], v[224:225] op_sel_hi:[1,0,1]
  v_pk_fma_f32 v[226:227], v[90:91], v[18:19], v[226:227] op_sel_hi:[1,0,1]
  v_pk_fma_f32 v[240:241], v[92:93], v[18:19], v[240:241] op_sel_hi:[1,0,1]
  v_pk_fma_f32 v[242:243], v[94:95], v[18:19], v[242:243] op_sel_hi:[1,0,1]
  v_pk_mul_f32 v[224:225], v[224:225], v[240:241]
  v_pk_mul_f32 v[226:227], v[226:227], v[242:243]
  v_mul_f32 v224, v224, v14
  v_mul_f32 v225, v225, v14
  v_mul_f32 v226, v226, v14
  v_mul_f32 v227, v227, v14
  v_cvt_pk_bf16_f32 v8, v224, v225
  v_cvt_pk_bf16_f32 v9, v226, v227
  buffer_store_dwordx4 v[6:9], v26, s[36:39], s53 offen offset:0 sc1
  v_pk_fma_f32 v[196:197], v[80:81], v[20:21], v[196:197] op_sel_hi:[1,0,1]
  v_pk_fma_f32 v[198:199], v[82:83], v[20:21], v[198:199] op_sel_hi:[1,0,1]
  v_pk_fma_f32 v[212:213], v[84:85], v[20:21], v[212:213] op_sel_hi:[1,0,1]
  v_pk_fma_f32 v[214:215], v[86:87], v[20:21], v[214:215] op_sel_hi:[1,0,1]
  v_pk_mul_f32 v[196:197], v[196:197], v[212:213]
  v_pk_mul_f32 v[198:199], v[198:199], v[214:215]
  v_mul_f32 v196, v196, v15
  v_mul_f32 v197, v197, v15
  v_mul_f32 v198, v198, v15
  v_mul_f32 v199, v199, v15
  v_cvt_pk_bf16_f32 v10, v196, v197
  v_cvt_pk_bf16_f32 v11, v198, v199
  v_pk_fma_f32 v[228:229], v[88:89], v[20:21], v[228:229] op_sel_hi:[1,0,1]
  v_pk_fma_f32 v[230:231], v[90:91], v[20:21], v[230:231] op_sel_hi:[1,0,1]
  v_pk_fma_f32 v[244:245], v[92:93], v[20:21], v[244:245] op_sel_hi:[1,0,1]
  v_pk_fma_f32 v[246:247], v[94:95], v[20:21], v[246:247] op_sel_hi:[1,0,1]
  v_pk_mul_f32 v[228:229], v[228:229], v[244:245]
  v_pk_mul_f32 v[230:231], v[230:231], v[246:247]
  v_mul_f32 v228, v228, v15
  v_mul_f32 v229, v229, v15
  v_mul_f32 v230, v230, v15
  v_mul_f32 v231, v231, v15
  v_cvt_pk_bf16_f32 v12, v228, v229
  v_cvt_pk_bf16_f32 v13, v230, v231
  buffer_store_dwordx4 v[10:13], v26, s[36:39], s53 offen offset:256 sc1
  v_pk_fma_f32 v[200:201], v[80:81], v[22:23], v[200:201] op_sel_hi:[1,0,1]
  v_pk_fma_f32 v[202:203], v[82:83], v[22:23], v[202:203] op_sel_hi:[1,0,1]
  v_pk_fma_f32 v[216:217], v[84:85], v[22:23], v[216:217] op_sel_hi:[1,0,1]
  v_pk_fma_f32 v[218:219], v[86:87], v[22:23], v[218:219] op_sel_hi:[1,0,1]
  v_pk_mul_f32 v[200:201], v[200:201], v[216:217]
  v_pk_mul_f32 v[202:203], v[202:203], v[218:219]
  v_mul_f32 v200, v200, v16
  v_mul_f32 v201, v201, v16
  v_mul_f32 v202, v202, v16
  v_mul_f32 v203, v203, v16
  v_cvt_pk_bf16_f32 v2, v200, v201
  v_cvt_pk_bf16_f32 v3, v202, v203
  v_pk_fma_f32 v[232:233], v[88:89], v[22:23], v[232:233] op_sel_hi:[1,0,1]
  v_pk_fma_f32 v[234:235], v[90:91], v[22:23], v[234:235] op_sel_hi:[1,0,1]
  v_pk_fma_f32 v[248:249], v[92:93], v[22:23], v[248:249] op_sel_hi:[1,0,1]
  v_pk_fma_f32 v[250:251], v[94:95], v[22:23], v[250:251] op_sel_hi:[1,0,1]
  v_pk_mul_f32 v[232:233], v[232:233], v[248:249]
  v_pk_mul_f32 v[234:235], v[234:235], v[250:251]
  v_mul_f32 v232, v232, v16
  v_mul_f32 v233, v233, v16
  v_mul_f32 v234, v234, v16
  v_mul_f32 v235, v235, v16
  v_cvt_pk_bf16_f32 v4, v232, v233
  v_cvt_pk_bf16_f32 v5, v234, v235
  buffer_store_dwordx4 v[2:5], v26, s[36:39], s55 offen offset:0 sc1
  v_pk_fma_f32 v[204:205], v[80:81], v[24:25], v[204:205] op_sel_hi:[1,0,1]
  v_pk_fma_f32 v[206:207], v[82:83], v[24:25], v[206:207] op_sel_hi:[1,0,1]
  v_pk_fma_f32 v[220:221], v[84:85], v[24:25], v[220:221] op_sel_hi:[1,0,1]
  v_pk_fma_f32 v[222:223], v[86:87], v[24:25], v[222:223] op_sel_hi:[1,0,1]
  v_pk_mul_f32 v[204:205], v[204:205], v[220:221]
  v_pk_mul_f32 v[206:207], v[206:207], v[222:223]
  v_mul_f32 v204, v204, v17
  v_mul_f32 v205, v205, v17
  v_mul_f32 v206, v206, v17
  v_mul_f32 v207, v207, v17
  v_cvt_pk_bf16_f32 v6, v204, v205
  v_cvt_pk_bf16_f32 v7, v206, v207
  v_pk_fma_f32 v[236:237], v[88:89], v[24:25], v[236:237] op_sel_hi:[1,0,1]
  v_pk_fma_f32 v[238:239], v[90:91], v[24:25], v[238:239] op_sel_hi:[1,0,1]
  v_pk_fma_f32 v[252:253], v[92:93], v[24:25], v[252:253] op_sel_hi:[1,0,1]
  v_pk_fma_f32 v[254:255], v[94:95], v[24:25], v[254:255] op_sel_hi:[1,0,1]
  v_pk_mul_f32 v[236:237], v[236:237], v[252:253]
  v_pk_mul_f32 v[238:239], v[238:239], v[254:255]
  v_mul_f32 v236, v236, v17
  v_mul_f32 v237, v237, v17
  v_mul_f32 v238, v238, v17
  v_mul_f32 v239, v239, v17
  v_cvt_pk_bf16_f32 v8, v236, v237
  v_cvt_pk_bf16_f32 v9, v238, v239
  buffer_store_dwordx4 v[6:9], v26, s[36:39], s55 offen offset:256 sc1
  s_branch L_k1_p0
L_k1_epiA1:
  v_pk_fma_f32 v[160:161], v[72:73], v[18:19], v[160:161] op_sel_hi:[1,0,1]
  v_pk_fma_f32 v[162:163], v[74:75], v[18:19], v[162:163] op_sel_hi:[1,0,1]
  v_pk_fma_f32 v[176:177], v[76:77], v[18:19], v[176:177] op_sel_hi:[1,0,1]
  v_pk_fma_f32 v[178:179], v[78:79], v[18:19], v[178:179] op_sel_hi:[1,0,1]
  v_pk_mul_f32 v[160:161], v[160:161], v[176:177]
  v_pk_mul_f32 v[162:163], v[162:163], v[178:179]
  v_mul_f32 v160, v160, v14
  v_mul_f32 v161, v161, v14
  v_mul_f32 v162, v162, v14
  v_mul_f32 v163, v163, v14
  v_cvt_pk_bf16_f32 v10, v160, v161
  v_cvt_pk_bf16_f32 v11, v162, v163
  v_pk_fma_f32 v[96:97], v[64:65], v[18:19], v[96:97] op_sel_hi:[1,0,1]
  v_pk_fma_f32 v[98:99], v[66:67], v[18:19], v[98:99] op_sel_hi:[1,0,1]
  v_pk_fma_f32 v[112:113], v[68:69], v[18:19], v[112:113] op_sel_hi:[1,0,1]
  v_pk_fma_f32 v[114:115], v[70:71], v[18:19], v[114:115] op_sel_hi:[1,0,1]
  v_pk_mul_f32 v[96:97], v[96:97], v[112:113]
  v_pk_mul_f32 v[98:99], v[98:99], v[114:115]
  v_mul_f32 v96, v96, v14
  v_mul_f32 v97, v97, v14
  v_mul_f32 v98, v98, v14
  v_mul_f32 v99, v99, v14
  v_cvt_pk_bf16_f32 v12, v96, v97
  v_cvt_pk_bf16_f32 v13, v98, v99
  buffer_store_dwordx4 v[10:13], v26, s[36:39], s52 offen offset:0 sc1
  v_pk_fma_f32 v[164:165], v[72:73], v[20:21], v[164:165] op_sel_hi:[1,0,1]
  v_pk_fma_f32 v[166:167], v[74:75], v[20:21], v[166:167] op_sel_hi:[1,0,1]
  v_pk_fma_f32 v[180:181], v[76:77], v[20:21], v[180:181] op_sel_hi:[1,0,1]
  v_pk_fma_f32 v[182:183], v[78:79], v[20:21], v[182:183] op_sel_hi:[1,0,1]
  v_pk_mul_f32 v[164:165], v[164:165], v[180:181]
  v_pk_mul_f32 v[166:167], v[166:167], v[182:183]
  v_mul_f32 v164, v164, v15
  v_mul_f32 v165, v165, v15
  v_mul_f32 v166, v166, v15
  v_mul_f32 v167, v167, v15
  v_cvt_pk_bf16_f32 v2, v164, v165
  v_cvt_pk_bf16_f32 v3, v166, v167
  v_pk_fma_f32 v[100:101], v[64:65], v[20:21], v[100:101] op_sel_hi:[1,0,1]
  v_pk_fma_f32 v[102:103], v[66:67], v[20:21], v[102:103] op_sel_hi:[1,0,1]
  v_pk_fma_f32 v[116:117], v[68:69], v[20:21], v[116:117] op_sel_hi:[1,0,1]
  v_pk_fma_f32 v[118:119], v[70:71], v[20:21], v[118:119] op_sel_hi:[1,0,1]
  v_pk_mul_f32 v[100:101], v[100:101], v[116:117]
  v_pk_mul_f32 v[102:103], v[102:103], v[118:119]
  v_mul_f32 v100, v100, v15
  v_mul_f32 v101, v101, v15
  v_mul_f32 v102, v102, v15
  v_mul_f32 v103, v103, v15
  v_cvt_pk_bf16_f32 v4, v100, v101
  v_cvt_pk_bf16_f32 v5, v102, v103
  buffer_store_dwordx4 v[2:5], v26, s[36:39], s52 offen offset:256 sc1
  v_pk_fma_f32 v[168:169], v[72:73], v[22:23], v[168:169] op_sel_hi:[1,0,1]
  v_pk_fma_f32 v[170:171], v[74:75], v[22:23], v[170:171] op_sel_hi:[1,0,1]
  v_pk_fma_f32 v[184:185], v[76:77], v[22:23], v[184:185] op_sel_hi:[1,0,1]
  v_pk_fma_f32 v[186:187], v[78:79], v[22:23], v[186:187] op_sel_hi:[1,0,1]
  v_pk_mul_f32 v[168:169], v[168:169], v[184:185]
  v_pk_mul_f32 v[170:171], v[170:171], v[186:187]
  v_mul_f32 v168, v168, v16
  v_mul_f32 v169, v169, v16
  v_mul_f32 v170, v170, v16
  v_mul_f32 v171, v171, v16
  v_cvt_pk_bf16_f32 v6, v168, v169
  v_cvt_pk_bf16_f32 v7, v170, v171
  v_pk_fma_f32 v[104:105], v[64:65], v[22:23], v[104:105] op_sel_hi:[1,0,1]
  v_pk_fma_f32 v[106:107], v[66:67], v[22:23], v[106:107] op_sel_hi:[1,0,1]
  v_pk_fma_f32 v[120:121], v[68:69], v[22:23], v[120:121] op_sel_hi:[1,0,1]
  v_pk_fma_f32 v[122:123], v[70:71], v[22:23], v[122:123] op_sel_hi:[1,0,1]
  v_pk_mul_f32 v[104:105], v[104:105], v[120:121]
  v_pk_mul_f32 v[106:107], v[106:107], v[122:123]
  v_mul_f32 v104, v104, v16
  v_mul_f32 v105, v105, v16
  v_mul_f32 v106, v106, v16
  v_mul_f32 v107, v107, v16
  v_cvt_pk_bf16_f32 v8, v104, v105
  v_cvt_pk_bf16_f32 v9, v106, v107
  buffer_store_dwordx4 v[6:9], v26, s[36:39], s54 offen offset:0 sc1
  v_pk_fma_f32 v[172:173], v[72:73], v[24:25], v[172:173] op_sel_hi:[1,0,1]
  v_pk_fma_f32 v[174:175], v[74:75], v[24:25], v[174:175] op_sel_hi:[1,0,1]
  v_pk_fma_f32 v[188:189], v[76:77], v[24:25], v[188:189] op_sel_hi:[1,0,1]
  v_pk_fma_f32 v[190:191], v[78:79], v[24:25], v[190:191] op_sel_hi:[1,0,1]
  v_pk_mul_f32 v[172:173], v[172:173], v[188:189]
  v_pk_mul_f32 v[174:175], v[174:175], v[190:191]
  v_mul_f32 v172, v172, v17
  v_mul_f32 v173, v173, v17
  v_mul_f32 v174, v174, v17
  v_mul_f32 v175, v175, v17
  v_cvt_pk_bf16_f32 v10, v172, v173
  v_cvt_pk_bf16_f32 v11, v174, v175
  v_pk_fma_f32 v[108:109], v[64:65], v[24:25], v[108:109] op_sel_hi:[1,0,1]
  v_pk_fma_f32 v[110:111], v[66:67], v[24:25], v[110:111] op_sel_hi:[1,0,1]
  v_pk_fma_f32 v[124:125], v[68:69], v[24:25], v[124:125] op_sel_hi:[1,0,1]
  v_pk_fma_f32 v[126:127], v[70:71], v[24:25], v[126:127] op_sel_hi:[1,0,1]
  v_pk_mul_f32 v[108:109], v[108:109], v[124:125]
  v_pk_mul_f32 v[110:111], v[110:111], v[126:127]
  v_mul_f32 v108, v108, v17
  v_mul_f32 v109, v109, v17
  v_mul_f32 v110, v110, v17
  v_mul_f32 v111, v111, v17
  v_cvt_pk_bf16_f32 v12, v108, v109
  v_cvt_pk_bf16_f32 v13, v110, v111
  buffer_store_dwordx4 v[10:13], v26, s[36:39], s54 offen offset:256 sc1
  v_pk_fma_f32 v[224:225], v[88:89], v[18:19], v[224:225] op_sel_hi:[1,0,1]
  v_pk_fma_f32 v[226:227], v[90:91], v[18:19], v[226:227] op_sel_hi:[1,0,1]
  v_pk_fma_f32 v[240:241], v[92:93], v[18:19], v[240:241] op_sel_hi:[1,0,1]
  v_pk_fma_f32 v[242:243], v[94:95], v[18:19], v[242:243] op_sel_hi:[1,0,1]
  v_pk_mul_f32 v[224:225], v[224:225], v[240:241]
  v_pk_mul_f32 v[226:227], v[226:227], v[242:243]
  v_mul_f32 v224, v224, v14
  v_mul_f32 v225, v225, v14
  v_mul_f32 v226, v226, v14
  v_mul_f32 v227, v227, v14
  v_cvt_pk_bf16_f32 v2, v224, v225
  v_cvt_pk_bf16_f32 v3, v226, v227
  v_pk_fma_f32 v[192:193], v[80:81], v[18:19], v[192:193] op_sel_hi:[1,0,1]
  v_pk_fma_f32 v[194:195], v[82:83], v[18:19], v[194:195] op_sel_hi:[1,0,1]
  v_pk_fma_f32 v[208:209], v[84:85], v[18:19], v[208:209] op_sel_hi:[1,0,1]
  v_pk_fma_f32 v[210:211], v[86:87], v[18:19], v[210:211] op_sel_hi:[1,0,1]
  v_pk_mul_f32 v[192:193], v[192:193], v[208:209]
  v_pk_mul_f32 v[194:195], v[194:195], v[210:211]
  v_mul_f32 v192, v192, v14
  v_mul_f32 v193, v193, v14
  v_mul_f32 v194, v194, v14
  v_mul_f32 v195, v195, v14
  v_cvt_pk_bf16_f32 v4, v192, v193
  v_cvt_pk_bf16_f32 v5, v194, v195
  buffer_store_dwordx4 v[2:5], v26, s[36:39], s53 offen offset:0 sc1
  v_pk_fma_f32 v[228:229], v[88:89], v[20:21], v[228:229] op_sel_hi:[1,0,1]
  v_pk_fma_f32 v[230:231], v[90:91], v[20:21], v[230:231] op_sel_hi:[1,0,1]
  v_pk_fma_f32 v[244:245], v[92:93], v[20:21], v[244:245] op_sel_hi:[1,0,1]
  v_pk_fma_f32 v[246:247], v[94:95], v[20:21], v[246:247] op_sel_hi:[1,0,1]
  v_pk_mul_f32 v[228:229], v[228:229], v[244:245]
  v_pk_mul_f32 v[230:231], v[230:231], v[246:247]
  v_mul_f32 v228, v228, v15
  v_mul_f32 v229, v229, v15
  v_mul_f32 v230, v230, v15
  v_mul_f32 v231, v231, v15
  v_cvt_pk_bf16_f32 v6, v228, v229
  v_cvt_pk_bf16_f32 v7, v230, v231
  v_pk_fma_f32 v[196:197], v[80:81], v[20:21], v[196:197] op_sel_hi:[1,0,1]
  v_pk_fma_f32 v[198:199], v[82:83], v[20:21], v[198:199] op_sel_hi:[1,0,1]
  v_pk_fma_f32 v[212:213], v[84:85], v[20:21], v[212:213] op_sel_hi:[1,0,1]
  v_pk_fma_f32 v[214:215], v[86:87], v[20:21], v[214:215] op_sel_hi:[1,0,1]
  v_pk_mul_f32 v[196:197], v[196:197], v[212:213]
  v_pk_mul_f32 v[198:199], v[198:199], v[214:215]
  v_mul_f32 v196, v196, v15
  v_mul_f32 v197, v197, v15
  v_mul_f32 v198, v198, v15
  v_mul_f32 v199, v199, v15
  v_cvt_pk_bf16_f32 v8, v196, v197
  v_cvt_pk_bf16_f32 v9, v198, v199
  buffer_store_dwordx4 v[6:9], v26, s[36:39], s53 offen offset:256 sc1
  v_pk_fma_f32 v[232:233], v[88:89], v[22:23], v[232:233] op_sel_hi:[1,0,1]
  v_pk_fma_f32 v[234:235], v[90:91], v[22:23], v[234:235] op_sel_hi:[1,0,1]
  v_pk_fma_f32 v[248:249], v[92:93], v[22:23], v[248:249] op_sel_hi:[1,0,1]
  v_pk_fma_f32 v[250:251], v[94:95], v[22:23], v[250:251] op_sel_hi:[1,0,1]
  v_pk_mul_f32 v[232:233], v[232:233], v[248:249]
  v_pk_mul_f32 v[234:235], v[234:235], v[250:251]
  v_mul_f32 v232, v232, v16
  v_mul_f32 v233, v233, v16
  v_mul_f32 v234, v234, v16
  v_mul_f32 v235, v235, v16
  v_cvt_pk_bf16_f32 v10, v232, v233
  v_cvt_pk_bf16_f32 v11, v234, v235
  v_pk_fma_f32 v[200:201], v[80:81], v[22:23], v[200:201] op_sel_hi:[1,0,1]
  v_pk_fma_f32 v[202:203], v[82:83], v[22:23], v[202:203] op_sel_hi:[1,0,1]
  v_pk_fma_f32 v[216:217], v[84:85], v[22:23], v[216:217] op_sel_hi:[1,0,1]
  v_pk_fma_f32 v[218:219], v[86:87], v[22:23], v[218:219] op_sel_hi:[1,0,1]
  v_pk_mul_f32 v[200:201], v[200:201], v[216:217]
  v_pk_mul_f32 v[202:203], v[202:203], v[218:219]
  v_mul_f32 v200, v200, v16
  v_mul_f32 v201, v201, v16
  v_mul_f32 v202, v202, v16
  v_mul_f32 v203, v203, v16
  v_cvt_pk_bf16_f32 v12, v200, v201
  v_cvt_pk_bf16_f32 v13, v202, v203
  buffer_store_dwordx4 v[10:13], v26, s[36:39], s55 offen offset:0 sc1
  v_pk_fma_f32 v[236:237], v[88:89], v[24:25], v[236:237] op_sel_hi:[1,0,1]
  v_pk_fma_f32 v[238:239], v[90:91], v[24:25], v[238:239] op_sel_hi:[1,0,1]
  v_pk_fma_f32 v[252:253], v[92:93], v[24:25], v[252:253] op_sel_hi:[1,0,1]
  v_pk_fma_f32 v[254:255], v[94:95], v[24:25], v[254:255] op_sel_hi:[1,0,1]
  v_pk_mul_f32 v[236:237], v[236:237], v[252:253]
  v_pk_mul_f32 v[238:239], v[238:239], v[254:255]
  v_mul_f32 v236, v236, v17
  v_mul_f32 v237, v237, v17
  v_mul_f32 v238, v238, v17
  v_mul_f32 v239, v239, v17
  v_cvt_pk_bf16_f32 v2, v236, v237
  v_cvt_pk_bf16_f32 v3, v238, v239
  v_pk_fma_f32 v[204:205], v[80:81], v[24:25], v[204:205] op_sel_hi:[1,0,1]
  v_pk_fma_f32 v[206:207], v[82:83], v[24:25], v[206:207] op_sel_hi:[1,0,1]
  v_pk_fma_f32 v[220:221], v[84:85], v[24:25], v[220:221] op_sel_hi:[1,0,1]
  v_pk_fma_f32 v[222:223], v[86:87], v[24:25], v[222:223] op_sel_hi:[1,0,1]
  v_pk_mul_f32 v[204:205], v[204:205], v[220:221]
  v_pk_mul_f32 v[206:207], v[206:207], v[222:223]
  v_mul_f32 v204, v204, v17
  v_mul_f32 v205, v205, v17
  v_mul_f32 v206, v206, v17
  v_mul_f32 v207, v207, v17
  v_cvt_pk_bf16_f32 v4, v204, v205
  v_cvt_pk_bf16_f32 v5, v206, v207
  buffer_store_dwordx4 v[2:5], v26, s[36:39], s55 offen offset:256 sc1
  s_branch L_k1_p0
L_k1_epiB:
  s_waitcnt lgkmcnt(0)
  s_bitcmp1_b32 s48, 0
  s_cbranch_scc1 L_k1_epiB1
  s_add_u32 s62, s60, 1
  s_lshl_b32 s62, s62, 1
  s_lshr_b32 s3, s48, 1
  s_xor_b32 s3, s3, 0
  s_add_u32 s62, s62, s3
  s_and_b32 s56, s62, 31
  s_lshr_b32 s57, s62, 5
  s_lshl_b32 s58, s56, 6
  s_add_u32 s58, s58, s50
  s_cmp_eq_u32 s57, 0
  s_cselect_b32 s53, 1, 2
  s_cselect_b32 s54, 1048744942, 1.0
  s_lshl_b32 s52, s53, 22
  s_lshl_b32 s53, s53, 11
  s_mul_i32 s58, s58, s53
  s_add_u32 s52, s52, s58
  s_cmp_eq_u32 s57, 2
  s_cselect_b32 s58, 2048, 0
  s_add_u32 s52, s52, s58
  s_cmp_eq_u32 s57, 1
  s_cselect_b32 s51, 32, 64
  s_cselect_b64 s[64:65], -1, 0
  s_lshl_b32 s51, s51, 2
  v_cndmask_b32 v28, v26, v27, s[64:65]
  v_mul_f32 v14, s54, v19
  v_mul_f32 v15, s54, v21
  v_mul_f32 v16, s54, v23
  v_mul_f32 v17, s54, v25
  v_pk_fma_f32 v[96:97], v[64:65], v[18:19], v[96:97] op_sel_hi:[1,0,1]
  v_pk_fma_f32 v[98:99], v[66:67], v[18:19], v[98:99] op_sel_hi:[1,0,1]
  v_mul_f32 v96, v96, v14
  v_mul_f32 v97, v97, v14
  v_mul_f32 v98, v98, v14
  v_mul_f32 v99, v99, v14
  v_cvt_pk_bf16_f32 v6, v96, v97
  v_cvt_pk_bf16_f32 v7, v98, v99
  v_pk_fma_f32 v[160:161], v[72:73], v[18:19], v[160:161] op_sel_hi:[1,0,1]
  v_pk_fma_f32 v[162:163], v[74:75], v[18:19], v[162:163] op_sel_hi:[1,0,1]
  v_mul_f32 v160, v160, v14
  v_mul_f32 v161, v161, v14
  v_mul_f32 v162, v162, v14
  v_mul_f32 v163, v163, v14
  v_cvt_pk_bf16_f32 v8, v160, v161
  v_cvt_pk_bf16_f32 v9, v162, v163
  buffer_store_dwordx4 v[6:9], v28, s[36:39], s52 offen sc1
  v_pk_fma_f32 v[100:101], v[64:65], v[20:21], v[100:101] op_sel_hi:[1,0,1]
  v_pk_fma_f32 v[102:103], v[66:67], v[20:21], v[102:103] op_sel_hi:[1,0,1]
  v_mul_f32 v100, v100, v15
  v_mul_f32 v101, v101, v15
  v_mul_f32 v102, v102, v15
  v_mul_f32 v103, v103, v15
  v_cvt_pk_bf16_f32 v10, v100, v101
  v_cvt_pk_bf16_f32 v11, v102, v103
  v_pk_fma_f32 v[164:165], v[72:73], v[20:21], v[164:165] op_sel_hi:[1,0,1]
  v_pk_fma_f32 v[166:167], v[74:75], v[20:21], v[166:167] op_sel_hi:[1,0,1]
  v_mul_f32 v164, v164, v15
  v_mul_f32 v165, v165, v15
  v_mul_f32 v166, v166, v15
  v_mul_f32 v167, v167, v15
  v_cvt_pk_bf16_f32 v12, v164, v165
  v_cvt_pk_bf16_f32 v13, v166, v167
  s_add_u32 s58, s52, s51
  buffer_store_dwordx4 v[10:13], v28, s[36:39], s58 offen sc1
  s_add_u32 s52, s52, s53
  v_pk_fma_f32 v[104:105], v[64:65], v[22:23], v[104:105] op_sel_hi:[1,0,1]
  v_pk_fma_f32 v[106:107], v[66:67], v[22:23], v[106:107] op_sel_hi:[1,0,1]
  v_mul_f32 v104, v104, v16
  v_mul_f32 v105, v105, v16
  v_mul_f32 v106, v106, v16
  v_mul_f32 v107, v107, v16
  v_cvt_pk_bf16_f32 v2, v104, v105
  v_cvt_pk_bf16_f32 v3, v106, v107
  v_pk_fma_f32 v[168:169], v[72:73], v[22:23], v[168:169] op_sel_hi:[1,0,1]
  v_pk_fma_f32 v[170:171], v[74:75], v[22:23], v[170:171] op_sel_hi:[1,0,1]
  v_mul_f32 v168, v168, v16
  v_mul_f32 v169, v169, v16
  v_mul_f32 v170, v170, v16
  v_mul_f32 v171, v171, v16
  v_cvt_pk_bf16_f32 v4, v168, v169
  v_cvt_pk_bf16_f32 v5, v170, v171
  buffer_store_dwordx4 v[2:5], v28, s[36:39], s52 offen sc1
  v_pk_fma_f32 v[108:109], v[64:65], v[24:25], v[108:109] op_sel_hi:[1,0,1]
  v_pk_fma_f32 v[110:111], v[66:67], v[24:25], v[110:111] op_sel_hi:[1,0,1]
  v_mul_f32 v108, v108, v17
  v_mul_f32 v109, v109, v17
  v_mul_f32 v110, v110, v17
  v_mul_f32 v111, v111, v17
  v_cvt_pk_bf16_f32 v6, v108, v109
  v_cvt_pk_bf16_f32 v7, v110, v111
  v_pk_fma_f32 v[172:173], v[72:73], v[24:25], v[172:173] op_sel_hi:[1,0,1]
  v_pk_fma_f32 v[174:175], v[74:75], v[24:25], v[174:175] op_sel_hi:[1,0,1]
  v_mul_f32 v172, v172, v17
  v_mul_f32 v173, v173, v17
  v_mul_f32 v174, v174, v17
  v_mul_f32 v175, v175, v17
  v_cvt_pk_bf16_f32 v8, v172, v173
  v_cvt_pk_bf16_f32 v9, v174, v175
  s_add_u32 s58, s52, s51
  buffer_store_dwordx4 v[6:9], v28, s[36:39], s58 offen sc1
  s_add_u32 s62, s60, 1
  s_lshl_b32 s62, s62, 1
  s_lshr_b32 s3, s48, 1
  s_xor_b32 s3, s3, 1
  s_add_u32 s62, s62, s3
  s_and_b32 s56, s62, 31
  s_lshr_b32 s57, s62, 5
  s_lshl_b32 s58, s56, 6
  s_add_u32 s58, s58, s50
  s_cmp_eq_u32 s57, 0
  s_cselect_b32 s53, 1, 2
  s_cselect_b32 s54, 1048744942, 1.0
  s_lshl_b32 s52, s53, 22
  s_lshl_b32 s53, s53, 11
  s_mul_i32 s58, s58, s53
  s_add_u32 s52, s52, s58
  s_cmp_eq_u32 s57, 2
  s_cselect_b32 s58, 2048, 0
  s_add_u32 s52, s52, s58
  s_cmp_eq_u32 s57, 1
  s_cselect_b32 s51, 32, 64
  s_cselect_b64 s[64:65], -1, 0
  s_lshl_b32 s51, s51, 2
  v_cndmask_b32 v28, v26, v27, s[64:65]
  v_mul_f32 v14, s54, v19
  v_mul_f32 v15, s54, v21
  v_mul_f32 v16, s54, v23
  v_mul_f32 v17, s54, v25
  v_pk_fma_f32 v[192:193], v[80:81], v[18:19], v[192:193] op_sel_hi:[1,0,1]
  v_pk_fma_f32 v[194:195], v[82:83], v[18:19], v[194:195] op_sel_hi:[1,0,1]
  v_mul_f32 v192, v192, v14
  v_mul_f32 v193, v193, v14
  v_mul_f32 v194, v194, v14
  v_mul_f32 v195, v195, v14
  v_cvt_pk_bf16_f32 v10, v192, v193
  v_cvt_pk_bf16_f32 v11, v194, v195
  v_pk_fma_f32 v[224:225], v[88:89], v[18:19], v[224:225] op_sel_hi:[1,0,1]
  v_pk_fma_f32 v[226:227], v[90:91], v[18:19], v[226:227] op_sel_hi:[1,0,1]
  v_mul_f32 v224, v224, v14
  v_mul_f32 v225, v225, v14
  v_mul_f32 v226, v226, v14
  v_mul_f32 v227, v227, v14
  v_cvt_pk_bf16_f32 v12, v224, v225
  v_cvt_pk_bf16_f32 v13, v226, v227
  buffer_store_dwordx4 v[10:13], v28, s[36:39], s52 offen sc1
  v_pk_fma_f32 v[196:197], v[80:81], v[20:21], v[196:197] op_sel_hi:[1,0,1]
  v_pk_fma_f32 v[198:199], v[82:83], v[20:21], v[198:199] op_sel_hi:[1,0,1]
  v_mul_f32 v196, v196, v15
  v_mul_f32 v197, v197, v15
  v_mul_f32 v198, v198, v15
  v_mul_f32 v199, v199, v15
  v_cvt_pk_bf16_f32 v2, v196, v197
  v_cvt_pk_bf16_f32 v3, v198, v199
  v_pk_fma_f32 v[228:229], v[88:89], v[20:21], v[228:229] op_sel_hi:[1,0,1]
  v_pk_fma_f32 v[230:231], v[90:91], v[20:21], v[230:231] op_sel_hi:[1,0,1]
  v_mul_f32 v228, v228, v15
  v_mul_f32 v229, v229, v15
  v_mul_f32 v230, v230, v15
  v_mul_f32 v231, v231, v15
  v_cvt_pk_bf16_f32 v4, v228, v229
  v_cvt_pk_bf16_f32 v5, v230, v231
  s_add_u32 s58, s52, s51
  buffer_store_dwordx4 v[2:5], v28, s[36:39], s58 offen sc1
  s_add_u32 s52, s52, s53
  v_pk_fma_f32 v[200:201], v[80:81], v[22:23], v[200:201] op_sel_hi:[1,0,1]
  v_pk_fma_f32 v[202:203], v[82:83], v[22:23], v[202:203] op_sel_hi:[1,0,1]
  v_mul_f32 v200, v200, v16
  v_mul_f32 v201, v201, v16
  v_mul_f32 v202, v202, v16
  v_mul_f32 v203, v203, v16
  v_cvt_pk_bf16_f32 v6, v200, v201
  v_cvt_pk_bf16_f32 v7, v202, v203
  v_pk_fma_f32 v[232:233], v[88:89], v[22:23], v[232:233] op_sel_hi:[1,0,1]
  v_pk_fma_f32 v[234:235], v[90:91], v[22:23], v[234:235] op_sel_hi:[1,0,1]
  v_mul_f32 v232, v232, v16
  v_mul_f32 v233, v233, v16
  v_mul_f32 v234, v234, v16
  v_mul_f32 v235, v235, v16
  v_cvt_pk_bf16_f32 v8, v232, v233
  v_cvt_pk_bf16_f32 v9, v234, v235
  buffer_store_dwordx4 v[6:9], v28, s[36:39], s52 offen sc1
  v_pk_fma_f32 v[204:205], v[80:81], v[24:25], v[204:205] op_sel_hi:[1,0,1]
  v_pk_fma_f32 v[206:207], v[82:83], v[24:25], v[206:207] op_sel_hi:[1,0,1]
  v_mul_f32 v204, v204, v17
  v_mul_f32 v205, v205, v17
  v_mul_f32 v206, v206, v17
  v_mul_f32 v207, v207, v17
  v_cvt_pk_bf16_f32 v10, v204, v205
  v_cvt_pk_bf16_f32 v11, v206, v207
  v_pk_fma_f32 v[236:237], v[88:89], v[24:25], v[236:237] op_sel_hi:[1,0,1]
  v_pk_fma_f32 v[238:239], v[90:91], v[24:25], v[238:239] op_sel_hi:[1,0,1]
  v_mul_f32 v236, v236, v17
  v_mul_f32 v237, v237, v17
  v_mul_f32 v238, v238, v17
  v_mul_f32 v239, v239, v17
  v_cvt_pk_bf16_f32 v12, v236, v237
  v_cvt_pk_bf16_f32 v13, v238, v239
  s_add_u32 s58, s52, s51
  buffer_store_dwordx4 v[10:13], v28, s[36:39], s58 offen sc1
  s_add_u32 s62, s60, 2
  s_lshl_b32 s62, s62, 1
  s_lshr_b32 s3, s48, 1
  s_xor_b32 s3, s3, 0
  s_add_u32 s62, s62, s3
  s_and_b32 s56, s62, 31
  s_lshr_b32 s57, s62, 5
  s_lshl_b32 s58, s56, 6
  s_add_u32 s58, s58, s50
  s_cmp_eq_u32 s57, 0
  s_cselect_b32 s53, 1, 2
  s_cselect_b32 s54, 1048744942, 1.0
  s_lshl_b32 s52, s53, 22
  s_lshl_b32 s53, s53, 11
  s_mul_i32 s58, s58, s53
  s_add_u32 s52, s52, s58
  s_cmp_eq_u32 s57, 2
  s_cselect_b32 s58, 2048, 0
  s_add_u32 s52, s52, s58
  s_cmp_eq_u32 s57, 1
  s_cselect_b32 s51, 32, 64
  s_cselect_b64 s[64:65], -1, 0
  s_lshl_b32 s51, s51, 2
  v_cndmask_b32 v28, v26, v27, s[64:65]
  v_mul_f32 v14, s54, v19
  v_mul_f32 v15, s54, v21
  v_mul_f32 v16, s54, v23
  v_mul_f32 v17, s54, v25
  v_pk_fma_f32 v[112:113], v[68:69], v[18:19], v[112:113] op_sel_hi:[1,0,1]
  v_pk_fma_f32 v[114:115], v[70:71], v[18:19], v[114:115] op_sel_hi:[1,0,1]
  v_mul_f32 v112, v112, v14
  v_mul_f32 v113, v113, v14
  v_mul_f32 v114, v114, v14
  v_mul_f32 v115, v115, v14
  v_cvt_pk_bf16_f32 v2, v112, v113
  v_cvt_pk_bf16_f32 v3, v114, v115
  v_pk_fma_f32 v[176:177], v[76:77], v[18:19], v[176:177] op_sel_hi:[1,0,1]
  v_pk_fma_f32 v[178:179], v[78:79], v[18:19], v[178:179] op_sel_hi:[1,0,1]
  v_mul_f32 v176, v176, v14
  v_mul_f32 v177, v177, v14
  v_mul_f32 v178, v178, v14
  v_mul_f32 v179, v179, v14
  v_cvt_pk_bf16_f32 v4, v176, v177
  v_cvt_pk_bf16_f32 v5, v178, v179
  buffer_store_dwordx4 v[2:5], v28, s[36:39], s52 offen sc1
  v_pk_fma_f32 v[116:117], v[68:69], v[20:21], v[116:117] op_sel_hi:[1,0,1]
  v_pk_fma_f32 v[118:119], v[70:71], v[20:21], v[118:119] op_sel_hi:[1,0,1]
  v_mul_f32 v116, v116, v15
  v_mul_f32 v117, v117, v15
  v_mul_f32 v118, v118, v15
  v_mul_f32 v119, v119, v15
  v_cvt_pk_bf16_f32 v6, v116, v117
  v_cvt_pk_bf16_f32 v7, v118, v119
  v_pk_fma_f32 v[180:181], v[76:77], v[20:21], v[180:181] op_sel_hi:[1,0,1]
  v_pk_fma_f32 v[182:183], v[78:79], v[20:21], v[182:183] op_sel_hi:[1,0,1]
  v_mul_f32 v180, v180, v15
  v_mul_f32 v181, v181, v15
  v_mul_f32 v182, v182, v15
  v_mul_f32 v183, v183, v15
  v_cvt_pk_bf16_f32 v8, v180, v181
  v_cvt_pk_bf16_f32 v9, v182, v183
  s_add_u32 s58, s52, s51
  buffer_store_dwordx4 v[6:9], v28, s[36:39], s58 offen sc1
  s_add_u32 s52, s52, s53
  v_pk_fma_f32 v[120:121], v[68:69], v[22:23], v[120:121] op_sel_hi:[1,0,1]
  v_pk_fma_f32 v[122:123], v[70:71], v[22:23], v[122:123] op_sel_hi:[1,0,1]
  v_mul_f32 v120, v120, v16
  v_mul_f32 v121, v121, v16
  v_mul_f32 v122, v122, v16
  v_mul_f32 v123, v123, v16
  v_cvt_pk_bf16_f32 v10, v120, v121
  v_cvt_pk_bf16_f32 v11, v122, v123
  v_pk_fma_f32 v[184:185], v[76:77], v[22:23], v[184:185] op_sel_hi:[1,0,1]
  v_pk_fma_f32 v[186:187], v[78:79], v[22:23], v[186:187] op_sel_hi:[1,0,1]
  v_mul_f32 v184, v184, v16
  v_mul_f32 v185, v185, v16
  v_mul_f32 v186, v186, v16
  v_mul_f32 v187, v187, v16
  v_cvt_pk_bf16_f32 v12, v184, v185
  v_cvt_pk_bf16_f32 v13, v186, v187
  buffer_store_dwordx4 v[10:13], v28, s[36:39], s52 offen sc1
  v_pk_fma_f32 v[124:125], v[68:69], v[24:25], v[124:125] op_sel_hi:[1,0,1]
  v_pk_fma_f32 v[126:127], v[70:71], v[24:25], v[126:127] op_sel_hi:[1,0,1]
  v_mul_f32 v124, v124, v17
  v_mul_f32 v125, v125, v17
  v_mul_f32 v126, v126, v17
  v_mul_f32 v127, v127, v17
  v_cvt_pk_bf16_f32 v2, v124, v125
  v_cvt_pk_bf16_f32 v3, v126, v127
  v_pk_fma_f32 v[188:189], v[76:77], v[24:25], v[188:189] op_sel_hi:[1,0,1]
  v_pk_fma_f32 v[190:191], v[78:79], v[24:25], v[190:191] op_sel_hi:[1,0,1]
  v_mul_f32 v188, v188, v17
  v_mul_f32 v189, v189, v17
  v_mul_f32 v190, v190, v17
  v_mul_f32 v191, v191, v17
  v_cvt_pk_bf16_f32 v4, v188, v189
  v_cvt_pk_bf16_f32 v5, v190, v191
  s_add_u32 s58, s52, s51
  buffer_store_dwordx4 v[2:5], v28, s[36:39], s58 offen sc1
  s_add_u32 s62, s60, 2
  s_lshl_b32 s62, s62, 1
  s_lshr_b32 s3, s48, 1
  s_xor_b32 s3, s3, 1
  s_add_u32 s62, s62, s3
  s_and_b32 s56, s62, 31
  s_lshr_b32 s57, s62, 5
  s_lshl_b32 s58, s56, 6
  s_add_u32 s58, s58, s50
  s_cmp_eq_u32 s57, 0
  s_cselect_b32 s53, 1, 2
  s_cselect_b32 s54, 1048744942, 1.0
  s_lshl_b32 s52, s53, 22
  s_lshl_b32 s53, s53, 11
  s_mul_i32 s58, s58, s53
  s_add_u32 s52, s52, s58
  s_cmp_eq_u32 s57, 2
  s_cselect_b32 s58, 2048, 0
  s_add_u32 s52, s52, s58
  s_cmp_eq_u32 s57, 1
  s_cselect_b32 s51, 32, 64
  s_cselect_b64 s[64:65], -1, 0
  s_lshl_b32 s51, s51, 2
  v_cndmask_b32 v28, v26, v27, s[64:65]
  v_mul_f32 v14, s54, v19
  v_mul_f32 v15, s54, v21
  v_mul_f32 v16, s54, v23
  v_mul_f32 v17, s54, v25
  v_pk_fma_f32 v[208:209], v[84:85], v[18:19], v[208:209] op_sel_hi:[1,0,1]
  v_pk_fma_f32 v[210:211], v[86:87], v[18:19], v[210:211] op_sel_hi:[1,0,1]
  v_mul_f32 v208, v208, v14
  v_mul_f32 v209, v209, v14
  v_mul_f32 v210, v210, v14
  v_mul_f32 v211, v211, v14
  v_cvt_pk_bf16_f32 v6, v208, v209
  v_cvt_pk_bf16_f32 v7, v210, v211
  v_pk_fma_f32 v[240:241], v[92:93], v[18:19], v[240:241] op_sel_hi:[1,0,1]
  v_pk_fma_f32 v[242:243], v[94:95], v[18:19], v[242:243] op_sel_hi:[1,0,1]
  v_mul_f32 v240, v240, v14
  v_mul_f32 v241, v241, v14
  v_mul_f32 v242, v242, v14
  v_mul_f32 v243, v243, v14
  v_cvt_pk_bf16_f32 v8, v240, v241
  v_cvt_pk_bf16_f32 v9, v242, v243
  buffer_store_dwordx4 v[6:9], v28, s[36:39], s52 offen sc1
  v_pk_fma_f32 v[212:213], v[84:85], v[20:21], v[212:213] op_sel_hi:[1,0,1]
  v_pk_fma_f32 v[214:215], v[86:87], v[20:21], v[214:215] op_sel_hi:[1,0,1]
  v_mul_f32 v212, v212, v15
  v_mul_f32 v213, v213, v15
  v_mul_f32 v214, v214, v15
  v_mul_f32 v215, v215, v15
  v_cvt_pk_bf16_f32 v10, v212, v213
  v_cvt_pk_bf16_f32 v11, v214, v215
  v_pk_fma_f32 v[244:245], v[92:93], v[20:21], v[244:245] op_sel_hi:[1,0,1]
  v_pk_fma_f32 v[246:247], v[94:95], v[20:21], v[246:247] op_sel_hi:[1,0,1]
  v_mul_f32 v244, v244, v15
  v_mul_f32 v245, v245, v15
  v_mul_f32 v246, v246, v15
  v_mul_f32 v247, v247, v15
  v_cvt_pk_bf16_f32 v12, v244, v245
  v_cvt_pk_bf16_f32 v13, v246, v247
  s_add_u32 s58, s52, s51
  buffer_store_dwordx4 v[10:13], v28, s[36:39], s58 offen sc1
  s_add_u32 s52, s52, s53
  v_pk_fma_f32 v[216:217], v[84:85], v[22:23], v[216:217] op_sel_hi:[1,0,1]
  v_pk_fma_f32 v[218:219], v[86:87], v[22:23], v[218:219] op_sel_hi:[1,0,1]
  v_mul_f32 v216, v216, v16
  v_mul_f32 v217, v217, v16
  v_mul_f32 v218, v218, v16
  v_mul_f32 v219, v219, v16
  v_cvt_pk_bf16_f32 v2, v216, v217
  v_cvt_pk_bf16_f32 v3, v218, v219
  v_pk_fma_f32 v[248:249], v[92:93], v[22:23], v[248:249] op_sel_hi:[1,0,1]
  v_pk_fma_f32 v[250:251], v[94:95], v[22:23], v[250:251] op_sel_hi:[1,0,1]
  v_mul_f32 v248, v248, v16
  v_mul_f32 v249, v249, v16
  v_mul_f32 v250, v250, v16
  v_mul_f32 v251, v251, v16
  v_cvt_pk_bf16_f32 v4, v248, v249
  v_cvt_pk_bf16_f32 v5, v250, v251
  buffer_store_dwordx4 v[2:5], v28, s[36:39], s52 offen sc1
  v_pk_fma_f32 v[220:221], v[84:85], v[24:25], v[220:221] op_sel_hi:[1,0,1]
  v_pk_fma_f32 v[222:223], v[86:87], v[24:25], v[222:223] op_sel_hi:[1,0,1]
  v_mul_f32 v220, v220, v17
  v_mul_f32 v221, v221, v17
  v_mul_f32 v222, v222, v17
  v_mul_f32 v223, v223, v17
  v_cvt_pk_bf16_f32 v6, v220, v221
  v_cvt_pk_bf16_f32 v7, v222, v223
  v_pk_fma_f32 v[252:253], v[92:93], v[24:25], v[252:253] op_sel_hi:[1,0,1]
  v_pk_fma_f32 v[254:255], v[94:95], v[24:25], v[254:255] op_sel_hi:[1,0,1]
  v_mul_f32 v252, v252, v17
  v_mul_f32 v253, v253, v17
  v_mul_f32 v254, v254, v17
  v_mul_f32 v255, v255, v17
  v_cvt_pk_bf16_f32 v8, v252, v253
  v_cvt_pk_bf16_f32 v9, v254, v255
  s_add_u32 s58, s52, s51
  buffer_store_dwordx4 v[6:9], v28, s[36:39], s58 offen sc1
  s_branch L_k1_p0
L_k1_epiB1:
  s_add_u32 s62, s60, 1
  s_lshl_b32 s62, s62, 1
  s_lshr_b32 s3, s48, 1
  s_xor_b32 s3, s3, 0
  s_add_u32 s62, s62, s3
  s_and_b32 s56, s62, 31
  s_lshr_b32 s57, s62, 5
  s_lshl_b32 s58, s56, 6
  s_add_u32 s58, s58, s50
  s_cmp_eq_u32 s57, 0
  s_cselect_b32 s53, 1, 2
  s_cselect_b32 s54, 1048744942, 1.0
  s_lshl_b32 s52, s53, 22
  s_lshl_b32 s53, s53, 11
  s_mul_i32 s58, s58, s53
  s_add_u32 s52, s52, s58
  s_cmp_eq_u32 s57, 2
  s_cselect_b32 s58, 2048, 0
  s_add_u32 s52, s52, s58
  s_cmp_eq_u32 s57, 1
  s_cselect_b32 s51, 32, 64
  s_cselect_b64 s[64:65], -1, 0
  s_lshl_b32 s51, s51, 2
  v_cndmask_b32 v28, v26, v27, s[64:65]
  v_mul_f32 v14, s54, v19
  v_mul_f32 v15, s54, v21
  v_mul_f32 v16, s54, v23
  v_mul_f32 v17, s54, v25
  v_pk_fma_f32 v[160:161], v[72:73], v[18:19], v[160:161] op_sel_hi:[1,0,1]
  v_pk_fma_f32 v[162:163], v[74:75], v[18:19], v[162:163] op_sel_hi:[1,0,1]
  v_mul_f32 v160, v160, v14
  v_mul_f32 v161, v161, v14
  v_mul_f32 v162, v162, v14
  v_mul_f32 v163, v163, v14
  v_cvt_pk_bf16_f32 v10, v160, v161
  v_cvt_pk_bf16_f32 v11, v162, v163
  v_pk_fma_f32 v[96:97], v[64:65], v[18:19], v[96:97] op_sel_hi:[1,0,1]
  v_pk_fma_f32 v[98:99], v[66:67], v[18:19], v[98:99] op_sel_hi:[1,0,1]
  v_mul_f32 v96, v96, v14
  v_mul_f32 v97, v97, v14
  v_mul_f32 v98, v98, v14
  v_mul_f32 v99, v99, v14
  v_cvt_pk_bf16_f32 v12, v96, v97
  v_cvt_pk_bf16_f32 v13, v98, v99
  buffer_store_dwordx4 v[10:13], v28, s[36:39], s52 offen sc1
  v_pk_fma_f32 v[164:165], v[72:73], v[20:21], v[164:165] op_sel_hi:[1,0,1]
  v_pk_fma_f32 v[166:167], v[74:75], v[20:21], v[166:167] op_sel_hi:[1,0,1]
  v_mul_f32 v164, v164, v15
  v_mul_f32 v165, v165, v15
  v_mul_f32 v166, v166, v15
  v_mul_f32 v167, v167, v15
  v_cvt_pk_bf16_f32 v2, v164, v165
  v_cvt_pk_bf16_f32 v3, v166, v167
  v_pk_fma_f32 v[100:101], v[64:65], v[20:21], v[100:101] op_sel_hi:[1,0,1]
  v_pk_fma_f32 v[102:103], v[66:67], v[20:21], v[102:103] op_sel_hi:[1,0,1]
  v_mul_f32 v100, v100, v15
  v_mul_f32 v101, v101, v15
  v_mul_f32 v102, v102, v15
  v_mul_f32 v103, v103, v15
  v_cvt_pk_bf16_f32 v4, v100, v101
  v_cvt_pk_bf16_f32 v5, v102, v103
  s_add_u32 s58, s52, s51
  buffer_store_dwordx4 v[2:5], v28, s[36:39], s58 offen sc1
  s_add_u32 s52, s52, s53
  v_pk_fma_f32 v[168:169], v[72:73], v[22:23], v[168:169] op_sel_hi:[1,0,1]
  v_pk_fma_f32 v[170:171], v[74:75], v[22:23], v[170:171] op_sel_hi:[1,0,1]
  v_mul_f32 v168, v168, v16
  v_mul_f32 v169, v169, v16
  v_mul_f32 v170, v170, v16
  v_mul_f32 v171, v171, v16
  v_cvt_pk_bf16_f32 v6, v168, v169
  v_cvt_pk_bf16_f32 v7, v170, v171
  v_pk_fma_f32 v[104:105], v[64:65], v[22:23], v[104:105] op_sel_hi:[1,0,1]
  v_pk_fma_f32 v[106:107], v[66:67], v[22:23], v[106:107] op_sel_hi:[1,0,1]
  v_mul_f32 v104, v104, v16
  v_mul_f32 v105, v105, v16
  v_mul_f32 v106, v106, v16
  v_mul_f32 v107, v107, v16
  v_cvt_pk_bf16_f32 v8, v104, v105
  v_cvt_pk_bf16_f32 v9, v106, v107
  buffer_store_dwordx4 v[6:9], v28, s[36:39], s52 offen sc1
  v_pk_fma_f32 v[172:173], v[72:73], v[24:25], v[172:173] op_sel_hi:[1,0,1]
  v_pk_fma_f32 v[174:175], v[74:75], v[24:25], v[174:175] op_sel_hi:[1,0,1]
  v_mul_f32 v172, v172, v17
  v_mul_f32 v173, v173, v17
  v_mul_f32 v174, v174, v17
  v_mul_f32 v175, v175, v17
  v_cvt_pk_bf16_f32 v10, v172, v173
  v_cvt_pk_bf16_f32 v11, v174, v175
  v_pk_fma_f32 v[108:109], v[64:65], v[24:25], v[108:109] op_sel_hi:[1,0,1]
  v_pk_fma_f32 v[110:111], v[66:67], v[24:25], v[110:111] op_sel_hi:[1,0,1]
  v_mul_f32 v108, v108, v17
  v_mul_f32 v109, v109, v17
  v_mul_f32 v110, v110, v17
  v_mul_f32 v111, v111, v17
  v_cvt_pk_bf16_f32 v12, v108, v109
  v_cvt_pk_bf16_f32 v13, v110, v111
  s_add_u32 s58, s52, s51
  buffer_store_dwordx4 v[10:13], v28, s[36:39], s58 offen sc1
  s_add_u32 s62, s60, 1
  s_lshl_b32 s62, s62, 1
  s_lshr_b32 s3, s48, 1
  s_xor_b32 s3, s3, 1
  s_add_u32 s62, s62, s3
  s_and_b32 s56, s62, 31
  s_lshr_b32 s57, s62, 5
  s_lshl_b32 s58, s56, 6
  s_add_u32 s58, s58, s50
  s_cmp_eq_u32 s57, 0
  s_cselect_b32 s53, 1, 2
  s_cselect_b32 s54, 1048744942, 1.0
  s_lshl_b32 s52, s53, 22
  s_lshl_b32 s53, s53, 11
  s_mul_i32 s58, s58, s53
  s_add_u32 s52, s52, s58
  s_cmp_eq_u32 s57, 2
  s_cselect_b32 s58, 2048, 0
  s_add_u32 s52, s52, s58
  s_cmp_eq_u32 s57, 1
  s_cselect_b32 s51, 32, 64
  s_cselect_b64 s[64:65], -1, 0
  s_lshl_b32 s51, s51, 2
  v_cndmask_b32 v28, v26, v27, s[64:65]
  v_mul_f32 v14, s54, v19
  v_mul_f32 v15, s54, v21
  v_mul_f32 v16, s54, v23
  v_mul_f32 v17, s54, v25
  v_pk_fma_f32 v[224:225], v[88:89], v[18:19], v[224:225] op_sel_hi:[1,0,1]
  v_pk_fma_f32 v[226:227], v[90:91], v[18:19], v[226:227] op_sel_hi:[1,0,1]
  v_mul_f32 v224, v224, v14
  v_mul_f32 v225, v225, v14
  v_mul_f32 v226, v226, v14
  v_mul_f32 v227, v227, v14
  v_cvt_pk_bf16_f32 v2, v224, v225
  v_cvt_pk_bf16_f32 v3, v226, v227
  v_pk_fma_f32 v[192:193], v[80:81], v[18:19], v[192:193] op_sel_hi:[1,0,1]
  v_pk_fma_f32 v[194:195], v[82:83], v[18:19], v[194:195] op_sel_hi:[1,0,1]
  v_mul_f32 v192, v192, v14
  v_mul_f32 v193, v193, v14
  v_mul_f32 v194, v194, v14
  v_mul_f32 v195, v195, v14
  v_cvt_pk_bf16_f32 v4, v192, v193
  v_cvt_pk_bf16_f32 v5, v194, v195
  buffer_store_dwordx4 v[2:5], v28, s[36:39], s52 offen sc1
  v_pk_fma_f32 v[228:229], v[88:89], v[20:21], v[228:229] op_sel_hi:[1,0,1]
  v_pk_fma_f32 v[230:231], v[90:91], v[20:21], v[230:231] op_sel_hi:[1,0,1]
  v_mul_f32 v228, v228, v15
  v_mul_f32 v229, v229, v15
  v_mul_f32 v230, v230, v15
  v_mul_f32 v231, v231, v15
  v_cvt_pk_bf16_f32 v6, v228, v229
  v_cvt_pk_bf16_f32 v7, v230, v231
  v_pk_fma_f32 v[196:197], v[80:81], v[20:21], v[196:197] op_sel_hi:[1,0,1]
  v_pk_fma_f32 v[198:199], v[82:83], v[20:21], v[198:199] op_sel_hi:[1,0,1]
  v_mul_f32 v196, v196, v15
  v_mul_f32 v197, v197, v15
  v_mul_f32 v198, v198, v15
  v_mul_f32 v199, v199, v15
  v_cvt_pk_bf16_f32 v8, v196, v197
  v_cvt_pk_bf16_f32 v9, v198, v199
  s_add_u32 s58, s52, s51
  buffer_store_dwordx4 v[6:9], v28, s[36:39], s58 offen sc1
  s_add_u32 s52, s52, s53
  v_pk_fma_f32 v[232:233], v[88:89], v[22:23], v[232:233] op_sel_hi:[1,0,1]
  v_pk_fma_f32 v[234:235], v[90:91], v[22:23], v[234:235] op_sel_hi:[1,0,1]
  v_mul_f32 v232, v232, v16
  v_mul_f32 v233, v233, v16
  v_mul_f32 v234, v234, v16
  v_mul_f32 v235, v235, v16
  v_cvt_pk_bf16_f32 v10, v232, v233
  v_cvt_pk_bf16_f32 v11, v234, v235
  v_pk_fma_f32 v[200:201], v[80:81], v[22:23], v[200:201] op_sel_hi:[1,0,1]
  v_pk_fma_f32 v[202:203], v[82:83], v[22:23], v[202:203] op_sel_hi:[1,0,1]
  v_mul_f32 v200, v200, v16
  v_mul_f32 v201, v201, v16
  v_mul_f32 v202, v202, v16
  v_mul_f32 v203, v203, v16
  v_cvt_pk_bf16_f32 v12, v200, v201
  v_cvt_pk_bf16_f32 v13, v202, v203
  buffer_store_dwordx4 v[10:13], v28, s[36:39], s52 offen sc1
  v_pk_fma_f32 v[236:237], v[88:89], v[24:25], v[236:237] op_sel_hi:[1,0,1]
  v_pk_fma_f32 v[238:239], v[90:91], v[24:25], v[238:239] op_sel_hi:[1,0,1]
  v_mul_f32 v236, v236, v17
  v_mul_f32 v237, v237, v17
  v_mul_f32 v238, v238, v17
  v_mul_f32 v239, v239, v17
  v_cvt_pk_bf16_f32 v2, v236, v237
  v_cvt_pk_bf16_f32 v3, v238, v239
  v_pk_fma_f32 v[204:205], v[80:81], v[24:25], v[204:205] op_sel_hi:[1,0,1]
  v_pk_fma_f32 v[206:207], v[82:83], v[24:25], v[206:207] op_sel_hi:[1,0,1]
  v_mul_f32 v204, v204, v17
  v_mul_f32 v205, v205, v17
  v_mul_f32 v206, v206, v17
  v_mul_f32 v207, v207, v17
  v_cvt_pk_bf16_f32 v4, v204, v205
  v_cvt_pk_bf16_f32 v5, v206, v207
  s_add_u32 s58, s52, s51
  buffer_store_dwordx4 v[2:5], v28, s[36:39], s58 offen sc1
  s_add_u32 s62, s60, 2
  s_lshl_b32 s62, s62, 1
  s_lshr_b32 s3, s48, 1
  s_xor_b32 s3, s3, 0
  s_add_u32 s62, s62, s3
  s_and_b32 s56, s62, 31
  s_lshr_b32 s57, s62, 5
  s_lshl_b32 s58, s56, 6
  s_add_u32 s58, s58, s50
  s_cmp_eq_u32 s57, 0
  s_cselect_b32 s53, 1, 2
  s_cselect_b32 s54, 1048744942, 1.0
  s_lshl_b32 s52, s53, 22
  s_lshl_b32 s53, s53, 11
  s_mul_i32 s58, s58, s53
  s_add_u32 s52, s52, s58
  s_cmp_eq_u32 s57, 2
  s_cselect_b32 s58, 2048, 0
  s_add_u32 s52, s52, s58
  s_cmp_eq_u32 s57, 1
  s_cselect_b32 s51, 32, 64
  s_cselect_b64 s[64:65], -1, 0
  s_lshl_b32 s51, s51, 2
  v_cndmask_b32 v28, v26, v27, s[64:65]
  v_mul_f32 v14, s54, v19
  v_mul_f32 v15, s54, v21
  v_mul_f32 v16, s54, v23
  v_mul_f32 v17, s54, v25
  v_pk_fma_f32 v[176:177], v[76:77], v[18:19], v[176:177] op_sel_hi:[1,0,1]
  v_pk_fma_f32 v[178:179], v[78:79], v[18:19], v[178:179] op_sel_hi:[1,0,1]
  v_mul_f32 v176, v176, v14
  v_mul_f32 v177, v177, v14
  v_mul_f32 v178, v178, v14
  v_mul_f32 v179, v179, v14
  v_cvt_pk_bf16_f32 v6, v176, v177
  v_cvt_pk_bf16_f32 v7, v178, v179
  v_pk_fma_f32 v[112:113], v[68:69], v[18:19], v[112:113] op_sel_hi:[1,0,1]
  v_pk_fma_f32 v[114:115], v[70:71], v[18:19], v[114:115] op_sel_hi:[1,0,1]
  v_mul_f32 v112, v112, v14
  v_mul_f32 v113, v113, v14
  v_mul_f32 v114, v114, v14
  v_mul_f32 v115, v115, v14
  v_cvt_pk_bf16_f32 v8, v112, v113
  v_cvt_pk_bf16_f32 v9, v114, v115
  buffer_store_dwordx4 v[6:9], v28, s[36:39], s52 offen sc1
  v_pk_fma_f32 v[180:181], v[76:77], v[20:21], v[180:181] op_sel_hi:[1,0,1]
  v_pk_fma_f32 v[182:183], v[78:79], v[20:21], v[182:183] op_sel_hi:[1,0,1]
  v_mul_f32 v180, v180, v15
  v_mul_f32 v181, v181, v15
  v_mul_f32 v182, v182, v15
  v_mul_f32 v183, v183, v15
  v_cvt_pk_bf16_f32 v10, v180, v181
  v_cvt_pk_bf16_f32 v11, v182, v183
  v_pk_fma_f32 v[116:117], v[68:69], v[20:21], v[116:117] op_sel_hi:[1,0,1]
  v_pk_fma_f32 v[118:119], v[70:71], v[20:21], v[118:119] op_sel_hi:[1,0,1]
  v_mul_f32 v116, v116, v15
  v_mul_f32 v117, v117, v15
  v_mul_f32 v118, v118, v15
  v_mul_f32 v119, v119, v15
  v_cvt_pk_bf16_f32 v12, v116, v117
  v_cvt_pk_bf16_f32 v13, v118, v119
  s_add_u32 s58, s52, s51
  buffer_store_dwordx4 v[10:13], v28, s[36:39], s58 offen sc1
  s_add_u32 s52, s52, s53
  v_pk_fma_f32 v[184:185], v[76:77], v[22:23], v[184:185] op_sel_hi:[1,0,1]
  v_pk_fma_f32 v[186:187], v[78:79], v[22:23], v[186:187] op_sel_hi:[1,0,1]
  v_mul_f32 v184, v184, v16
  v_mul_f32 v185, v185, v16
  v_mul_f32 v186, v186, v16
  v_mul_f32 v187, v187, v16
  v_cvt_pk_bf16_f32 v2, v184, v185
  v_cvt_pk_bf16_f32 v3, v186, v187
  v_pk_fma_f32 v[120:121], v[68:69], v[22:23], v[120:121] op_sel_hi:[1,0,1]
  v_pk_fma_f32 v[122:123], v[70:71], v[22:23], v[122:123] op_sel_hi:[1,0,1]
  v_mul_f32 v120, v120, v16
  v_mul_f32 v121, v121, v16
  v_mul_f32 v122, v122, v16
  v_mul_f32 v123, v123, v16
  v_cvt_pk_bf16_f32 v4, v120, v121
  v_cvt_pk_bf16_f32 v5, v122, v123
  buffer_store_dwordx4 v[2:5], v28, s[36:39], s52 offen sc1
  v_pk_fma_f32 v[188:189], v[76:77], v[24:25], v[188:189] op_sel_hi:[1,0,1]
  v_pk_fma_f32 v[190:191], v[78:79], v[24:25], v[190:191] op_sel_hi:[1,0,1]
  v_mul_f32 v188, v188, v17
  v_mul_f32 v189, v189, v17
  v_mul_f32 v190, v190, v17
  v_mul_f32 v191, v191, v17
  v_cvt_pk_bf16_f32 v6, v188, v189
  v_cvt_pk_bf16_f32 v7, v190, v191
  v_pk_fma_f32 v[124:125], v[68:69], v[24:25], v[124:125] op_sel_hi:[1,0,1]
  v_pk_fma_f32 v[126:127], v[70:71], v[24:25], v[126:127] op_sel_hi:[1,0,1]
  v_mul_f32 v124, v124, v17
  v_mul_f32 v125, v125, v17
  v_mul_f32 v126, v126, v17
  v_mul_f32 v127, v127, v17
  v_cvt_pk_bf16_f32 v8, v124, v125
  v_cvt_pk_bf16_f32 v9, v126, v127
  s_add_u32 s58, s52, s51
  buffer_store_dwordx4 v[6:9], v28, s[36:39], s58 offen sc1
  s_add_u32 s62, s60, 2
  s_lshl_b32 s62, s62, 1
  s_lshr_b32 s3, s48, 1
  s_xor_b32 s3, s3, 1
  s_add_u32 s62, s62, s3
  s_and_b32 s56, s62, 31
  s_lshr_b32 s57, s62, 5
  s_lshl_b32 s58, s56, 6
  s_add_u32 s58, s58, s50
  s_cmp_eq_u32 s57, 0
  s_cselect_b32 s53, 1, 2
  s_cselect_b32 s54, 1048744942, 1.0
  s_lshl_b32 s52, s53, 22
  s_lshl_b32 s53, s53, 11
  s_mul_i32 s58, s58, s53
  s_add_u32 s52, s52, s58
  s_cmp_eq_u32 s57, 2
  s_cselect_b32 s58, 2048, 0
  s_add_u32 s52, s52, s58
  s_cmp_eq_u32 s57, 1
  s_cselect_b32 s51, 32, 64
  s_cselect_b64 s[64:65], -1, 0
  s_lshl_b32 s51, s51, 2
  v_cndmask_b32 v28, v26, v27, s[64:65]
  v_mul_f32 v14, s54, v19
  v_mul_f32 v15, s54, v21
  v_mul_f32 v16, s54, v23
  v_mul_f32 v17, s54, v25
  v_pk_fma_f32 v[240:241], v[92:93], v[18:19], v[240:241] op_sel_hi:[1,0,1]
  v_pk_fma_f32 v[242:243], v[94:95], v[18:19], v[242:243] op_sel_hi:[1,0,1]
  v_mul_f32 v240, v240, v14
  v_mul_f32 v241, v241, v14
  v_mul_f32 v242, v242, v14
  v_mul_f32 v243, v243, v14
  v_cvt_pk_bf16_f32 v10, v240, v241
  v_cvt_pk_bf16_f32 v11, v242, v243
  v_pk_fma_f32 v[208:209], v[84:85], v[18:19], v[208:209] op_sel_hi:[1,0,1]
  v_pk_fma_f32 v[210:211], v[86:87], v[18:19], v[210:211] op_sel_hi:[1,0,1]
  v_mul_f32 v208, v208, v14
  v_mul_f32 v209, v209, v14
  v_mul_f32 v210, v210, v14
  v_mul_f32 v211, v211, v14
  v_cvt_pk_bf16_f32 v12, v208, v209
  v_cvt_pk_bf16_f32 v13, v210, v211
  buffer_store_dwordx4 v[10:13], v28, s[36:39], s52 offen sc1
  v_pk_fma_f32 v[244:245], v[92:93], v[20:21], v[244:245] op_sel_hi:[1,0,1]
  v_pk_fma_f32 v[246:247], v[94:95], v[20:21], v[246:247] op_sel_hi:[1,0,1]
  v_mul_f32 v244, v244, v15
  v_mul_f32 v245, v245, v15
  v_mul_f32 v246, v246, v15
  v_mul_f32 v247, v247, v15
  v_cvt_pk_bf16_f32 v2, v244, v245
  v_cvt_pk_bf16_f32 v3, v246, v247
  v_pk_fma_f32 v[212:213], v[84:85], v[20:21], v[212:213] op_sel_hi:[1,0,1]
  v_pk_fma_f32 v[214:215], v[86:87], v[20:21], v[214:215] op_sel_hi:[1,0,1]
  v_mul_f32 v212, v212, v15
  v_mul_f32 v213, v213, v15
  v_mul_f32 v214, v214, v15
  v_mul_f32 v215, v215, v15
  v_cvt_pk_bf16_f32 v4, v212, v213
  v_cvt_pk_bf16_f32 v5, v214, v215
  s_add_u32 s58, s52, s51
  buffer_store_dwordx4 v[2:5], v28, s[36:39], s58 offen sc1
  s_add_u32 s52, s52, s53
  v_pk_fma_f32 v[248:249], v[92:93], v[22:23], v[248:249] op_sel_hi:[1,0,1]
  v_pk_fma_f32 v[250:251], v[94:95], v[22:23], v[250:251] op_sel_hi:[1,0,1]
  v_mul_f32 v248, v248, v16
  v_mul_f32 v249, v249, v16
  v_mul_f32 v250, v250, v16
  v_mul_f32 v251, v251, v16
  v_cvt_pk_bf16_f32 v6, v248, v249
  v_cvt_pk_bf16_f32 v7, v250, v251
  v_pk_fma_f32 v[216:217], v[84:85], v[22:23], v[216:217] op_sel_hi:[1,0,1]
  v_pk_fma_f32 v[218:219], v[86:87], v[22:23], v[218:219] op_sel_hi:[1,0,1]
  v_mul_f32 v216, v216, v16
  v_mul_f32 v217, v217, v16
  v_mul_f32 v218, v218, v16
  v_mul_f32 v219, v219, v16
  v_cvt_pk_bf16_f32 v8, v216, v217
  v_cvt_pk_bf16_f32 v9, v218, v219
  buffer_store_dwordx4 v[6:9], v28, s[36:39], s52 offen sc1
  v_pk_fma_f32 v[252:253], v[92:93], v[24:25], v[252:253] op_sel_hi:[1,0,1]
  v_pk_fma_f32 v[254:255], v[94:95], v[24:25], v[254:255] op_sel_hi:[1,0,1]
  v_mul_f32 v252, v252, v17
  v_mul_f32 v253, v253, v17
  v_mul_f32 v254, v254, v17
  v_mul_f32 v255, v255, v17
  v_cvt_pk_bf16_f32 v10, v252, v253
  v_cvt_pk_bf16_f32 v11, v254, v255
  v_pk_fma_f32 v[220:221], v[84:85], v[24:25], v[220:221] op_sel_hi:[1,0,1]
  v_pk_fma_f32 v[222:223], v[86:87], v[24:25], v[222:223] op_sel_hi:[1,0,1]
  v_mul_f32 v220, v220, v17
  v_mul_f32 v221, v221, v17
  v_mul_f32 v222, v222, v17
  v_mul_f32 v223, v223, v17
  v_cvt_pk_bf16_f32 v12, v220, v221
  v_cvt_pk_bf16_f32 v13, v222, v223
  s_add_u32 s58, s52, s51
  buffer_store_dwordx4 v[10:13], v28, s[36:39], s58 offen sc1
L_k1_p0:
  s_lshl_b32 s62, s60, 1
  s_add_u32 s62, s62, s49
  s_lshl_b32 s3, s49, 10
  s_add_u32 s3, s3, 147968
  s_bitcmp0_b32 s42, 1
  s_cbranch_scc1 L_k1_p0v
  v_lshl_add_u32 v30, v29, 4, s3
  ds_read_b128 v[32:35], v30 offset:0
  ds_read_b128 v[36:39], v30 offset:64
  ds_read_b128 v[40:43], v30 offset:128
  ds_read_b128 v[44:47], v30 offset:192
  ds_read_b128 v[48:51], v30 offset:256
  ds_read_b128 v[52:55], v30 offset:320
  ds_read_b128 v[56:59], v30 offset:384
  ds_read_b128 v[60:63], v30 offset:448
  s_waitcnt lgkmcnt(0)
  v_pk_add_f32 v[32:33], v[32:33], v[40:41]
  v_pk_add_f32 v[34:35], v[34:35], v[42:43]
  v_pk_add_f32 v[36:37], v[36:37], v[44:45]
  v_pk_add_f32 v[38:39], v[38:39], v[46:47]
  v_pk_add_f32 v[48:49], v[48:49], v[56:57]
  v_pk_add_f32 v[50:51], v[50:51], v[58:59]
  v_pk_add_f32 v[52:53], v[52:53], v[60:61]
  v_pk_add_f32 v[54:55], v[54:55], v[62:63]
  v_pk_add_f32 v[32:33], v[32:33], v[48:49]
  v_pk_add_f32 v[34:35], v[34:35], v[50:51]
  v_pk_add_f32 v[36:37], v[36:37], v[52:53]
  v_pk_add_f32 v[38:39], v[38:39], v[54:55]
  s_and_b32 s56, s62, 31
  s_lshr_b32 s57, s62, 5
  s_lshl_b32 s58, s56, 6
  s_add_u32 s58, s58, s50
  s_cmp_eq_u32 s57, 0
  s_cselect_b32 s53, 1, 2
  s_cselect_b32 s54, 1048744942, 1.0
  s_lshl_b32 s52, s53, 22
  s_lshl_b32 s53, s53, 11
  s_mul_i32 s58, s58, s53
  s_add_u32 s52, s52, s58
  s_cmp_eq_u32 s57, 2
  s_cselect_b32 s58, 2048, 0
  s_add_u32 s52, s52, s58
  s_cmp_eq_u32 s57, 1
  s_cselect_b32 s51, 32, 64
  s_cselect_b64 s[64:65], -1, 0
  s_lshl_b32 s51, s51, 2
  v_cndmask_b32 v28, v26, v27, s[64:65]
  v_mul_f32 v14, s54, v19
  v_mul_f32 v15, s54, v21
  v_mul_f32 v16, s54, v23
  v_mul_f32 v17, s54, v25
  v_pk_fma_f32 v[128:129], v[32:33], v[18:19], v[128:129] op_sel_hi:[1,0,1]
  v_pk_fma_f32 v[130:131], v[34:35], v[18:19], v[130:131] op_sel_hi:[1,0,1]
  v_mul_f32 v128, v128, v14
  v_mul_f32 v129, v129, v14
  v_mul_f32 v130, v130, v14
  v_mul_f32 v131, v131, v14
  v_cvt_pk_bf16_f32 v2, v128, v129
  v_cvt_pk_bf16_f32 v3, v130, v131
  v_pk_fma_f32 v[144:145], v[36:37], v[18:19], v[144:145] op_sel_hi:[1,0,1]
  v_pk_fma_f32 v[146:147], v[38:39], v[18:19], v[146:147] op_sel_hi:[1,0,1]
  v_mul_f32 v144, v144, v14
  v_mul_f32 v145, v145, v14
  v_mul_f32 v146, v146, v14
  v_mul_f32 v147, v147, v14
  v_cvt_pk_bf16_f32 v4, v144, v145
  v_cvt_pk_bf16_f32 v5, v146, v147
  buffer_store_dwordx4 v[2:5], v28, s[36:39], s52 offen sc1
  v_pk_fma_f32 v[132:133], v[32:33], v[20:21], v[132:133] op_sel_hi:[1,0,1]
  v_pk_fma_f32 v[134:135], v[34:35], v[20:21], v[134:135] op_sel_hi:[1,0,1]
  v_mul_f32 v132, v132, v15
  v_mul_f32 v133, v133, v15
  v_mul_f32 v134, v134, v15
  v_mul_f32 v135, v135, v15
  v_cvt_pk_bf16_f32 v6, v132, v133
  v_cvt_pk_bf16_f32 v7, v134, v135
  v_pk_fma_f32 v[148:149], v[36:37], v[20:21], v[148:149] op_sel_hi:[1,0,1]
  v_pk_fma_f32 v[150:151], v[38:39], v[20:21], v[150:151] op_sel_hi:[1,0,1]
  v_mul_f32 v148, v148, v15
  v_mul_f32 v149, v149, v15
  v_mul_f32 v150, v150, v15
  v_mul_f32 v151, v151, v15
  v_cvt_pk_bf16_f32 v8, v148, v149
  v_cvt_pk_bf16_f32 v9, v150, v151
  s_add_u32 s58, s52, s51
  buffer_store_dwordx4 v[6:9], v28, s[36:39], s58 offen sc1
  s_add_u32 s52, s52, s53
  v_pk_fma_f32 v[136:137], v[32:33], v[22:23], v[136:137] op_sel_hi:[1,0,1]
  v_pk_fma_f32 v[138:139], v[34:35], v[22:23], v[138:139] op_sel_hi:[1,0,1]
  v_mul_f32 v136, v136, v16
  v_mul_f32 v137, v137, v16
  v_mul_f32 v138, v138, v16
  v_mul_f32 v139, v139, v16
  v_cvt_pk_bf16_f32 v10, v136, v137
  v_cvt_pk_bf16_f32 v11, v138, v139
  v_pk_fma_f32 v[152:153], v[36:37], v[22:23], v[152:153] op_sel_hi:[1,0,1]
  v_pk_fma_f32 v[154:155], v[38:39], v[22:23], v[154:155] op_sel_hi:[1,0,1]
  v_mul_f32 v152, v152, v16
  v_mul_f32 v153, v153, v16
  v_mul_f32 v154, v154, v16
  v_mul_f32 v155, v155, v16
  v_cvt_pk_bf16_f32 v12, v152, v153
  v_cvt_pk_bf16_f32 v13, v154, v155
  buffer_store_dwordx4 v[10:13], v28, s[36:39], s52 offen sc1
  v_pk_fma_f32 v[140:141], v[32:33], v[24:25], v[140:141] op_sel_hi:[1,0,1]
  v_pk_fma_f32 v[142:143], v[34:35], v[24:25], v[142:143] op_sel_hi:[1,0,1]
  v_mul_f32 v140, v140, v17
  v_mul_f32 v141, v141, v17
  v_mul_f32 v142, v142, v17
  v_mul_f32 v143, v143, v17
  v_cvt_pk_bf16_f32 v2, v140, v141
  v_cvt_pk_bf16_f32 v3, v142, v143
  v_pk_fma_f32 v[156:157], v[36:37], v[24:25], v[156:157] op_sel_hi:[1,0,1]
  v_pk_fma_f32 v[158:159], v[38:39], v[24:25], v[158:159] op_sel_hi:[1,0,1]
  v_mul_f32 v156, v156, v17
  v_mul_f32 v157, v157, v17
  v_mul_f32 v158, v158, v17
  v_mul_f32 v159, v159, v17
  v_cvt_pk_bf16_f32 v4, v156, v157
  v_cvt_pk_bf16_f32 v5, v158, v159
  s_add_u32 s58, s52, s51
  buffer_store_dwordx4 v[2:5], v28, s[36:39], s58 offen sc1
  s_branch L_k1_fin
L_k1_p0v:
  v_and_b32 v30, 15, v1
  v_lshl_add_u32 v30, v30, 2, s3
  ds_read2_b32 v[64:65], v30 offset0:0 offset1:16
  ds_read2_b32 v[66:67], v30 offset0:32 offset1:48
  ds_read2_b32 v[68:69], v30 offset0:64 offset1:80
  ds_read2_b32 v[70:71], v30 offset0:96 offset1:112
  s_and_b32 s56, s62, 31
  s_lshr_b32 s57, s62, 5
  s_lshl_b32 s58, s56, 6
  s_add_u32 s58, s58, s50
  s_cmp_eq_u32 s57, 0
  s_cselect_b32 s53, 1, 2
  s_cselect_b32 s54, 1048744942, 1.0
  s_lshl_b32 s52, s53, 22
  s_lshl_b32 s53, s53, 11
  s_mul_i32 s58, s58, s53
  s_add_u32 s52, s52, s58
  s_cmp_eq_u32 s57, 2
  s_cselect_b32 s58, 2048, 0
  s_add_u32 s52, s52, s58
  s_cmp_eq_u32 s57, 1
  s_cselect_b32 s51, 32, 64
  s_cselect_b64 s[64:65], -1, 0
  s_lshl_b32 s51, s51, 2
  s_waitcnt lgkmcnt(0) vmcnt(8)
  v_pk_add_f32 v[64:65], v[64:65], v[66:67]
  v_pk_add_f32 v[68:69], v[68:69], v[70:71]
  v_pk_add_f32 v[64:65], v[64:65], v[68:69]
  v_fmac_f32 v128, v32, v64
  v_fmac_f32 v129, v34, v64
  v_fmac_f32 v130, v36, v64
  v_fmac_f32 v131, v38, v64
  v_mul_f32 v128, v128, v33
  v_mul_f32 v129, v129, v35
  v_mul_f32 v130, v130, v37
  v_mul_f32 v131, v131, v39
  v_cvt_pk_bf16_f32 v6, v128, v129
  v_cvt_pk_bf16_f32 v7, v130, v131
  v_fmac_f32 v132, v40, v64
  v_fmac_f32 v133, v42, v64
  v_fmac_f32 v134, v44, v64
  v_fmac_f32 v135, v46, v64
  v_mul_f32 v132, v132, v41
  v_mul_f32 v133, v133, v43
  v_mul_f32 v134, v134, v45
  v_mul_f32 v135, v135, v47
  v_cvt_pk_bf16_f32 v8, v132, v133
  v_cvt_pk_bf16_f32 v9, v134, v135
  buffer_store_dwordx4 v[6:9], v26, s[36:39], s52 offen offset:0 sc1
  v_fmac_f32 v144, v32, v65
  v_fmac_f32 v145, v34, v65
  v_fmac_f32 v146, v36, v65
  v_fmac_f32 v147, v38, v65
  v_mul_f32 v144, v144, v33
  v_mul_f32 v145, v145, v35
  v_mul_f32 v146, v146, v37
  v_mul_f32 v147, v147, v39
  v_cvt_pk_bf16_f32 v10, v144, v145
  v_cvt_pk_bf16_f32 v11, v146, v147
  v_fmac_f32 v148, v40, v65
  v_fmac_f32 v149, v42, v65
  v_fmac_f32 v150, v44, v65
  v_fmac_f32 v151, v46, v65
  v_mul_f32 v148, v148, v41
  v_mul_f32 v149, v149, v43
  v_mul_f32 v150, v150, v45
  v_mul_f32 v151, v151, v47
  v_cvt_pk_bf16_f32 v12, v148, v149
  v_cvt_pk_bf16_f32 v13, v150, v151
  buffer_store_dwordx4 v[10:13], v26, s[36:39], s52 offen offset:256 sc1
  s_add_u32 s52, s52, s53
  v_fmac_f32 v136, v48, v64
  v_fmac_f32 v137, v50, v64
  v_fmac_f32 v138, v52, v64
  v_fmac_f32 v139, v54, v64
  v_mul_f32 v136, v136, v49
  v_mul_f32 v137, v137, v51
  v_mul_f32 v138, v138, v53
  v_mul_f32 v139, v139, v55
  v_cvt_pk_bf16_f32 v2, v136, v137
  v_cvt_pk_bf16_f32 v3, v138, v139
  v_fmac_f32 v140, v56, v64
  v_fmac_f32 v141, v58, v64
  v_fmac_f32 v142, v60, v64
  v_fmac_f32 v143, v62, v64
  v_mul_f32 v140, v140, v57
  v_mul_f32 v141, v141, v59
  v_mul_f32 v142, v142, v61
  v_mul_f32 v143, v143, v63
  v_cvt_pk_bf16_f32 v4, v140, v141
  v_cvt_pk_bf16_f32 v5, v142, v143
  buffer_store_dwordx4 v[2:5], v26, s[36:39], s52 offen offset:0 sc1
  v_fmac_f32 v152, v48, v65
  v_fmac_f32 v153, v50, v65
  v_fmac_f32 v154, v52, v65
  v_fmac_f32 v155, v54, v65
  v_mul_f32 v152, v152, v49
  v_mul_f32 v153, v153, v51
  v_mul_f32 v154, v154, v53
  v_mul_f32 v155, v155, v55
  v_cvt_pk_bf16_f32 v6, v152, v153
  v_cvt_pk_bf16_f32 v7, v154, v155
  v_fmac_f32 v156, v56, v65
  v_fmac_f32 v157, v58, v65
  v_fmac_f32 v158, v60, v65
  v_fmac_f32 v159, v62, v65
  v_mul_f32 v156, v156, v57
  v_mul_f32 v157, v157, v59
  v_mul_f32 v158, v158, v61
  v_mul_f32 v159, v159, v63
  v_cvt_pk_bf16_f32 v8, v156, v157
  v_cvt_pk_bf16_f32 v9, v158, v159
  buffer_store_dwordx4 v[6:9], v26, s[36:39], s52 offen offset:256 sc1
L_k1_fin:
L_k1_end:
  s_endpgm
.section .rodata,"a"
.p2align 6
.amdhsa_kernel k1_gemm_kernel
  .amdhsa_next_free_vgpr 256
  .amdhsa_next_free_sgpr 102
  .amdhsa_accum_offset 256
  .amdhsa_group_segment_fixed_size 0
  .amdhsa_kernarg_size 80
  .amdhsa_user_sgpr_count 2
  .amdhsa_user_sgpr_kernarg_segment_ptr 1
  .amdhsa_system_sgpr_workgroup_id_x 1
  .amdhsa_float_denorm_mode_32 3
.end_amdhsa_kernel
.text
.globl k2_attn_kernel
.p2align 8
.type k2_attn_kernel,@function
k2_attn_kernel:
  s_cmp_ge_u32 s2, 256
  s_cbranch_scc1 L_k2_end
  s_load_dwordx2 s[4:5], s[0:1], 48
  s_load_dwordx2 s[6:7], s[0:1], 72
  s_load_dwordx2 s[20:21], s[0:1], 0
  s_load_dwordx2 s[22:23], s[0:1], 56
  s_load_dwordx2 s[32:33], s[0:1], 16
  v_and_b32 v4, 63, v0
  v_lshrrev_b32 v2, 6, v0
  v_lshlrev_b32 v1, 4, v4
  s_mov_b32 s60, s2
  s_mov_b32 s61, 0
  v_readfirstlane_b32 s39, v2
  s_lshr_b32 s3, s2, 3
  s_lshr_b32 s69, s3, 2
  s_and_b32 s3, s3, 3
  s_and_b32 s67, s2, 6
  s_lshl_b32 s67, s67, 1
  s_add_u32 s67, s67, s3
  s_lshr_b32 s66, s67, 1
  s_and_b32 s3, s39, 3
  s_lshl_b32 s67, s67, 2
  s_add_u32 s67, s67, s3
  s_lshl_b32 s64, s3, 10
  s_lshl_b32 s65, s3, 14
  s_and_b32 s3, s2, 1
  s_lshl_b32 s68, s69, 1
  s_add_u32 s68, s68, s3
  s_lshl_b32 s63, s67, 10
  s_lshl_b32 s3, s68, 1
  s_add_u32 s63, s63, s3
  s_lshr_b32 s3, s39, 2
  s_add_u32 s63, s63, s3
  s_lshl_b32 s63, s63, 6
  v_and_b32 v5, 31, v4
  v_lshrrev_b32 v6, 5, v4
  v_lshlrev_b32 v5, 11, v5
  v_lshl_add_u32 v248, v6, 4, v5
  v_bfe_u32 v5, v4, 4, 1
  v_lshlrev_b32 v5, 2, v5
  v_and_b32 v6, 7, v4
  v_xor_b32 v5, v5, v6
  v_lshlrev_b32 v5, 4, v5
  v_lshrrev_b32 v6, 3, v4
  v_lshl_add_u32 v249, v6, 11, v5
  s_cmp_lt_u32 s39, 4
  s_mov_b32 s3, 28672
  s_cselect_b32 s3, 86016, s3
  s_add_u32 s3, s3, s64
  v_add_u32 v250, s3, v1
  s_add_u32 s3, s64, 151552
  v_add_u32 v251, s3, v1
  s_lshl_b32 s3, s68, 7
  s_waitcnt lgkmcnt(0)
  s_mov_b32 s8, s6
  s_mov_b32 s9, s7
  s_mov_b32 s10, 50331648
  s_mov_b32 s11, 0x20000
  s_mov_b32 s24, s20
  s_mov_b32 s25, s21
  s_mov_b32 s26, 4194304
  s_mov_b32 s27, 0x20000
  s_add_u32 s16, s32, s3
  s_addc_u32 s17, s33, 0
  s_sub_u32 s18, 2097152, s3
  s_mov_b32 s19, 0x20000
L_k2_task:
  s_mov_b32 s40, s39
  s_and_b32 s41, s60, 7
  s_lshl_b32 s41, s41, 2
  s_lshr_b32 s42, s60, 3
  s_and_b32 s3, s42, 3
  s_add_u32 s41, s41, s3
  s_lshr_b32 s42, s60, 5
  s_cmp_ge_u32 s40, 4
  s_cbranch_scc1 L_k2_down
  s_lshl_b32 s43, s41, 6
  s_lshl_b32 s44, s42, 3
  s_lshl_b32 s45, s40, 1
  s_add_u32 s44, s44, s45
  s_add_u32 s45, s43, s44
  s_lshl_b32 s45, s45, 11
  s_add_u32 s45, s45, 4194304
  s_lshl_b32 s46, s41, 18
  s_add_u32 s46, s46, 8388608
  buffer_load_dwordx4 v[16:19], v1, s[8:11], s45 offen offset:0
  buffer_load_dwordx4 v[20:23], v1, s[8:11], s45 offen offset:1024
  buffer_load_dwordx4 v[24:27], v1, s[8:11], s45 offen offset:2048
  buffer_load_dwordx4 v[28:31], v1, s[8:11], s45 offen offset:3072
  buffer_load_dwordx4 v[168:171], v1, s[8:11], s46 offen offset:0
  buffer_load_dwordx4 v[172:175], v1, s[8:11], s46 offen offset:1024
  v_mov_b32 v160, 0
  v_mov_b32 v161, 0
  v_mov_b32 v162, 0
  v_mov_b32 v163, 0
  v_mov_b32 v164, 0
  v_mov_b32 v165, 0
  v_mov_b32 v166, 0
  v_mov_b32 v167, 0
  v_mov_b32 v104, 0
  v_mov_b32 v105, 0
  v_mov_b32 v106, 0
  v_mov_b32 v107, 0
  v_mov_b32 v108, 0
  v_mov_b32 v109, 0
  v_mov_b32 v110, 0
  v_mov_b32 v111, 0
  v_mov_b32 v112, 0
  v_mov_b32 v113, 0
  v_mov_b32 v114, 0
  v_mov_b32 v115, 0
  v_mov_b32 v116, 0
  v_mov_b32 v117, 0
  v_mov_b32 v118, 0
  v_mov_b32 v119, 0
  v_mov_b32 v120, 0
  v_mov_b32 v121, 0
  v_mov_b32 v122, 0
  v_mov_b32 v123, 0
  v_mov_b32 v124, 0
  v_mov_b32 v125, 0
  v_mov_b32 v126, 0
  v_mov_b32 v127, 0
  v_mov_b32 v128, 0
  v_mov_b32 v129, 0
  v_mov_b32 v130, 0
  v_mov_b32 v131, 0
  v_mov_b32 v132, 0
  v_mov_b32 v133, 0
  v_mov_b32 v134, 0
  v_mov_b32 v135, 0
  v_mov_b32 v136, 0
  v_mov_b32 v137, 0
  v_mov_b32 v138, 0
  v_mov_b32 v139, 0
  v_mov_b32 v140, 0
  v_mov_b32 v141, 0
  v_mov_b32 v142, 0
  v_mov_b32 v143, 0
  v_mov_b32 v176, 0
  v_mov_b32 v177, 0
  v_mov_b32 v178, 0
  v_mov_b32 v179, 0
  v_mov_b32 v180, 0
  v_mov_b32 v181, 0
  v_mov_b32 v182, 0
  v_mov_b32 v183, 0
  v_and_b32 v3, 6, v0
  v_mov_b32 v4, 0x3f803f80
  v_cmp_eq_u32 vcc, 0, v3
  s_nop 1
  v_cndmask_b32 v8, 0, v4, vcc
  v_cndmask_b32 v9, 0, v4, vcc
  v_cmp_eq_u32 vcc, 4, v3
  s_nop 1
  v_cndmask_b32 v10, 0, v4, vcc
  v_cndmask_b32 v11, 0, v4, vcc
  v_and_b32 v3, 1, v0
  v_mov_b32 v4, 0x44444444
  v_mov_b32 v5, 0xeeeeeeee
  v_cmp_eq_u32 vcc, 0, v3
  s_nop 1
  v_cndmask_b32 v12, v5, v4, vcc
  v_add_u32 v2, 86016, v1
  v_mov_b32 v3, 159744
  ds_write_b128 v3, v[112:115]
  ds_write_b64 v3, v[112:113] offset:16
  s_mov_b32 s47, 0
  s_waitcnt vmcnt(0) lgkmcnt(0)
  v_mfma_f32_32x32x16_bf16 v[64:79], v[168:171], v[16:19], 0
  v_mfma_f32_32x32x16_bf16 v[80:95], v[168:171], v[24:27], 0
  v_mfma_f32_32x32x16_bf16 v[64:79], v[172:175], v[20:23], v[64:79]
  v_mfma_f32_32x32x16_bf16 v[80:95], v[172:175], v[28:31], v[80:95]
  s_nop 7
  s_nop 7
  v_max3_f32 v4, v64, v65, v66
  v_max3_f32 v4, v4, v67, v68
  v_max3_f32 v4, v4, v69, v70
  v_max3_f32 v4, v4, v71, v72
  v_max3_f32 v4, v4, v73, v74
  v_max3_f32 v4, v4, v75, v76
  v_max3_f32 v4, v4, v77, v78
  v_max_f32 v4, v4, v79
  v_max3_f32 v5, v80, v81, v82
  v_max3_f32 v5, v5, v83, v84
  v_max3_f32 v5, v5, v85, v86
  v_max3_f32 v5, v5, v87, v88
  v_max3_f32 v5, v5, v89, v90
  v_max3_f32 v5, v5, v91, v92
  v_max3_f32 v5, v5, v93, v94
  v_max_f32 v5, v5, v95
  v_mov_b32 v6, v4
  v_mov_b32 v7, v5
  s_nop 1
  v_permlane32_swap_b32 v4, v6
  v_permlane32_swap_b32 v5, v7
  s_nop 1
  v_max_f32 v4, v4, v6
  v_max_f32 v5, v5, v7
  v_sub_f32 v32, 0, v4
  v_sub_f32 v33, 0, v4
  v_sub_f32 v34, 0, v4
  v_sub_f32 v35, 0, v4
  v_sub_f32 v36, 0, v4
  v_sub_f32 v37, 0, v4
  v_sub_f32 v38, 0, v4
  v_sub_f32 v39, 0, v4
  v_sub_f32 v40, 0, v4
  v_sub_f32 v41, 0, v4
  v_sub_f32 v42, 0, v4
  v_sub_f32 v43, 0, v4
  v_sub_f32 v44, 0, v4
  v_sub_f32 v45, 0, v4
  v_sub_f32 v46, 0, v4
  v_sub_f32 v47, 0, v4
  v_sub_f32 v48, 0, v5
  v_sub_f32 v49, 0, v5
  v_sub_f32 v50, 0, v5
  v_sub_f32 v51, 0, v5
  v_sub_f32 v52, 0, v5
  v_sub_f32 v53, 0, v5
  v_sub_f32 v54, 0, v5
  v_sub_f32 v55, 0, v5
  v_sub_f32 v56, 0, v5
  v_sub_f32 v57, 0, v5
  v_sub_f32 v58, 0, v5
  v_sub_f32 v59, 0, v5
  v_sub_f32 v60, 0, v5
  v_sub_f32 v61, 0, v5
  v_sub_f32 v62, 0, v5
  v_sub_f32 v63, 0, v5
  s_nop 1
  v_mfma_f32_32x32x16_bf16 v[64:79], v[168:171], v[16:19], v[32:47]
  v_mfma_f32_32x32x16_bf16 v[64:79], v[172:175], v[20:23], v[64:79]
  s_mov_b32 s48, 13
  s_nop 7
  s_nop 7
L_attn_1:
  s_barrier
  v_mfma_f32_32x32x16_bf16 v[80:95], v[168:171], v[24:27], v[48:63]
  v_exp_f32 v64, v64
  ds_read_b128 v[152:155], v2 offset:2048
  v_exp_f32 v65, v65
  ds_read_b128 v[156:159], v2 offset:3072
  v_exp_f32 v66, v66
  ds_read_b128 v[144:147], v2 offset:0
  v_exp_f32 v67, v67
  v_cvt_pk_bf16_f32 v96, v64, v65
  v_cvt_pk_bf16_f32 v97, v66, v67
  v_mfma_f32_32x32x16_bf16 v[80:95], v[172:175], v[28:31], v[80:95]
  v_exp_f32 v68, v68
  ds_read_b128 v[148:151], v2 offset:1024
  v_exp_f32 v69, v69
  v_exp_f32 v70, v70
  v_exp_f32 v71, v71
  v_cvt_pk_bf16_f32 v98, v68, v69
  v_smfmac_f32_16x16x64_bf16 v[180:183], v[8:11], v[104:111], v12
  v_cvt_pk_bf16_f32 v99, v70, v71
  v_mfma_f32_32x32x16_bf16 v[128:143], v[160:163], v[104:107], v[128:143]
  v_exp_f32 v72, v72
  v_exp_f32 v73, v73
  v_exp_f32 v74, v74
  v_exp_f32 v75, v75
  v_cvt_pk_bf16_f32 v100, v72, v73
  v_cvt_pk_bf16_f32 v101, v74, v75
  v_mfma_f32_32x32x16_bf16 v[128:143], v[164:167], v[108:111], v[128:143]
  v_exp_f32 v76, v76
  v_exp_f32 v77, v77
  v_exp_f32 v78, v78
  v_exp_f32 v79, v79
  v_cvt_pk_bf16_f32 v102, v76, v77
  v_cvt_pk_bf16_f32 v103, v78, v79
  s_waitcnt lgkmcnt(0)
  v_mfma_f32_32x32x16_bf16 v[64:79], v[152:155], v[16:19], v[32:47]
  v_exp_f32 v80, v80
  v_exp_f32 v81, v81
  v_exp_f32 v82, v82
  v_exp_f32 v83, v83
  v_cvt_pk_bf16_f32 v104, v80, v81
  v_cvt_pk_bf16_f32 v105, v82, v83
  v_mfma_f32_32x32x16_bf16 v[64:79], v[156:159], v[20:23], v[64:79]
  v_exp_f32 v84, v84
  v_exp_f32 v85, v85
  v_exp_f32 v86, v86
  v_exp_f32 v87, v87
  v_cvt_pk_bf16_f32 v106, v84, v85
  v_smfmac_f32_16x16x64_bf16 v[176:179], v[8:11], v[96:103], v12
  v_cvt_pk_bf16_f32 v107, v86, v87
  v_mfma_f32_32x32x16_bf16 v[112:127], v[144:147], v[96:99], v[112:127]
  v_exp_f32 v88, v88
  v_exp_f32 v89, v89
  v_exp_f32 v90, v90
  v_exp_f32 v91, v91
  v_cvt_pk_bf16_f32 v108, v88, v89
  v_cvt_pk_bf16_f32 v109, v90, v91
  v_mfma_f32_32x32x16_bf16 v[112:127], v[148:151], v[100:103], v[112:127]
  v_exp_f32 v92, v92
  v_exp_f32 v93, v93
  v_exp_f32 v94, v94
  v_exp_f32 v95, v95
  v_cvt_pk_bf16_f32 v110, v92, v93
  v_cvt_pk_bf16_f32 v111, v94, v95
  v_mfma_f32_32x32x16_bf16 v[80:95], v[152:155], v[24:27], v[48:63]
  v_exp_f32 v64, v64
  ds_read_b128 v[168:171], v2 offset:6144
  v_exp_f32 v65, v65
  ds_read_b128 v[172:175], v2 offset:7168
  v_exp_f32 v66, v66
  ds_read_b128 v[160:163], v2 offset:4096
  v_exp_f32 v67, v67
  v_cvt_pk_bf16_f32 v96, v64, v65
  v_cvt_pk_bf16_f32 v97, v66, v67
  v_mfma_f32_32x32x16_bf16 v[80:95], v[156:159], v[28:31], v[80:95]
  v_exp_f32 v68, v68
  ds_read_b128 v[164:167], v2 offset:5120
  v_exp_f32 v69, v69
  v_exp_f32 v70, v70
  v_exp_f32 v71, v71
  v_cvt_pk_bf16_f32 v98, v68, v69
  v_smfmac_f32_16x16x64_bf16 v[180:183], v[8:11], v[104:111], v12
  v_cvt_pk_bf16_f32 v99, v70, v71
  v_mfma_f32_32x32x16_bf16 v[128:143], v[144:147], v[104:107], v[128:143]
  v_exp_f32 v72, v72
  v_exp_f32 v73, v73
  v_exp_f32 v74, v74
  v_exp_f32 v75, v75
  v_cvt_pk_bf16_f32 v100, v72, v73
  v_cvt_pk_bf16_f32 v101, v74, v75
  v_mfma_f32_32x32x16_bf16 v[128:143], v[148:151], v[108:111], v[128:143]
  v_exp_f32 v76, v76
  v_exp_f32 v77, v77
  v_exp_f32 v78, v78
  v_exp_f32 v79, v79
  v_cvt_pk_bf16_f32 v102, v76, v77
  v_cvt_pk_bf16_f32 v103, v78, v79
  s_waitcnt lgkmcnt(0)
  v_mfma_f32_32x32x16_bf16 v[64:79], v[168:171], v[16:19], v[32:47]
  v_exp_f32 v80, v80
  v_exp_f32 v81, v81
  v_exp_f32 v82, v82
  v_exp_f32 v83, v83
  v_cvt_pk_bf16_f32 v104, v80, v81
  v_cvt_pk_bf16_f32 v105, v82, v83
  v_mfma_f32_32x32x16_bf16 v[64:79], v[172:175], v[20:23], v[64:79]
  v_exp_f32 v84, v84
  v_exp_f32 v85, v85
  v_exp_f32 v86, v86
  v_exp_f32 v87, v87
  v_cvt_pk_bf16_f32 v106, v84, v85
  v_smfmac_f32_16x16x64_bf16 v[176:179], v[8:11], v[96:103], v12
  v_cvt_pk_bf16_f32 v107, v86, v87
  v_mfma_f32_32x32x16_bf16 v[112:127], v[160:163], v[96:99], v[112:127]
  v_exp_f32 v88, v88
  v_exp_f32 v89, v89
  v_exp_f32 v90, v90
  v_exp_f32 v91, v91
  v_cvt_pk_bf16_f32 v108, v88, v89
  v_cvt_pk_bf16_f32 v109, v90, v91
  v_mfma_f32_32x32x16_bf16 v[112:127], v[164:167], v[100:103], v[112:127]
  v_exp_f32 v92, v92
  v_exp_f32 v93, v93
  v_exp_f32 v94, v94
  v_exp_f32 v95, v95
  v_cvt_pk_bf16_f32 v110, v92, v93
  v_cvt_pk_bf16_f32 v111, v94, v95
  v_mfma_f32_32x32x16_bf16 v[80:95], v[168:171], v[24:27], v[48:63]
  v_exp_f32 v64, v64
  ds_read_b128 v[152:155], v2 offset:10240
  v_exp_f32 v65, v65
  ds_read_b128 v[156:159], v2 offset:11264
  v_exp_f32 v66, v66
  ds_read_b128 v[144:147], v2 offset:8192
  v_exp_f32 v67, v67
  v_cvt_pk_bf16_f32 v96, v64, v65
  v_cvt_pk_bf16_f32 v97, v66, v67
  v_mfma_f32_32x32x16_bf16 v[80:95], v[172:175], v[28:31], v[80:95]
  v_exp_f32 v68, v68
  ds_read_b128 v[148:151], v2 offset:9216
  v_exp_f32 v69, v69
  v_exp_f32 v70, v70
  v_exp_f32 v71, v71
  v_cvt_pk_bf16_f32 v98, v68, v69
  v_smfmac_f32_16x16x64_bf16 v[180:183], v[8:11], v[104:111], v12
  v_cvt_pk_bf16_f32 v99, v70, v71
  v_mfma_f32_32x32x16_bf16 v[128:143], v[160:163], v[104:107], v[128:143]
  v_exp_f32 v72, v72
  v_exp_f32 v73, v73
  v_exp_f32 v74, v74
  v_exp_f32 v75, v75
  v_cvt_pk_bf16_f32 v100, v72, v73
  v_cvt_pk_bf16_f32 v101, v74, v75
  v_mfma_f32_32x32x16_bf16 v[128:143], v[164:167], v[108:111], v[128:143]
  v_exp_f32 v76, v76
  v_exp_f32 v77, v77
  v_exp_f32 v78, v78
  v_exp_f32 v79, v79
  v_cvt_pk_bf16_f32 v102, v76, v77
  v_cvt_pk_bf16_f32 v103, v78, v79
  s_waitcnt lgkmcnt(0)
  v_mfma_f32_32x32x16_bf16 v[64:79], v[152:155], v[16:19], v[32:47]
  v_exp_f32 v80, v80
  v_exp_f32 v81, v81
  v_exp_f32 v82, v82
  v_exp_f32 v83, v83
  v_cvt_pk_bf16_f32 v104, v80, v81
  v_cvt_pk_bf16_f32 v105, v82, v83
  v_mfma_f32_32x32x16_bf16 v[64:79], v[156:159], v[20:23], v[64:79]
  v_exp_f32 v84, v84
  v_exp_f32 v85, v85
  v_exp_f32 v86, v86
  v_exp_f32 v87, v87
  v_cvt_pk_bf16_f32 v106, v84, v85
  v_smfmac_f32_16x16x64_bf16 v[176:179], v[8:11], v[96:103], v12
  v_cvt_pk_bf16_f32 v107, v86, v87
  v_mfma_f32_32x32x16_bf16 v[112:127], v[144:147], v[96:99], v[112:127]
  v_exp_f32 v88, v88
  v_exp_f32 v89, v89
  v_exp_f32 v90, v90
  v_exp_f32 v91, v91
  v_cvt_pk_bf16_f32 v108, v88, v89
  v_cvt_pk_bf16_f32 v109, v90, v91
  v_mfma_f32_32x32x16_bf16 v[112:127], v[148:151], v[100:103], v[112:127]
  v_exp_f32 v92, v92
  v_exp_f32 v93, v93
  v_exp_f32 v94, v94
  v_exp_f32 v95, v95
  v_cvt_pk_bf16_f32 v110, v92, v93
  v_cvt_pk_bf16_f32 v111, v94, v95
  v_mfma_f32_32x32x16_bf16 v[80:95], v[152:155], v[24:27], v[48:63]
  v_exp_f32 v64, v64
  ds_read_b128 v[168:171], v2 offset:14336
  v_exp_f32 v65, v65
  ds_read_b128 v[172:175], v2 offset:15360
  v_exp_f32 v66, v66
  ds_read_b128 v[160:163], v2 offset:12288
  v_exp_f32 v67, v67
  v_cvt_pk_bf16_f32 v96, v64, v65
  v_cvt_pk_bf16_f32 v97, v66, v67
  v_mfma_f32_32x32x16_bf16 v[80:95], v[156:159], v[28:31], v[80:95]
  v_exp_f32 v68, v68
  ds_read_b128 v[164:167], v2 offset:13312
  v_exp_f32 v69, v69
  v_exp_f32 v70, v70
  v_exp_f32 v71, v71
  v_cvt_pk_bf16_f32 v98, v68, v69
  v_smfmac_f32_16x16x64_bf16 v[180:183], v[8:11], v[104:111], v12
  v_cvt_pk_bf16_f32 v99, v70, v71
  v_mfma_f32_32x32x16_bf16 v[128:143], v[144:147], v[104:107], v[128:143]
  v_exp_f32 v72, v72
  v_exp_f32 v73, v73
  v_exp_f32 v74, v74
  v_exp_f32 v75, v75
  v_cvt_pk_bf16_f32 v100, v72, v73
  v_cvt_pk_bf16_f32 v101, v74, v75
  v_mfma_f32_32x32x16_bf16 v[128:143], v[148:151], v[108:111], v[128:143]
  v_exp_f32 v76, v76
  v_exp_f32 v77, v77
  v_exp_f32 v78, v78
  v_exp_f32 v79, v79
  v_cvt_pk_bf16_f32 v102, v76, v77
  v_cvt_pk_bf16_f32 v103, v78, v79
  s_waitcnt lgkmcnt(0)
  v_mfma_f32_32x32x16_bf16 v[64:79], v[168:171], v[16:19], v[32:47]
  v_exp_f32 v80, v80
  s_add_u32 s47, s47, 24576
  v_exp_f32 v81, v81
  s_cmp_eq_u32 s47, 73728
  v_exp_f32 v82, v82
  s_cselect_b32 s47, 0, s47
  v_exp_f32 v83, v83
  v_cvt_pk_bf16_f32 v104, v80, v81
  v_cvt_pk_bf16_f32 v105, v82, v83
  v_mfma_f32_32x32x16_bf16 v[64:79], v[172:175], v[20:23], v[64:79]
  v_exp_f32 v84, v84
  s_add_u32 s49, s47, 86016
  v_exp_f32 v85, v85
  s_sub_u32 s48, s48, 1
  v_exp_f32 v86, v86
  s_cmp_lg_u32 s48, 0
  v_exp_f32 v87, v87
  v_cvt_pk_bf16_f32 v106, v84, v85
  v_smfmac_f32_16x16x64_bf16 v[176:179], v[8:11], v[96:103], v12
  v_cvt_pk_bf16_f32 v107, v86, v87
  v_mfma_f32_32x32x16_bf16 v[112:127], v[160:163], v[96:99], v[112:127]
  v_exp_f32 v88, v88
  v_exp_f32 v89, v89
  v_exp_f32 v90, v90
  v_exp_f32 v91, v91
  v_cvt_pk_bf16_f32 v108, v88, v89
  v_cvt_pk_bf16_f32 v109, v90, v91
  v_mfma_f32_32x32x16_bf16 v[112:127], v[164:167], v[100:103], v[112:127]
  v_exp_f32 v92, v92
  v_exp_f32 v93, v93
  v_exp_f32 v94, v94
  v_exp_f32 v95, v95
  v_cvt_pk_bf16_f32 v110, v92, v93
  v_cvt_pk_bf16_f32 v111, v94, v95
  v_add_u32 v2, s49, v1
  s_cbranch_scc0 L_attn_1x
  s_cmp_eq_u32 s48, 10
  s_cbranch_scc1 L_attn_1p0
  s_cmp_eq_u32 s48, 8
  s_cbranch_scc1 L_attn_1p1
  s_cmp_eq_u32 s48, 6
  s_cbranch_scc1 L_attn_1p2
  s_cmp_eq_u32 s48, 4
  s_cbranch_scc1 L_attn_1p3
  s_branch L_attn_1
L_attn_1p0:
  s_add_u32 s56, s65, 0
  buffer_load_dwordx4 v[184:187], v249, s[16:19], s56 offen
  s_add_u32 s56, s65, 65536
  buffer_load_dwordx4 v[188:191], v249, s[16:19], s56 offen
  s_add_u32 s56, s65, 131072
  buffer_load_dwordx4 v[192:195], v249, s[16:19], s56 offen
  s_add_u32 s56, s65, 196608
  buffer_load_dwordx4 v[196:199], v249, s[16:19], s56 offen
  s_branch L_attn_1
L_attn_1p1:
  s_add_u32 s56, s65, 262144
  buffer_load_dwordx4 v[200:203], v249, s[16:19], s56 offen
  s_add_u32 s56, s65, 327680
  buffer_load_dwordx4 v[204:207], v249, s[16:19], s56 offen
  s_add_u32 s56, s65, 393216
  buffer_load_dwordx4 v[208:211], v249, s[16:19], s56 offen
  s_add_u32 s56, s65, 458752
  buffer_load_dwordx4 v[212:215], v249, s[16:19], s56 offen
  s_branch L_attn_1
L_attn_1p2:
  s_add_u32 s56, s65, 524288
  buffer_load_dwordx4 v[216:219], v249, s[16:19], s56 offen
  s_add_u32 s56, s65, 589824
  buffer_load_dwordx4 v[220:223], v249, s[16:19], s56 offen
  s_add_u32 s56, s65, 655360
  buffer_load_dwordx4 v[224:227], v249, s[16:19], s56 offen
  s_add_u32 s56, s65, 720896
  buffer_load_dwordx4 v[228:231], v249, s[16:19], s56 offen
  s_branch L_attn_1
L_attn_1p3:
  s_add_u32 s56, s65, 786432
  buffer_load_dwordx4 v[232:235], v249, s[16:19], s56 offen
  s_add_u32 s56, s65, 851968
  buffer_load_dwordx4 v[236:239], v249, s[16:19], s56 offen
  s_add_u32 s56, s65, 917504
  buffer_load_dwordx4 v[240:243], v249, s[16:19], s56 offen
  s_add_u32 s56, s65, 983040
  buffer_load_dwordx4 v[244:247], v249, s[16:19], s56 offen
  s_branch L_attn_1
L_attn_1x:
  s_mov_b32 s48, 2
L_attn_1b:
  s_barrier
  v_mfma_f32_32x32x16_bf16 v[80:95], v[168:171], v[24:27], v[48:63]
  v_exp_f32 v64, v64
  ds_read_b128 v[152:155], v2 offset:2048
  v_exp_f32 v65, v65
  ds_read_b128 v[156:159], v2 offset:3072
  v_exp_f32 v66, v66
  ds_read_b128 v[144:147], v2 offset:0
  v_exp_f32 v67, v67
  v_cvt_pk_bf16_f32 v96, v64, v65
  v_cvt_pk_bf16_f32 v97, v66, v67
  v_mfma_f32_32x32x16_bf16 v[80:95], v[172:175], v[28:31], v[80:95]
  v_exp_f32 v68, v68
  ds_read_b128 v[148:151], v2 offset:1024
  v_exp_f32 v69, v69
  v_exp_f32 v70, v70
  v_exp_f32 v71, v71
  v_cvt_pk_bf16_f32 v98, v68, v69
  v_smfmac_f32_16x16x64_bf16 v[180:183], v[8:11], v[104:111], v12
  v_cvt_pk_bf16_f32 v99, v70, v71
  v_mfma_f32_32x32x16_bf16 v[128:143], v[160:163], v[104:107], v[128:143]
  v_exp_f32 v72, v72
  v_exp_f32 v73, v73
  v_exp_f32 v74, v74
  v_exp_f32 v75, v75
  v_cvt_pk_bf16_f32 v100, v72, v73
  v_cvt_pk_bf16_f32 v101, v74, v75
  v_mfma_f32_32x32x16_bf16 v[128:143], v[164:167], v[108:111], v[128:143]
  v_exp_f32 v76, v76
  v_exp_f32 v77, v77
  v_exp_f32 v78, v78
  v_exp_f32 v79, v79
  v_cvt_pk_bf16_f32 v102, v76, v77
  v_cvt_pk_bf16_f32 v103, v78, v79
  s_waitcnt lgkmcnt(0)
  v_mfma_f32_32x32x16_bf16 v[64:79], v[152:155], v[16:19], v[32:47]
  v_exp_f32 v80, v80
  v_exp_f32 v81, v81
  v_exp_f32 v82, v82
  v_exp_f32 v83, v83
  v_cvt_pk_bf16_f32 v104, v80, v81
  v_cvt_pk_bf16_f32 v105, v82, v83
  v_mfma_f32_32x32x16_bf16 v[64:79], v[156:159], v[20:23], v[64:79]
  v_exp_f32 v84, v84
  v_exp_f32 v85, v85
  v_exp_f32 v86, v86
  v_exp_f32 v87, v87
  v_cvt_pk_bf16_f32 v106, v84, v85
  v_smfmac_f32_16x16x64_bf16 v[176:179], v[8:11], v[96:103], v12
  v_cvt_pk_bf16_f32 v107, v86, v87
  v_mfma_f32_32x32x16_bf16 v[112:127], v[144:147], v[96:99], v[112:127]
  v_exp_f32 v88, v88
  v_exp_f32 v89, v89
  v_exp_f32 v90, v90
  v_exp_f32 v91, v91
  v_cvt_pk_bf16_f32 v108, v88, v89
  v_cvt_pk_bf16_f32 v109, v90, v91
  v_mfma_f32_32x32x16_bf16 v[112:127], v[148:151], v[100:103], v[112:127]
  v_exp_f32 v92, v92
  v_exp_f32 v93, v93
  v_exp_f32 v94, v94
  v_exp_f32 v95, v95
  v_cvt_pk_bf16_f32 v110, v92, v93
  v_cvt_pk_bf16_f32 v111, v94, v95
  v_mfma_f32_32x32x16_bf16 v[80:95], v[152:155], v[24:27], v[48:63]
  v_exp_f32 v64, v64
  ds_read_b128 v[168:171], v2 offset:6144
  v_exp_f32 v65, v65
  ds_read_b128 v[172:175], v2 offset:7168
  v_exp_f32 v66, v66
  ds_read_b128 v[160:163], v2 offset:4096
  v_exp_f32 v67, v67
  v_cvt_pk_bf16_f32 v96, v64, v65
  v_cvt_pk_bf16_f32 v97, v66, v67
  v_mfma_f32_32x32x16_bf16 v[80:95], v[156:159], v[28:31], v[80:95]
  v_exp_f32 v68, v68
  ds_read_b128 v[164:167], v2 offset:5120
  v_exp_f32 v69, v69
  v_exp_f32 v70, v70
  v_exp_f32 v71, v71
  v_cvt_pk_bf16_f32 v98, v68, v69
  v_smfmac_f32_16x16x64_bf16 v[180:183], v[8:11], v[104:111], v12
  v_cvt_pk_bf16_f32 v99, v70, v71
  v_mfma_f32_32x32x16_bf16 v[128:143], v[144:147], v[104:107], v[128:143]
  v_exp_f32 v72, v72
  v_exp_f32 v73, v73
  v_exp_f32 v74, v74
  v_exp_f32 v75, v75
  v_cvt_pk_bf16_f32 v100, v72, v73
  v_cvt_pk_bf16_f32 v101, v74, v75
  v_mfma_f32_32x32x16_bf16 v[128:143], v[148:151], v[108:111], v[128:143]
  v_exp_f32 v76, v76
  v_exp_f32 v77, v77
  v_exp_f32 v78, v78
  v_exp_f32 v79, v79
  v_cvt_pk_bf16_f32 v102, v76, v77
  v_cvt_pk_bf16_f32 v103, v78, v79
  s_waitcnt lgkmcnt(0)
  v_mfma_f32_32x32x16_bf16 v[64:79], v[168:171], v[16:19], v[32:47]
  v_exp_f32 v80, v80
  v_exp_f32 v81, v81
  v_exp_f32 v82, v82
  v_exp_f32 v83, v83
  v_cvt_pk_bf16_f32 v104, v80, v81
  v_cvt_pk_bf16_f32 v105, v82, v83
  v_mfma_f32_32x32x16_bf16 v[64:79], v[172:175], v[20:23], v[64:79]
  v_exp_f32 v84, v84
  v_exp_f32 v85, v85
  v_exp_f32 v86, v86
  v_exp_f32 v87, v87
  v_cvt_pk_bf16_f32 v106, v84, v85
  v_smfmac_f32_16x16x64_bf16 v[176:179], v[8:11], v[96:103], v12
  v_cvt_pk_bf16_f32 v107, v86, v87
  v_mfma_f32_32x32x16_bf16 v[112:127], v[160:163], v[96:99], v[112:127]
  v_exp_f32 v88, v88
  v_exp_f32 v89, v89
  v_exp_f32 v90, v90
  v_exp_f32 v91, v91
  v_cvt_pk_bf16_f32 v108, v88, v89
  v_cvt_pk_bf16_f32 v109, v90, v91
  v_mfma_f32_32x32x16_bf16 v[112:127], v[164:167], v[100:103], v[112:127]
  v_exp_f32 v92, v92
  v_exp_f32 v93, v93
  v_exp_f32 v94, v94
  v_exp_f32 v95, v95
  v_cvt_pk_bf16_f32 v110, v92, v93
  v_cvt_pk_bf16_f32 v111, v94, v95
  v_mfma_f32_32x32x16_bf16 v[80:95], v[168:171], v[24:27], v[48:63]
  v_exp_f32 v64, v64
  ds_read_b128 v[152:155], v2 offset:10240
  v_exp_f32 v65, v65
  ds_read_b128 v[156:159], v2 offset:11264
  v_exp_f32 v66, v66
  ds_read_b128 v[144:147], v2 offset:8192
  v_exp_f32 v67, v67
  v_cvt_pk_bf16_f32 v96, v64, v65
  v_cvt_pk_bf16_f32 v97, v66, v67
  v_mfma_f32_32x32x16_bf16 v[80:95], v[172:175], v[28:31], v[80:95]
  v_exp_f32 v68, v68
  ds_read_b128 v[148:151], v2 offset:9216
  v_exp_f32 v69, v69
  v_exp_f32 v70, v70
  v_exp_f32 v71, v71
  v_cvt_pk_bf16_f32 v98, v68, v69
  v_smfmac_f32_16x16x64_bf16 v[180:183], v[8:11], v[104:111], v12
  v_cvt_pk_bf16_f32 v99, v70, v71
  v_mfma_f32_32x32x16_bf16 v[128:143], v[160:163], v[104:107], v[128:143]
  v_exp_f32 v72, v72
  v_exp_f32 v73, v73
  v_exp_f32 v74, v74
  v_exp_f32 v75, v75
  v_cvt_pk_bf16_f32 v100, v72, v73
  v_cvt_pk_bf16_f32 v101, v74, v75
  v_mfma_f32_32x32x16_bf16 v[128:143], v[164:167], v[108:111], v[128:143]
  v_exp_f32 v76, v76
  v_exp_f32 v77, v77
  v_exp_f32 v78, v78
  v_exp_f32 v79, v79
  v_cvt_pk_bf16_f32 v102, v76, v77
  v_cvt_pk_bf16_f32 v103, v78, v79
  s_waitcnt lgkmcnt(0)
  v_mfma_f32_32x32x16_bf16 v[64:79], v[152:155], v[16:19], v[32:47]
  v_exp_f32 v80, v80
  v_exp_f32 v81, v81
  v_exp_f32 v82, v82
  v_exp_f32 v83, v83
  v_cvt_pk_bf16_f32 v104, v80, v81
  v_cvt_pk_bf16_f32 v105, v82, v83
  v_mfma_f32_32x32x16_bf16 v[64:79], v[156:159], v[20:23], v[64:79]
  v_exp_f32 v84, v84
  v_exp_f32 v85, v85
  v_exp_f32 v86, v86
  v_exp_f32 v87, v87
  v_cvt_pk_bf16_f32 v106, v84, v85
  v_smfmac_f32_16x16x64_bf16 v[176:179], v[8:11], v[96:103], v12
  v_cvt_pk_bf16_f32 v107, v86, v87
  v_mfma_f32_32x32x16_bf16 v[112:127], v[144:147], v[96:99], v[112:127]
  v_exp_f32 v88, v88
  v_exp_f32 v89, v89
  v_exp_f32 v90, v90
  v_exp_f32 v91, v91
  v_cvt_pk_bf16_f32 v108, v88, v89
  v_cvt_pk_bf16_f32 v109, v90, v91
  v_mfma_f32_32x32x16_bf16 v[112:127], v[148:151], v[100:103], v[112:127]
  v_exp_f32 v92, v92
  v_exp_f32 v93, v93
  v_exp_f32 v94, v94
  v_exp_f32 v95, v95
  v_cvt_pk_bf16_f32 v110, v92, v93
  v_cvt_pk_bf16_f32 v111, v94, v95
  v_mfma_f32_32x32x16_bf16 v[80:95], v[152:155], v[24:27], v[48:63]
  v_exp_f32 v64, v64
  ds_read_b128 v[168:171], v2 offset:14336
  v_exp_f32 v65, v65
  ds_read_b128 v[172:175], v2 offset:15360
  v_exp_f32 v66, v66
  ds_read_b128 v[160:163], v2 offset:12288
  v_exp_f32 v67, v67
  v_cvt_pk_bf16_f32 v96, v64, v65
  v_cvt_pk_bf16_f32 v97, v66, v67
  v_mfma_f32_32x32x16_bf16 v[80:95], v[156:159], v[28:31], v[80:95]
  v_exp_f32 v68, v68
  ds_read_b128 v[164:167], v2 offset:13312
  v_exp_f32 v69, v69
  v_exp_f32 v70, v70
  v_exp_f32 v71, v71
  v_cvt_pk_bf16_f32 v98, v68, v69
  v_smfmac_f32_16x16x64_bf16 v[180:183], v[8:11], v[104:111], v12
  v_cvt_pk_bf16_f32 v99, v70, v71
  v_mfma_f32_32x32x16_bf16 v[128:143], v[144:147], v[104:107], v[128:143]
  v_exp_f32 v72, v72
  v_exp_f32 v73, v73
  v_exp_f32 v74, v74
  v_exp_f32 v75, v75
  v_cvt_pk_bf16_f32 v100, v72, v73
  v_cvt_pk_bf16_f32 v101, v74, v75
  v_mfma_f32_32x32x16_bf16 v[128:143], v[148:151], v[108:111], v[128:143]
  v_exp_f32 v76, v76
  v_exp_f32 v77, v77
  v_exp_f32 v78, v78
  v_exp_f32 v79, v79
  v_cvt_pk_bf16_f32 v102, v76, v77
  v_cvt_pk_bf16_f32 v103, v78, v79
  s_waitcnt lgkmcnt(0)
  v_mfma_f32_32x32x16_bf16 v[64:79], v[168:171], v[16:19], v[32:47]
  v_exp_f32 v80, v80
  v_exp_f32 v81, v81
  v_exp_f32 v82, v82
  v_exp_f32 v83, v83
  v_cvt_pk_bf16_f32 v104, v80, v81
  v_cvt_pk_bf16_f32 v105, v82, v83
  v_mfma_f32_32x32x16_bf16 v[64:79], v[172:175], v[20:23], v[64:79]
  v_exp_f32 v84, v84
  v_exp_f32 v85, v85
  v_exp_f32 v86, v86
  v_exp_f32 v87, v87
  v_cvt_pk_bf16_f32 v106, v84, v85
  v_smfmac_f32_16x16x64_bf16 v[176:179], v[8:11], v[96:103], v12
  v_cvt_pk_bf16_f32 v107, v86, v87
  v_mfma_f32_32x32x16_bf16 v[112:127], v[160:163], v[96:99], v[112:127]
  v_exp_f32 v88, v88
  v_exp_f32 v89, v89
  v_exp_f32 v90, v90
  v_exp_f32 v91, v91
  v_cvt_pk_bf16_f32 v108, v88, v89
  v_cvt_pk_bf16_f32 v109, v90, v91
  v_mfma_f32_32x32x16_bf16 v[112:127], v[164:167], v[100:103], v[112:127]
  v_exp_f32 v92, v92
  v_exp_f32 v93, v93
  v_exp_f32 v94, v94
  v_exp_f32 v95, v95
  v_cvt_pk_bf16_f32 v110, v92, v93
  v_cvt_pk_bf16_f32 v111, v94, v95
  v_mfma_f32_32x32x16_bf16 v[80:95], v[168:171], v[24:27], v[48:63]
  v_exp_f32 v64, v64
  ds_read_b128 v[152:155], v2 offset:18432
  v_exp_f32 v65, v65
  ds_read_b128 v[156:159], v2 offset:19456
  v_exp_f32 v66, v66
  ds_read_b128 v[144:147], v2 offset:16384
  v_exp_f32 v67, v67
  v_cvt_pk_bf16_f32 v96, v64, v65
  v_cvt_pk_bf16_f32 v97, v66, v67
  v_mfma_f32_32x32x16_bf16 v[80:95], v[172:175], v[28:31], v[80:95]
  v_exp_f32 v68, v68
  ds_read_b128 v[148:151], v2 offset:17408
  v_exp_f32 v69, v69
  v_exp_f32 v70, v70
  v_exp_f32 v71, v71
  v_cvt_pk_bf16_f32 v98, v68, v69
  v_smfmac_f32_16x16x64_bf16 v[180:183], v[8:11], v[104:111], v12
  v_cvt_pk_bf16_f32 v99, v70, v71
  v_mfma_f32_32x32x16_bf16 v[128:143], v[160:163], v[104:107], v[128:143]
  v_exp_f32 v72, v72
  v_exp_f32 v73, v73
  v_exp_f32 v74, v74
  v_exp_f32 v75, v75
  v_cvt_pk_bf16_f32 v100, v72, v73
  v_cvt_pk_bf16_f32 v101, v74, v75
  v_mfma_f32_32x32x16_bf16 v[128:143], v[164:167], v[108:111], v[128:143]
  v_exp_f32 v76, v76
  v_exp_f32 v77, v77
  v_exp_f32 v78, v78
  v_exp_f32 v79, v79
  v_cvt_pk_bf16_f32 v102, v76, v77
  v_cvt_pk_bf16_f32 v103, v78, v79
  s_waitcnt lgkmcnt(0)
  v_mfma_f32_32x32x16_bf16 v[64:79], v[152:155], v[16:19], v[32:47]
  v_exp_f32 v80, v80
  v_exp_f32 v81, v81
  v_exp_f32 v82, v82
  v_exp_f32 v83, v83
  v_cvt_pk_bf16_f32 v104, v80, v81
  v_cvt_pk_bf16_f32 v105, v82, v83
  v_mfma_f32_32x32x16_bf16 v[64:79], v[156:159], v[20:23], v[64:79]
  v_exp_f32 v84, v84
  v_exp_f32 v85, v85
  v_exp_f32 v86, v86
  v_exp_f32 v87, v87
  v_cvt_pk_bf16_f32 v106, v84, v85
  v_smfmac_f32_16x16x64_bf16 v[176:179], v[8:11], v[96:103], v12
  v_cvt_pk_bf16_f32 v107, v86, v87
  v_mfma_f32_32x32x16_bf16 v[112:127], v[144:147], v[96:99], v[112:127]
  v_exp_f32 v88, v88
  v_exp_f32 v89, v89
  v_exp_f32 v90, v90
  v_exp_f32 v91, v91
  v_cvt_pk_bf16_f32 v108, v88, v89
  v_cvt_pk_bf16_f32 v109, v90, v91
  v_mfma_f32_32x32x16_bf16 v[112:127], v[148:151], v[100:103], v[112:127]
  v_exp_f32 v92, v92
  v_exp_f32 v93, v93
  v_exp_f32 v94, v94
  v_exp_f32 v95, v95
  v_cvt_pk_bf16_f32 v110, v92, v93
  v_cvt_pk_bf16_f32 v111, v94, v95
  v_mfma_f32_32x32x16_bf16 v[80:95], v[152:155], v[24:27], v[48:63]
  v_exp_f32 v64, v64
  ds_read_b128 v[168:171], v2 offset:22528
  v_exp_f32 v65, v65
  ds_read_b128 v[172:175], v2 offset:23552
  v_exp_f32 v66, v66
  ds_read_b128 v[160:163], v2 offset:20480
  v_exp_f32 v67, v67
  v_cvt_pk_bf16_f32 v96, v64, v65
  v_cvt_pk_bf16_f32 v97, v66, v67
  v_mfma_f32_32x32x16_bf16 v[80:95], v[156:159], v[28:31], v[80:95]
  v_exp_f32 v68, v68
  ds_read_b128 v[164:167], v2 offset:21504
  v_exp_f32 v69, v69
  v_exp_f32 v70, v70
  v_exp_f32 v71, v71
  v_cvt_pk_bf16_f32 v98, v68, v69
  v_smfmac_f32_16x16x64_bf16 v[180:183], v[8:11], v[104:111], v12
  v_cvt_pk_bf16_f32 v99, v70, v71
  v_mfma_f32_32x32x16_bf16 v[128:143], v[144:147], v[104:107], v[128:143]
  v_exp_f32 v72, v72
  v_exp_f32 v73, v73
  v_exp_f32 v74, v74
  v_exp_f32 v75, v75
  v_cvt_pk_bf16_f32 v100, v72, v73
  v_cvt_pk_bf16_f32 v101, v74, v75
  v_mfma_f32_32x32x16_bf16 v[128:143], v[148:151], v[108:111], v[128:143]
  v_exp_f32 v76, v76
  v_exp_f32 v77, v77
  v_exp_f32 v78, v78
  v_exp_f32 v79, v79
  v_cvt_pk_bf16_f32 v102, v76, v77
  v_cvt_pk_bf16_f32 v103, v78, v79
  s_waitcnt lgkmcnt(0)
  v_mfma_f32_32x32x16_bf16 v[64:79], v[168:171], v[16:19], v[32:47]
  v_exp_f32 v80, v80
  s_add_u32 s47, s47, 24576
  v_exp_f32 v81, v81
  s_cmp_eq_u32 s47, 73728
  v_exp_f32 v82, v82
  s_cselect_b32 s47, 0, s47
  v_exp_f32 v83, v83
  v_cvt_pk_bf16_f32 v104, v80, v81
  v_cvt_pk_bf16_f32 v105, v82, v83
  v_mfma_f32_32x32x16_bf16 v[64:79], v[172:175], v[20:23], v[64:79]
  v_exp_f32 v84, v84
  s_add_u32 s49, s47, 86016
  v_exp_f32 v85, v85
  s_sub_u32 s48, s48, 1
  v_exp_f32 v86, v86
  s_cmp_lg_u32 s48, 0
  v_exp_f32 v87, v87
  v_cvt_pk_bf16_f32 v106, v84, v85
  v_smfmac_f32_16x16x64_bf16 v[176:179], v[8:11], v[96:103], v12
  v_cvt_pk_bf16_f32 v107, v86, v87
  v_mfma_f32_32x32x16_bf16 v[112:127], v[160:163], v[96:99], v[112:127]
  v_exp_f32 v88, v88
  v_exp_f32 v89, v89
  v_exp_f32 v90, v90
  v_exp_f32 v91, v91
  v_cvt_pk_bf16_f32 v108, v88, v89
  v_cvt_pk_bf16_f32 v109, v90, v91
  v_mfma_f32_32x32x16_bf16 v[112:127], v[164:167], v[100:103], v[112:127]
  v_exp_f32 v92, v92
  v_exp_f32 v93, v93
  v_exp_f32 v94, v94
  v_exp_f32 v95, v95
  v_cvt_pk_bf16_f32 v110, v92, v93
  v_cvt_pk_bf16_f32 v111, v94, v95
  v_add_u32 v2, s49, v1
  s_cbranch_scc1 L_attn_1b
  v_mfma_f32_32x32x16_bf16 v[128:143], v[160:163], v[104:107], v[128:143]
  v_smfmac_f32_16x16x64_bf16 v[180:183], v[8:11], v[104:111], v12
  v_mfma_f32_32x32x16_bf16 v[128:143], v[164:167], v[108:111], v[128:143]
  s_nop 7
  v_add_f32 v4, v176, v177
  v_add_f32 v5, v180, v181
  s_mov_b32 s50, 0x5d800000
  v_add_f32 v7, v4, v5
  v_cmp_nle_f32 vcc, v7, s50
  s_nop 4
  s_cbranch_vccz L_k2_fin
  v_mov_b32 v4, 0xff800000
  v_mov_b32 v5, 0xff800000
  s_mov_b32 s51, s46
  s_mov_b32 s48, 64
L_k2_fb1:
  buffer_load_dwordx4 v[152:155], v1, s[8:11], s51 offen offset:0
  buffer_load_dwordx4 v[156:159], v1, s[8:11], s51 offen offset:1024
  s_add_u32 s51, s51, 4096
  s_waitcnt vmcnt(0)
  v_mfma_f32_32x32x16_bf16 v[64:79], v[152:155], v[16:19], 0
  v_mfma_f32_32x32x16_bf16 v[80:95], v[152:155], v[24:27], 0
  v_mfma_f32_32x32x16_bf16 v[64:79], v[156:159], v[20:23], v[64:79]
  v_mfma_f32_32x32x16_bf16 v[80:95], v[156:159], v[28:31], v[80:95]
  s_nop 7
  s_nop 7
  v_max3_f32 v6, v64, v65, v66
  v_max3_f32 v6, v6, v67, v68
  v_max3_f32 v6, v6, v69, v70
  v_max3_f32 v6, v6, v71, v72
  v_max3_f32 v6, v6, v73, v74
  v_max3_f32 v6, v6, v75, v76
  v_max3_f32 v6, v6, v77, v78
  v_max_f32 v6, v6, v79
  v_max_f32 v4, v4, v6
  v_max3_f32 v6, v80, v81, v82
  v_max3_f32 v6, v6, v83, v84
  v_max3_f32 v6, v6, v85, v86
  v_max3_f32 v6, v6, v87, v88
  v_max3_f32 v6, v6, v89, v90
  v_max3_f32 v6, v6, v91, v92
  v_max3_f32 v6, v6, v93, v94
  v_max_f32 v6, v6, v95
  v_max_f32 v5, v5, v6
  s_sub_u32 s48, s48, 1
  s_cmp_lg_u32 s48, 0
  s_cbranch_scc1 L_k2_fb1
  v_mov_b32 v6, v4
  v_mov_b32 v7, v5
  s_nop 1
  v_permlane32_swap_b32 v4, v6
  v_permlane32_swap_b32 v5, v7
  s_nop 1
  v_max_f32 v4, v4, v6
  v_max_f32 v5, v5, v7
  v_sub_f32 v32, 0, v4
  v_sub_f32 v33, 0, v4
  v_sub_f32 v34, 0, v4
  v_sub_f32 v35, 0, v4
  v_sub_f32 v36, 0, v4
  v_sub_f32 v37, 0, v4
  v_sub_f32 v38, 0, v4
  v_sub_f32 v39, 0, v4
  v_sub_f32 v40, 0, v4
  v_sub_f32 v41, 0, v4
  v_sub_f32 v42, 0, v4
  v_sub_f32 v43, 0, v4
  v_sub_f32 v44, 0, v4
  v_sub_f32 v45, 0, v4
  v_sub_f32 v46, 0, v4
  v_sub_f32 v47, 0, v4
  v_sub_f32 v48, 0, v5
  v_sub_f32 v49, 0, v5
  v_sub_f32 v50, 0, v5
  v_sub_f32 v51, 0, v5
  v_sub_f32 v52, 0, v5
  v_sub_f32 v53, 0, v5
  v_sub_f32 v54, 0, v5
  v_sub_f32 v55, 0, v5
  v_sub_f32 v56, 0, v5
  v_sub_f32 v57, 0, v5
  v_sub_f32 v58, 0, v5
  v_sub_f32 v59, 0, v5
  v_sub_f32 v60, 0, v5
  v_sub_f32 v61, 0, v5
  v_sub_f32 v62, 0, v5
  v_sub_f32 v63, 0, v5
  v_mov_b32 v112, 0
  v_mov_b32 v113, 0
  v_mov_b32 v114, 0
  v_mov_b32 v115, 0
  v_mov_b32 v116, 0
  v_mov_b32 v117, 0
  v_mov_b32 v118, 0
  v_mov_b32 v119, 0
  v_mov_b32 v120, 0
  v_mov_b32 v121, 0
  v_mov_b32 v122, 0
  v_mov_b32 v123, 0
  v_mov_b32 v124, 0
  v_mov_b32 v125, 0
  v_mov_b32 v126, 0
  v_mov_b32 v127, 0
  v_mov_b32 v128, 0
  v_mov_b32 v129, 0
  v_mov_b32 v130, 0
  v_mov_b32 v131, 0
  v_mov_b32 v132, 0
  v_mov_b32 v133, 0
  v_mov_b32 v134, 0
  v_mov_b32 v135, 0
  v_mov_b32 v136, 0
  v_mov_b32 v137, 0
  v_mov_b32 v138, 0
  v_mov_b32 v139, 0
  v_mov_b32 v140, 0
  v_mov_b32 v141, 0
  v_mov_b32 v142, 0
  v_mov_b32 v143, 0
  v_mov_b32 v176, 0
  v_mov_b32 v177, 0
  v_mov_b32 v178, 0
  v_mov_b32 v179, 0
  v_mov_b32 v180, 0
  v_mov_b32 v181, 0
  v_mov_b32 v182, 0
  v_mov_b32 v183, 0
  s_mov_b32 s51, s46
  s_mov_b32 s48, 64
L_k2_fb2:
  buffer_load_dwordx4 v[152:155], v1, s[8:11], s51 offen offset:0
  buffer_load_dwordx4 v[156:159], v1, s[8:11], s51 offen offset:1024
  buffer_load_dwordx4 v[144:147], v1, s[8:11], s51 offen offset:2048
  buffer_load_dwordx4 v[148:151], v1, s[8:11], s51 offen offset:3072
  s_add_u32 s51, s51, 4096
  s_waitcnt vmcnt(0)
  v_mfma_f32_32x32x16_bf16 v[64:79], v[152:155], v[16:19], v[32:47]
  v_mfma_f32_32x32x16_bf16 v[80:95], v[152:155], v[24:27], v[48:63]
  v_mfma_f32_32x32x16_bf16 v[64:79], v[156:159], v[20:23], v[64:79]
  v_mfma_f32_32x32x16_bf16 v[80:95], v[156:159], v[28:31], v[80:95]
  s_nop 7
  s_nop 7
  s_nop 0
  v_exp_f32 v64, v64
  v_exp_f32 v65, v65
  v_exp_f32 v66, v66
  v_exp_f32 v67, v67
  v_cvt_pk_bf16_f32 v96, v64, v65
  v_cvt_pk_bf16_f32 v97, v66, v67
  s_nop 0
  v_exp_f32 v68, v68
  v_exp_f32 v69, v69
  v_exp_f32 v70, v70
  v_exp_f32 v71, v71
  v_cvt_pk_bf16_f32 v98, v68, v69
  v_cvt_pk_bf16_f32 v99, v70, v71
  s_nop 0
  v_exp_f32 v72, v72
  v_exp_f32 v73, v73
  v_exp_f32 v74, v74
  v_exp_f32 v75, v75
  v_cvt_pk_bf16_f32 v100, v72, v73
  v_cvt_pk_bf16_f32 v101, v74, v75
  s_nop 0
  v_exp_f32 v76, v76
  v_exp_f32 v77, v77
  v_exp_f32 v78, v78
  v_exp_f32 v79, v79
  v_cvt_pk_bf16_f32 v102, v76, v77
  v_cvt_pk_bf16_f32 v103, v78, v79
  s_nop 0
  v_exp_f32 v80, v80
  v_exp_f32 v81, v81
  v_exp_f32 v82, v82
  v_exp_f32 v83, v83
  v_cvt_pk_bf16_f32 v104, v80, v81
  v_cvt_pk_bf16_f32 v105, v82, v83
  s_nop 0
  v_exp_f32 v84, v84
  v_exp_f32 v85, v85
  v_exp_f32 v86, v86
  v_exp_f32 v87, v87
  v_cvt_pk_bf16_f32 v106, v84, v85
  v_cvt_pk_bf16_f32 v107, v86, v87
  s_nop 0
  v_exp_f32 v88, v88
  v_exp_f32 v89, v89
  v_exp_f32 v90, v90
  v_exp_f32 v91, v91
  v_cvt_pk_bf16_f32 v108, v88, v89
  v_cvt_pk_bf16_f32 v109, v90, v91
  s_nop 0
  v_exp_f32 v92, v92
  v_exp_f32 v93, v93
  v_exp_f32 v94, v94
  v_exp_f32 v95, v95
  v_cvt_pk_bf16_f32 v110, v92, v93
  v_cvt_pk_bf16_f32 v111, v94, v95
  s_nop 1
  v_smfmac_f32_16x16x64_bf16 v[176:179], v[8:11], v[96:103], v12
  v_smfmac_f32_16x16x64_bf16 v[180:183], v[8:11], v[104:111], v12
  v_mfma_f32_32x32x16_bf16 v[112:127], v[144:147], v[96:99], v[112:127]
  v_mfma_f32_32x32x16_bf16 v[128:143], v[144:147], v[104:107], v[128:143]
  v_mfma_f32_32x32x16_bf16 v[112:127], v[148:151], v[100:103], v[112:127]
  v_mfma_f32_32x32x16_bf16 v[128:143], v[148:151], v[108:111], v[128:143]
  s_nop 7
  s_nop 7
  s_sub_u32 s48, s48, 1
  s_cmp_lg_u32 s48, 0
  s_cbranch_scc1 L_k2_fb2
  s_nop 7
  v_add_f32 v4, v176, v177
  v_add_f32 v5, v180, v181
L_k2_fin:
  s_waitcnt vmcnt(0)
  v_rcp_f32 v6, v5
  v_rcp_f32 v4, v4
  s_lshl_b32 s45, s44, 6
  s_lshl_b32 s43, s41, 1
  s_add_u32 s45, s45, s43
  s_lshl_b32 s45, s45, 10
  s_add_u32 s45, s45, 33554432
  s_nop 7
  v_pk_mul_f32 v[112:113], v[112:113], v[4:5] op_sel_hi:[1,0]
  v_pk_mul_f32 v[114:115], v[114:115], v[4:5] op_sel_hi:[1,0]
  v_pk_mul_f32 v[116:117], v[116:117], v[4:5] op_sel_hi:[1,0]
  v_pk_mul_f32 v[118:119], v[118:119], v[4:5] op_sel_hi:[1,0]
  v_pk_mul_f32 v[120:121], v[120:121], v[4:5] op_sel_hi:[1,0]
  v_pk_mul_f32 v[122:123], v[122:123], v[4:5] op_sel_hi:[1,0]
  v_pk_mul_f32 v[124:125], v[124:125], v[4:5] op_sel_hi:[1,0]
  v_pk_mul_f32 v[126:127], v[126:127], v[4:5] op_sel_hi:[1,0]
  v_cvt_pk_bf16_f32 v64, v112, v113
  v_cvt_pk_bf16_f32 v65, v114, v115
  v_cvt_pk_bf16_f32 v66, v116, v117
  v_cvt_pk_bf16_f32 v67, v118, v119
  v_cvt_pk_bf16_f32 v68, v120, v121
  v_cvt_pk_bf16_f32 v69, v122, v123
  v_cvt_pk_bf16_f32 v70, v124, v125
  v_cvt_pk_bf16_f32 v71, v126, v127
  buffer_store_dwordx4 v[64:67], v1, s[8:11], s45 offen offset:0 sc1
  buffer_store_dwordx4 v[68:71], v1, s[8:11], s45 offen offset:1024 sc1
  s_add_u32 s45, s45, 65536
  v_pk_mul_f32 v[128:129], v[128:129], v[6:7] op_sel_hi:[1,0]
  v_pk_mul_f32 v[130:131], v[130:131], v[6:7] op_sel_hi:[1,0]
  v_pk_mul_f32 v[132:133], v[132:133], v[6:7] op_sel_hi:[1,0]
  v_pk_mul_f32 v[134:135], v[134:135], v[6:7] op_sel_hi:[1,0]
  v_pk_mul_f32 v[136:137], v[136:137], v[6:7] op_sel_hi:[1,0]
  v_pk_mul_f32 v[138:139], v[138:139], v[6:7] op_sel_hi:[1,0]
  v_pk_mul_f32 v[140:141], v[140:141], v[6:7] op_sel_hi:[1,0]
  v_pk_mul_f32 v[142:143], v[142:143], v[6:7] op_sel_hi:[1,0]
  v_cvt_pk_bf16_f32 v80, v128, v129
  v_cvt_pk_bf16_f32 v81, v130, v131
  v_cvt_pk_bf16_f32 v82, v132, v133
  v_cvt_pk_bf16_f32 v83, v134, v135
  v_cvt_pk_bf16_f32 v84, v136, v137
  v_cvt_pk_bf16_f32 v85, v138, v139
  v_cvt_pk_bf16_f32 v86, v140, v141
  v_cvt_pk_bf16_f32 v87, v142, v143
  buffer_store_dwordx4 v[80:83], v1, s[8:11], s45 offen offset:0 sc1
  buffer_store_dwordx4 v[84:87], v1, s[8:11], s45 offen offset:1024 sc1
  buffer_load_dwordx4 v[32:35], v248, s[24:27], s63 offen offset:0
  buffer_load_dwordx4 v[36:39], v248, s[24:27], s63 offen offset:32
  s_barrier
  ds_write_b128 v250, v[184:187] offset:0
  ds_write_b128 v250, v[188:191] offset:4096
  ds_write_b128 v250, v[192:195] offset:8192
  ds_write_b128 v250, v[196:199] offset:12288
  ds_write_b128 v250, v[200:203] offset:16384
  ds_write_b128 v250, v[204:207] offset:20480
  ds_write_b128 v250, v[208:211] offset:24576
  ds_write_b128 v250, v[212:215] offset:28672
  ds_write_b128 v250, v[216:219] offset:32768
  ds_write_b128 v250, v[220:223] offset:36864
  ds_write_b128 v250, v[224:227] offset:40960
  ds_write_b128 v250, v[228:231] offset:45056
  ds_write_b128 v250, v[232:235] offset:49152
  ds_write_b128 v250, v[236:239] offset:53248
  ds_write_b128 v250, v[240:243] offset:57344
  ds_write_b128 v250, v[244:247] offset:61440
  v_mov_b32 v5, 1
  s_lshr_b32 s3, s39, 1
  s_lshl_b32 s62, s42, 1
  s_add_u32 s3, s3, s62
  s_lshr_b32 s62, s3, 2
  s_lshl_b32 s62, s62, 1
  s_and_b32 s3, s3, 3
  s_lshl_b32 s3, s3, 3
  s_add_u32 s3, s3, s62
  s_lshl_b32 s3, s3, 10
  s_add_u32 s3, s3, 2097152
  v_lshrrev_b32 v4, 5, v1
  v_mul_u32_u24 v4, 32768, v4
  v_bfe_u32 v7, v1, 4, 1
  v_lshl_add_u32 v4, v7, 10, v4
  s_waitcnt vmcnt(0)
  s_sub_u32 s62, s61, 1
  s_cmp_lt_u32 s62, 33
  s_cbranch_scc1 L_k2_next
  v_mov_b32 v6, 159744
  s_cmp_lg_u32 s61, 0
  s_cbranch_scc1 L_k2_nosig
  s_mov_b64 exec, 65535
  buffer_atomic_add v5, v4, s[8:11], s3 offen sc1
  s_mov_b64 exec, -1
L_k2_nosig:
  v_permlane32_swap_b32 v32, v34
  v_permlane32_swap_b32 v33, v35
  v_permlane32_swap_b32 v36, v38
  v_permlane32_swap_b32 v37, v39
  s_mov_b32 s50, 0xffff0000
  v_lshlrev_b32 v104, 16, v32
  v_and_b32 v105, s50, v32
  v_lshlrev_b32 v106, 16, v33
  v_and_b32 v107, s50, v33
  v_lshlrev_b32 v108, 16, v34
  v_and_b32 v109, s50, v34
  v_lshlrev_b32 v110, 16, v35
  v_and_b32 v111, s50, v35
  v_lshlrev_b32 v112, 16, v36
  v_and_b32 v113, s50, v36
  v_lshlrev_b32 v114, 16, v37
  v_and_b32 v115, s50, v37
  v_lshlrev_b32 v116, 16, v38
  v_and_b32 v117, s50, v38
  v_lshlrev_b32 v118, 16, v39
  v_and_b32 v119, s50, v39
  v_mov_b32 v120, 0
  v_mov_b32 v121, 0
  v_mov_b32 v122, 0
  v_mov_b32 v123, 0
  v_mov_b32 v124, 0
  v_mov_b32 v125, 0
  v_mov_b32 v126, 0
  v_mov_b32 v127, 0
  v_mov_b32 v128, 0
  v_mov_b32 v129, 0
  v_mov_b32 v130, 0
  v_mov_b32 v131, 0
  v_mov_b32 v132, 0
  v_mov_b32 v133, 0
  v_mov_b32 v134, 0
  v_mov_b32 v135, 0
  s_waitcnt lgkmcnt(0)
  s_barrier
  s_cmp_lg_u32 s61, 0
  s_cbranch_scc1 L_k2_pollok
  s_cmp_lg_u32 s39, 0
  s_cbranch_scc1 L_k2_nopoll
  s_andn2_b32 s3, s2, 0
  s_lshl_b32 s3, s3, 10
  s_add_u32 s3, s3, 2097152
  s_mov_b32 s62, 256
L_k2_poll:
  buffer_load_dword v7, off, s[8:11], s3 sc1
  s_waitcnt vmcnt(0)
  v_cmp_ne_u32 vcc, 64, v7
  s_nop 4
  s_cbranch_vccz L_k2_pollok
  s_sleep 4
  s_sub_u32 s62, s62, 1
  s_cmp_lg_u32 s62, 0
  s_cbranch_scc1 L_k2_poll
  v_mov_b32 v5, 2
L_k2_pollok:
  ds_write_b32 v6, v5 offset:16
L_k2_nopoll:
  s_branch L_k2_out
L_k2_next:
  s_waitcnt vmcnt(0) lgkmcnt(0)
  s_barrier
  s_lshl_b32 s60, s66, 5
  s_add_u32 s60, s60, s61
  s_xor_b32 s3, s2, 1
  s_cmp_eq_u32 s61, 32
  s_cselect_b32 s60, s3, s60
  s_cmp_eq_u32 s61, 33
  s_cselect_b32 s60, s2, s60
  s_add_u32 s61, s61, 1
  s_branch L_k2_task
L_k2_down:
  s_and_b32 s40, s40, 3
  s_and_b32 s51, s60, 7
  s_lshr_b32 s52, s60, 3
  s_and_b32 s53, s51, 1
  s_lshr_b32 s51, s51, 1
  s_lshl_b32 s51, s51, 2
  s_and_b32 s54, s52, 3
  s_add_u32 s51, s51, s54
  s_lshr_b32 s52, s52, 2
  s_lshl_b32 s51, s51, 2
  s_add_u32 s51, s51, s40
  s_mul_i32 s54, s53, 3670016
  s_lshl_b32 s55, s52, 8
  s_add_u32 s54, s54, s55
  s_add_u32 s12, s4, s54
  s_addc_u32 s13, s5, 0
  s_sub_u32 s14, 7340032, s54
  s_mov_b32 s15, 0x20000
  v_and_b32 v4, 63, v0
  v_lshrrev_b32 v5, 4, v4
  v_lshlrev_b32 v6, 2, v5
  v_and_b32 v7, 15, v4
  v_xor_b32 v6, v6, v7
  v_lshlrev_b32 v6, 4, v6
  s_lshr_b32 s55, s40, 1
  s_lshl_b32 s55, s55, 15
  s_and_b32 s56, s40, 1
  s_lshl_b32 s56, s56, 13
  s_add_u32 s55, s55, s56
  v_lshl_add_u32 v3, v5, 11, v6
  v_add_u32 v3, s55, v3
  v_add_u32 v2, 4096, v1
  s_mov_b32 s43, 4294918144
  s_lshl_b32 s44, s41, 18
  s_lshl_b32 s55, s40, 10
  s_add_u32 s44, s44, s55
  s_add_u32 s44, s44, 8386560
  s_add_u32 s47, s55, 86016
  s_lshl_b32 s46, s40, 10
  s_mul_i32 s45, s51, 224
  s_mul_i32 s55, s53, 112
  s_add_u32 s45, s45, s55
  s_lshl_b32 s45, s45, 10
  s_add_u32 s45, s45, 16777216
  s_add_u32 m0, s47, 0
  s_add_u32 s44, s44, 4096
  buffer_load_dwordx4 v1, s[8:11], s44 offen lds
  s_add_u32 m0, s47, 4096
  s_add_u32 s44, s44, 4096
  buffer_load_dwordx4 v1, s[8:11], s44 offen lds
  s_add_u32 m0, s47, 8192
  s_add_u32 s44, s44, 4096
  buffer_load_dwordx4 v1, s[8:11], s44 offen lds
  s_add_u32 m0, s47, 12288
  s_add_u32 s44, s44, 4096
  buffer_load_dwordx4 v1, s[8:11], s44 offen lds
  s_add_u32 m0, s46, 0
  s_add_u32 s43, s43, 49152
  buffer_load_dwordx4 v3, s[12:15], s43 offen lds
  buffer_load_dwordx4 v[48:51], v1, s[8:11], s45 offen offset:0
  s_add_u32 m0, s46, 4096
  s_add_u32 s43, s43, 16384
  buffer_load_dwordx4 v3, s[12:15], s43 offen lds
  buffer_load_dwordx4 v[52:55], v1, s[8:11], s45 offen offset:1024
  s_add_u32 m0, s46, 8192
  s_add_u32 s43, s43, 49152
  buffer_load_dwordx4 v3, s[12:15], s43 offen lds
  buffer_load_dwordx4 v[56:59], v1, s[8:11], s45 offen offset:2048
  s_add_u32 m0, s46, 12288
  s_add_u32 s43, s43, 16384
  buffer_load_dwordx4 v3, s[12:15], s43 offen lds
  buffer_load_dwordx4 v[60:63], v1, s[8:11], s45 offen offset:3072
  s_add_u32 m0, s46, 16384
  s_add_u32 s43, s43, 49152
  buffer_load_dwordx4 v3, s[12:15], s43 offen lds
  buffer_load_dwordx4 v[64:67], v2, s[8:11], s45 offen offset:0
  s_add_u32 m0, s46, 20480
  s_add_u32 s43, s43, 16384
  buffer_load_dwordx4 v3, s[12:15], s43 offen lds
  buffer_load_dwordx4 v[68:71], v2, s[8:11], s45 offen offset:1024
  s_add_u32 m0, s46, 24576
  s_add_u32 s43, s43, 49152
  buffer_load_dwordx4 v3, s[12:15], s43 offen lds
  buffer_load_dwordx4 v[72:75], v2, s[8:11], s45 offen offset:2048
  s_add_u32 s45, s45, 7168
  s_add_u32 s46, s46, 28672
  s_cmp_ge_u32 s46, 86016
  s_cselect_b32 s50, 86016, 0
  s_sub_u32 s46, s46, s50
  s_add_u32 s47, s47, 24576
  s_cmp_ge_u32 s47, 159744
  s_cselect_b32 s50, 73728, 0
  s_sub_u32 s47, s47, s50
  v_bfe_u32 v5, v4, 2, 2
  v_mul_u32_u24 v6, 320, v5
  v_lshrrev_b32 v7, 5, v4
  v_lshl_add_u32 v6, v7, 10, v6
  v_bfe_u32 v7, v4, 4, 1
  v_lshl_add_u32 v6, v7, 5, v6
  v_and_b32 v7, 3, v4
  v_lshl_add_u32 v12, v7, 3, v6
  s_lshl_b32 s55, s53, 7
  s_add_u32 s55, s55, 64
  v_xor_b32 v12, s55, v12
  v_xor_b32 v13, 64, v12
  v_xor_b32 v14, 128, v12
  v_xor_b32 v15, 192, v12
  v_mov_b32 v104, 0
  v_mov_b32 v105, 0
  v_mov_b32 v106, 0
  v_mov_b32 v107, 0
  v_mov_b32 v108, 0
  v_mov_b32 v109, 0
  v_mov_b32 v110, 0
  v_mov_b32 v111, 0
  v_mov_b32 v112, 0
  v_mov_b32 v113, 0
  v_mov_b32 v114, 0
  v_mov_b32 v115, 0
  v_mov_b32 v116, 0
  v_mov_b32 v117, 0
  v_mov_b32 v118, 0
  v_mov_b32 v119, 0
  v_mov_b32 v120, 0
  v_mov_b32 v121, 0
  v_mov_b32 v122, 0
  v_mov_b32 v123, 0
  v_mov_b32 v124, 0
  v_mov_b32 v125, 0
  v_mov_b32 v126, 0
  v_mov_b32 v127, 0
  v_mov_b32 v128, 0
  v_mov_b32 v129, 0
  v_mov_b32 v130, 0
  v_mov_b32 v131, 0
  v_mov_b32 v132, 0
  v_mov_b32 v133, 0
  v_mov_b32 v134, 0
  v_mov_b32 v135, 0
  v_mov_b32 v136, 0
  v_mov_b32 v137, 0
  v_mov_b32 v138, 0
  v_mov_b32 v139, 0
  v_mov_b32 v140, 0
  v_mov_b32 v141, 0
  v_mov_b32 v142, 0
  v_mov_b32 v143, 0
  v_mov_b32 v144, 0
  v_mov_b32 v145, 0
  v_mov_b32 v146, 0
  v_mov_b32 v147, 0
  v_mov_b32 v148, 0
  v_mov_b32 v149, 0
  v_mov_b32 v150, 0
  v_mov_b32 v151, 0
  v_mov_b32 v152, 0
  v_mov_b32 v153, 0
  v_mov_b32 v154, 0
  v_mov_b32 v155, 0
  v_mov_b32 v156, 0
  v_mov_b32 v157, 0
  v_mov_b32 v158, 0
  v_mov_b32 v159, 0
  v_mov_b32 v160, 0
  v_mov_b32 v161, 0
  v_mov_b32 v162, 0
  v_mov_b32 v163, 0
  v_mov_b32 v164, 0
  v_mov_b32 v165, 0
  v_mov_b32 v166, 0
  v_mov_b32 v167, 0
  s_mov_b32 s48, 0
  s_waitcnt vmcnt(14)
  s_barrier
  s_and_b32 s55, s40, 3
  s_lshl_b32 s55, s55, 2
  s_add_u32 s55, s55, 159744
  v_mov_b32 v8, s55
  v_mov_b32 v9, 1
  v_mov_b32 v10, 159744
  s_add_u32 m0, s47, 0
  s_add_u32 s44, s44, 4096
  buffer_load_dwordx4 v1, s[8:11], s44 offen lds
  s_add_u32 m0, s47, 4096
  s_add_u32 s44, s44, 4096
  buffer_load_dwordx4 v1, s[8:11], s44 offen lds
  s_add_u32 m0, s47, 8192
  s_add_u32 s44, s44, 4096
  buffer_load_dwordx4 v1, s[8:11], s44 offen lds
  s_add_u32 m0, s47, 12288
  s_add_u32 s44, s44, 4096
  buffer_load_dwordx4 v1, s[8:11], s44 offen lds
  s_add_u32 m0, s46, 0
  s_add_u32 s43, s43, 16384
  buffer_load_dwordx4 v3, s[12:15], s43 offen lds
  buffer_load_dwordx4 v[76:79], v1, s[8:11], s45 offen offset:0
  s_add_u32 m0, s46, 4096
  s_add_u32 s43, s43, 49152
  buffer_load_dwordx4 v3, s[12:15], s43 offen lds
  buffer_load_dwordx4 v[80:83], v1, s[8:11], s45 offen offset:1024
  s_add_u32 m0, s46, 8192
  s_add_u32 s43, s43, 16384
  buffer_load_dwordx4 v3, s[12:15], s43 offen lds
  buffer_load_dwordx4 v[84:87], v1, s[8:11], s45 offen offset:2048
  s_add_u32 m0, s46, 12288
  s_add_u32 s43, s43, 49152
  buffer_load_dwordx4 v3, s[12:15], s43 offen lds
  buffer_load_dwordx4 v[88:91], v1, s[8:11], s45 offen offset:3072
  s_add_u32 m0, s46, 16384
  s_add_u32 s43, s43, 16384
  buffer_load_dwordx4 v3, s[12:15], s43 offen lds
  buffer_load_dwordx4 v[92:95], v2, s[8:11], s45 offen offset:0
  s_add_u32 m0, s46, 20480
  s_add_u32 s43, s43, 49152
  buffer_load_dwordx4 v3, s[12:15], s43 offen lds
  buffer_load_dwordx4 v[96:99], v2, s[8:11], s45 offen offset:1024
  s_add_u32 m0, s46, 24576
  s_add_u32 s43, s43, 16384
  buffer_load_dwordx4 v3, s[12:15], s43 offen lds
  buffer_load_dwordx4 v[100:103], v2, s[8:11], s45 offen offset:2048
  s_add_u32 s45, s45, 7168
  s_add_u32 s46, s46, 28672
  s_cmp_ge_u32 s46, 86016
  s_cselect_b32 s50, 86016, 0
  s_sub_u32 s46, s46, s50
  s_add_u32 s47, s47, 24576
  s_cmp_ge_u32 s47, 159744
  s_cselect_b32 s50, 73728, 0
  s_sub_u32 s47, s47, s50
  s_waitcnt vmcnt(18)
  ds_write_b32 v8, v9
L_k2_est:
  ds_read_b128 v[16:19], v10
  s_waitcnt lgkmcnt(0)
  v_and_b32 v16, v16, v17
  v_and_b32 v18, v18, v19
  v_and_b32 v16, v16, v18
  s_nop 1
  v_readfirstlane_b32 s55, v16
  s_cmp_eq_u32 s55, 0
  s_cbranch_scc1 L_k2_est
  v_add_u32 v8, s48, v12
  v_add_u32 v9, s48, v13
  v_add_u32 v10, s48, v14
  v_add_u32 v11, s48, v15
  s_add_u32 s48, s48, 28672
  s_cmp_eq_u32 s48, 86016
  s_cselect_b32 s48, 0, s48
  ds_read_b64_tr_b16 v[16:17], v8 offset:0
  ds_read_b64_tr_b16 v[18:19], v8 offset:2048
  ds_read_b64_tr_b16 v[20:21], v9 offset:0
  ds_read_b64_tr_b16 v[22:23], v9 offset:2048
  ds_read_b64_tr_b16 v[24:25], v10 offset:0
  ds_read_b64_tr_b16 v[26:27], v10 offset:2048
  ds_read_b64_tr_b16 v[28:29], v11 offset:0
  ds_read_b64_tr_b16 v[30:31], v11 offset:2048
  s_waitcnt lgkmcnt(0)
  v_mfma_f32_32x32x16_bf16 v[104:119], v[16:19], v[48:51], v[104:119]
  ds_read_b64_tr_b16 v[32:33], v8 offset:4096
  ds_read_b64_tr_b16 v[34:35], v8 offset:6144
  s_add_u32 m0, s47, 0
  s_add_u32 s44, s44, 4096
  v_mfma_f32_32x32x16_bf16 v[120:135], v[20:23], v[48:51], v[120:135]
  ds_read_b64_tr_b16 v[36:37], v9 offset:4096
  ds_read_b64_tr_b16 v[38:39], v9 offset:6144
  buffer_load_dwordx4 v1, s[8:11], s44 offen lds
  s_add_u32 m0, s46, 0
  v_mfma_f32_32x32x16_bf16 v[136:151], v[24:27], v[48:51], v[136:151]
  ds_read_b64_tr_b16 v[40:41], v10 offset:4096
  ds_read_b64_tr_b16 v[42:43], v10 offset:6144
  s_add_u32 s43, s43, 49152
  v_mfma_f32_32x32x16_bf16 v[152:167], v[28:31], v[48:51], v[152:167]
  ds_read_b64_tr_b16 v[44:45], v11 offset:4096
  ds_read_b64_tr_b16 v[46:47], v11 offset:6144
  buffer_load_dwordx4 v3, s[12:15], s43 offen lds
  s_waitcnt lgkmcnt(0)
  v_mfma_f32_32x32x16_bf16 v[104:119], v[32:35], v[52:55], v[104:119]
  ds_read_b64_tr_b16 v[16:17], v8 offset:8192
  ds_read_b64_tr_b16 v[18:19], v8 offset:10240
  buffer_load_dwordx4 v[48:51], v1, s[8:11], s45 offen offset:0
  s_add_u32 m0, s47, 4096
  v_mfma_f32_32x32x16_bf16 v[120:135], v[36:39], v[52:55], v[120:135]
  ds_read_b64_tr_b16 v[20:21], v9 offset:8192
  ds_read_b64_tr_b16 v[22:23], v9 offset:10240
  s_add_u32 s44, s44, 4096
  buffer_load_dwordx4 v1, s[8:11], s44 offen lds
  v_mfma_f32_32x32x16_bf16 v[136:151], v[40:43], v[52:55], v[136:151]
  ds_read_b64_tr_b16 v[24:25], v10 offset:8192
  ds_read_b64_tr_b16 v[26:27], v10 offset:10240
  s_add_u32 m0, s46, 4096
  s_add_u32 s43, s43, 16384
  v_mfma_f32_32x32x16_bf16 v[152:167], v[44:47], v[52:55], v[152:167]
  ds_read_b64_tr_b16 v[28:29], v11 offset:8192
  ds_read_b64_tr_b16 v[30:31], v11 offset:10240
  buffer_load_dwordx4 v3, s[12:15], s43 offen lds
  s_waitcnt lgkmcnt(0)
  v_mfma_f32_32x32x16_bf16 v[104:119], v[16:19], v[56:59], v[104:119]
  ds_read_b64_tr_b16 v[32:33], v8 offset:12288
  ds_read_b64_tr_b16 v[34:35], v8 offset:14336
  buffer_load_dwordx4 v[52:55], v1, s[8:11], s45 offen offset:1024
  s_add_u32 m0, s47, 8192
  v_mfma_f32_32x32x16_bf16 v[120:135], v[20:23], v[56:59], v[120:135]
  ds_read_b64_tr_b16 v[36:37], v9 offset:12288
  ds_read_b64_tr_b16 v[38:39], v9 offset:14336
  s_add_u32 s44, s44, 4096
  buffer_load_dwordx4 v1, s[8:11], s44 offen lds
  v_mfma_f32_32x32x16_bf16 v[136:151], v[24:27], v[56:59], v[136:151]
  ds_read_b64_tr_b16 v[40:41], v10 offset:12288
  ds_read_b64_tr_b16 v[42:43], v10 offset:14336
  s_add_u32 m0, s46, 8192
  s_add_u32 s43, s43, 49152
  v_mfma_f32_32x32x16_bf16 v[152:167], v[28:31], v[56:59], v[152:167]
  ds_read_b64_tr_b16 v[44:45], v11 offset:12288
  ds_read_b64_tr_b16 v[46:47], v11 offset:14336
  buffer_load_dwordx4 v3, s[12:15], s43 offen lds
  s_waitcnt lgkmcnt(0)
  v_mfma_f32_32x32x16_bf16 v[104:119], v[32:35], v[60:63], v[104:119]
  ds_read_b64_tr_b16 v[16:17], v8 offset:16384
  ds_read_b64_tr_b16 v[18:19], v8 offset:18432
  buffer_load_dwordx4 v[56:59], v1, s[8:11], s45 offen offset:2048
  s_add_u32 m0, s47, 12288
  v_mfma_f32_32x32x16_bf16 v[120:135], v[36:39], v[60:63], v[120:135]
  ds_read_b64_tr_b16 v[20:21], v9 offset:16384
  ds_read_b64_tr_b16 v[22:23], v9 offset:18432
  s_add_u32 s44, s44, 4096
  buffer_load_dwordx4 v1, s[8:11], s44 offen lds
  v_mfma_f32_32x32x16_bf16 v[136:151], v[40:43], v[60:63], v[136:151]
  ds_read_b64_tr_b16 v[24:25], v10 offset:16384
  ds_read_b64_tr_b16 v[26:27], v10 offset:18432
  s_add_u32 m0, s46, 12288
  s_add_u32 s43, s43, 16384
  v_mfma_f32_32x32x16_bf16 v[152:167], v[44:47], v[60:63], v[152:167]
  ds_read_b64_tr_b16 v[28:29], v11 offset:16384
  ds_read_b64_tr_b16 v[30:31], v11 offset:18432
  buffer_load_dwordx4 v3, s[12:15], s43 offen lds
  s_waitcnt lgkmcnt(0)
  v_mfma_f32_32x32x16_bf16 v[104:119], v[16:19], v[64:67], v[104:119]
  ds_read_b64_tr_b16 v[32:33], v8 offset:20480
  ds_read_b64_tr_b16 v[34:35], v8 offset:22528
  buffer_load_dwordx4 v[60:63], v1, s[8:11], s45 offen offset:3072
  v_mfma_f32_32x32x16_bf16 v[120:135], v[20:23], v[64:67], v[120:135]
  ds_read_b64_tr_b16 v[36:37], v9 offset:20480
  ds_read_b64_tr_b16 v[38:39], v9 offset:22528
  s_add_u32 m0, s46, 16384
  v_mfma_f32_32x32x16_bf16 v[136:151], v[24:27], v[64:67], v[136:151]
  ds_read_b64_tr_b16 v[40:41], v10 offset:20480
  ds_read_b64_tr_b16 v[42:43], v10 offset:22528
  s_add_u32 s43, s43, 49152
  v_mfma_f32_32x32x16_bf16 v[152:167], v[28:31], v[64:67], v[152:167]
  ds_read_b64_tr_b16 v[44:45], v11 offset:20480
  ds_read_b64_tr_b16 v[46:47], v11 offset:22528
  buffer_load_dwordx4 v3, s[12:15], s43 offen lds
  s_waitcnt lgkmcnt(0)
  v_mfma_f32_32x32x16_bf16 v[104:119], v[32:35], v[68:71], v[104:119]
  ds_read_b64_tr_b16 v[16:17], v8 offset:24576
  ds_read_b64_tr_b16 v[18:19], v8 offset:26624
  buffer_load_dwordx4 v[64:67], v2, s[8:11], s45 offen offset:0
  s_add_u32 m0, s46, 20480
  v_mfma_f32_32x32x16_bf16 v[120:135], v[36:39], v[68:71], v[120:135]
  ds_read_b64_tr_b16 v[20:21], v9 offset:24576
  ds_read_b64_tr_b16 v[22:23], v9 offset:26624
  s_add_u32 s43, s43, 16384
  buffer_load_dwordx4 v3, s[12:15], s43 offen lds
  v_mfma_f32_32x32x16_bf16 v[136:151], v[40:43], v[68:71], v[136:151]
  ds_read_b64_tr_b16 v[24:25], v10 offset:24576
  ds_read_b64_tr_b16 v[26:27], v10 offset:26624
  s_add_u32 m0, s46, 24576
  s_add_u32 s43, s43, 49152
  v_mfma_f32_32x32x16_bf16 v[152:167], v[44:47], v[68:71], v[152:167]
  ds_read_b64_tr_b16 v[28:29], v11 offset:24576
  ds_read_b64_tr_b16 v[30:31], v11 offset:26624
  buffer_load_dwordx4 v3, s[12:15], s43 offen lds
  buffer_load_dwordx4 v[68:71], v2, s[8:11], s45 offen offset:1024
  s_add_u32 s46, s46, 28672
  s_cmp_ge_u32 s46, 86016
  s_cselect_b32 s50, 86016, 0
  s_sub_u32 s46, s46, s50
  s_add_u32 s47, s47, 24576
  s_cmp_ge_u32 s47, 159744
  s_cselect_b32 s50, 73728, 0
  s_sub_u32 s47, s47, s50
  s_waitcnt vmcnt(17) lgkmcnt(0)
  s_barrier
  v_add_u32 v8, s48, v12
  v_add_u32 v9, s48, v13
  v_add_u32 v10, s48, v14
  v_add_u32 v11, s48, v15
  s_add_u32 s48, s48, 28672
  s_cmp_eq_u32 s48, 86016
  s_cselect_b32 s48, 0, s48
  v_mfma_f32_32x32x16_bf16 v[104:119], v[16:19], v[72:75], v[104:119]
  ds_read_b64_tr_b16 v[32:33], v8 offset:0
  ds_read_b64_tr_b16 v[34:35], v8 offset:2048
  v_mfma_f32_32x32x16_bf16 v[120:135], v[20:23], v[72:75], v[120:135]
  ds_read_b64_tr_b16 v[36:37], v9 offset:0
  ds_read_b64_tr_b16 v[38:39], v9 offset:2048
  v_mfma_f32_32x32x16_bf16 v[136:151], v[24:27], v[72:75], v[136:151]
  ds_read_b64_tr_b16 v[40:41], v10 offset:0
  ds_read_b64_tr_b16 v[42:43], v10 offset:2048
  v_mfma_f32_32x32x16_bf16 v[152:167], v[28:31], v[72:75], v[152:167]
  ds_read_b64_tr_b16 v[44:45], v11 offset:0
  ds_read_b64_tr_b16 v[46:47], v11 offset:2048
  s_waitcnt lgkmcnt(0)
  v_mfma_f32_32x32x16_bf16 v[104:119], v[32:35], v[76:79], v[104:119]
  ds_read_b64_tr_b16 v[16:17], v8 offset:4096
  ds_read_b64_tr_b16 v[18:19], v8 offset:6144
  buffer_load_dwordx4 v[72:75], v2, s[8:11], s45 offen offset:2048
  s_add_u32 s45, s45, 7168
  v_mfma_f32_32x32x16_bf16 v[120:135], v[36:39], v[76:79], v[120:135]
  ds_read_b64_tr_b16 v[20:21], v9 offset:4096
  ds_read_b64_tr_b16 v[22:23], v9 offset:6144
  s_add_u32 m0, s47, 0
  s_add_u32 s44, s44, 4096
  v_mfma_f32_32x32x16_bf16 v[136:151], v[40:43], v[76:79], v[136:151]
  ds_read_b64_tr_b16 v[24:25], v10 offset:4096
  ds_read_b64_tr_b16 v[26:27], v10 offset:6144
  buffer_load_dwordx4 v1, s[8:11], s44 offen lds
  s_add_u32 m0, s46, 0
  v_mfma_f32_32x32x16_bf16 v[152:167], v[44:47], v[76:79], v[152:167]
  ds_read_b64_tr_b16 v[28:29], v11 offset:4096
  ds_read_b64_tr_b16 v[30:31], v11 offset:6144
  s_add_u32 s43, s43, 16384
  buffer_load_dwordx4 v3, s[12:15], s43 offen lds
  s_waitcnt lgkmcnt(0)
  v_mfma_f32_32x32x16_bf16 v[104:119], v[16:19], v[80:83], v[104:119]
  ds_read_b64_tr_b16 v[32:33], v8 offset:8192
  ds_read_b64_tr_b16 v[34:35], v8 offset:10240
  buffer_load_dwordx4 v[76:79], v1, s[8:11], s45 offen offset:0
  s_add_u32 m0, s47, 4096
  v_mfma_f32_32x32x16_bf16 v[120:135], v[20:23], v[80:83], v[120:135]
  ds_read_b64_tr_b16 v[36:37], v9 offset:8192
  ds_read_b64_tr_b16 v[38:39], v9 offset:10240
  s_add_u32 s44, s44, 4096
  buffer_load_dwordx4 v1, s[8:11], s44 offen lds
  v_mfma_f32_32x32x16_bf16 v[136:151], v[24:27], v[80:83], v[136:151]
  ds_read_b64_tr_b16 v[40:41], v10 offset:8192
  ds_read_b64_tr_b16 v[42:43], v10 offset:10240
  s_add_u32 m0, s46, 4096
  s_add_u32 s43, s43, 49152
  v_mfma_f32_32x32x16_bf16 v[152:167], v[28:31], v[80:83], v[152:167]
  ds_read_b64_tr_b16 v[44:45], v11 offset:8192
  ds_read_b64_tr_b16 v[46:47], v11 offset:10240
  buffer_load_dwordx4 v3, s[12:15], s43 offen lds
  s_waitcnt lgkmcnt(0)
  v_mfma_f32_32x32x16_bf16 v[104:119], v[32:35], v[84:87], v[104:119]
  ds_read_b64_tr_b16 v[16:17], v8 offset:12288
  ds_read_b64_tr_b16 v[18:19], v8 offset:14336
  buffer_load_dwordx4 v[80:83], v1, s[8:11], s45 offen offset:1024
  s_add_u32 m0, s47, 8192
  v_mfma_f32_32x32x16_bf16 v[120:135], v[36:39], v[84:87], v[120:135]
  ds_read_b64_tr_b16 v[20:21], v9 offset:12288
  ds_read_b64_tr_b16 v[22:23], v9 offset:14336
  s_add_u32 s44, s44, 4096
  buffer_load_dwordx4 v1, s[8:11], s44 offen lds
  v_mfma_f32_32x32x16_bf16 v[136:151], v[40:43], v[84:87], v[136:151]
  ds_read_b64_tr_b16 v[24:25], v10 offset:12288
  ds_read_b64_tr_b16 v[26:27], v10 offset:14336
  s_add_u32 m0, s46, 8192
  s_add_u32 s43, s43, 16384
  v_mfma_f32_32x32x16_bf16 v[152:167], v[44:47], v[84:87], v[152:167]
  ds_read_b64_tr_b16 v[28:29], v11 offset:12288
  ds_read_b64_tr_b16 v[30:31], v11 offset:14336
  buffer_load_dwordx4 v3, s[12:15], s43 offen lds
  s_waitcnt lgkmcnt(0)
  v_mfma_f32_32x32x16_bf16 v[104:119], v[16:19], v[88:91], v[104:119]
  ds_read_b64_tr_b16 v[32:33], v8 offset:16384
  ds_read_b64_tr_b16 v[34:35], v8 offset:18432
  buffer_load_dwordx4 v[84:87], v1, s[8:11], s45 offen offset:2048
  s_add_u32 m0, s47, 12288
  v_mfma_f32_32x32x16_bf16 v[120:135], v[20:23], v[88:91], v[120:135]
  ds_read_b64_tr_b16 v[36:37], v9 offset:16384
  ds_read_b64_tr_b16 v[38:39], v9 offset:18432
  s_add_u32 s44, s44, 4096
  buffer_load_dwordx4 v1, s[8:11], s44 offen lds
  v_mfma_f32_32x32x16_bf16 v[136:151], v[24:27], v[88:91], v[136:151]
  ds_read_b64_tr_b16 v[40:41], v10 offset:16384
  ds_read_b64_tr_b16 v[42:43], v10 offset:18432
  s_add_u32 m0, s46, 12288
  s_add_u32 s43, s43, 49152
  v_mfma_f32_32x32x16_bf16 v[152:167], v[28:31], v[88:91], v[152:167]
  ds_read_b64_tr_b16 v[44:45], v11 offset:16384
  ds_read_b64_tr_b16 v[46:47], v11 offset:18432
  buffer_load_dwordx4 v3, s[12:15], s43 offen lds
  s_waitcnt lgkmcnt(0)
  v_mfma_f32_32x32x16_bf16 v[104:119], v[32:35], v[92:95], v[104:119]
  ds_read_b64_tr_b16 v[16:17], v8 offset:20480
  ds_read_b64_tr_b16 v[18:19], v8 offset:22528
  buffer_load_dwordx4 v[88:91], v1, s[8:11], s45 offen offset:3072
  v_mfma_f32_32x32x16_bf16 v[120:135], v[36:39], v[92:95], v[120:135]
  ds_read_b64_tr_b16 v[20:21], v9 offset:20480
  ds_read_b64_tr_b16 v[22:23], v9 offset:22528
  s_add_u32 m0, s46, 16384
  v_mfma_f32_32x32x16_bf16 v[136:151], v[40:43], v[92:95], v[136:151]
  ds_read_b64_tr_b16 v[24:25], v10 offset:20480
  ds_read_b64_tr_b16 v[26:27], v10 offset:22528
  s_add_u32 s43, s43, 16384
  v_mfma_f32_32x32x16_bf16 v[152:167], v[44:47], v[92:95], v[152:167]
  ds_read_b64_tr_b16 v[28:29], v11 offset:20480
  ds_read_b64_tr_b16 v[30:31], v11 offset:22528
  buffer_load_dwordx4 v3, s[12:15], s43 offen lds
  s_waitcnt lgkmcnt(0)
  v_mfma_f32_32x32x16_bf16 v[104:119], v[16:19], v[96:99], v[104:119]
  ds_read_b64_tr_b16 v[32:33], v8 offset:24576
  ds_read_b64_tr_b16 v[34:35], v8 offset:26624
  buffer_load_dwordx4 v[92:95], v2, s[8:11], s45 offen offset:0
  s_add_u32 m0, s46, 20480
  v_mfma_f32_32x32x16_bf16 v[120:135], v[20:23], v[96:99], v[120:135]
  ds_read_b64_tr_b16 v[36:37], v9 offset:24576
  ds_read_b64_tr_b16 v[38:39], v9 offset:26624
  s_add_u32 s43, s43, 49152
  buffer_load_dwordx4 v3, s[12:15], s43 offen lds
  v_mfma_f32_32x32x16_bf16 v[136:151], v[24:27], v[96:99], v[136:151]
  ds_read_b64_tr_b16 v[40:41], v10 offset:24576
  ds_read_b64_tr_b16 v[42:43], v10 offset:26624
  s_add_u32 m0, s46, 24576
  s_add_u32 s43, s43, 16384
  v_mfma_f32_32x32x16_bf16 v[152:167], v[28:31], v[96:99], v[152:167]
  ds_read_b64_tr_b16 v[44:45], v11 offset:24576
  ds_read_b64_tr_b16 v[46:47], v11 offset:26624
  buffer_load_dwordx4 v3, s[12:15], s43 offen lds
  buffer_load_dwordx4 v[96:99], v2, s[8:11], s45 offen offset:1024
  s_add_u32 s46, s46, 28672
  s_cmp_ge_u32 s46, 86016
  s_cselect_b32 s50, 86016, 0
  s_sub_u32 s46, s46, s50
  s_add_u32 s47, s47, 24576
  s_cmp_ge_u32 s47, 159744
  s_cselect_b32 s50, 73728, 0
  s_sub_u32 s47, s47, s50
  s_mov_b32 s49, 3
L_down_2:
  s_waitcnt vmcnt(18) lgkmcnt(0)
  s_barrier
  v_add_u32 v8, s48, v12
  v_add_u32 v9, s48, v13
  v_add_u32 v10, s48, v14
  v_add_u32 v11, s48, v15
  s_add_u32 s48, s48, 28672
  s_cmp_eq_u32 s48, 86016
  s_cselect_b32 s48, 0, s48
  v_mfma_f32_32x32x16_bf16 v[104:119], v[32:35], v[100:103], v[104:119]
  ds_read_b64_tr_b16 v[16:17], v8 offset:0
  ds_read_b64_tr_b16 v[18:19], v8 offset:2048
  v_mfma_f32_32x32x16_bf16 v[120:135], v[36:39], v[100:103], v[120:135]
  ds_read_b64_tr_b16 v[20:21], v9 offset:0
  ds_read_b64_tr_b16 v[22:23], v9 offset:2048
  v_mfma_f32_32x32x16_bf16 v[136:151], v[40:43], v[100:103], v[136:151]
  ds_read_b64_tr_b16 v[24:25], v10 offset:0
  ds_read_b64_tr_b16 v[26:27], v10 offset:2048
  v_mfma_f32_32x32x16_bf16 v[152:167], v[44:47], v[100:103], v[152:167]
  ds_read_b64_tr_b16 v[28:29], v11 offset:0
  ds_read_b64_tr_b16 v[30:31], v11 offset:2048
  s_waitcnt lgkmcnt(0)
  v_mfma_f32_32x32x16_bf16 v[104:119], v[16:19], v[48:51], v[104:119]
  ds_read_b64_tr_b16 v[32:33], v8 offset:4096
  ds_read_b64_tr_b16 v[34:35], v8 offset:6144
  buffer_load_dwordx4 v[100:103], v2, s[8:11], s45 offen offset:2048
  s_add_u32 s45, s45, 7168
  v_mfma_f32_32x32x16_bf16 v[120:135], v[20:23], v[48:51], v[120:135]
  ds_read_b64_tr_b16 v[36:37], v9 offset:4096
  ds_read_b64_tr_b16 v[38:39], v9 offset:6144
  s_add_u32 m0, s47, 0
  s_add_u32 s44, s44, 4096
  v_mfma_f32_32x32x16_bf16 v[136:151], v[24:27], v[48:51], v[136:151]
  ds_read_b64_tr_b16 v[40:41], v10 offset:4096
  ds_read_b64_tr_b16 v[42:43], v10 offset:6144
  buffer_load_dwordx4 v1, s[8:11], s44 offen lds
  s_add_u32 m0, s46, 0
  v_mfma_f32_32x32x16_bf16 v[152:167], v[28:31], v[48:51], v[152:167]
  ds_read_b64_tr_b16 v[44:45], v11 offset:4096
  ds_read_b64_tr_b16 v[46:47], v11 offset:6144
  s_add_u32 s43, s43, 49152
  buffer_load_dwordx4 v3, s[12:15], s43 offen lds
  s_waitcnt lgkmcnt(0)
  v_mfma_f32_32x32x16_bf16 v[104:119], v[32:35], v[52:55], v[104:119]
  ds_read_b64_tr_b16 v[16:17], v8 offset:8192
  ds_read_b64_tr_b16 v[18:19], v8 offset:10240
  buffer_load_dwordx4 v[48:51], v1, s[8:11], s45 offen offset:0
  s_add_u32 m0, s47, 4096
  v_mfma_f32_32x32x16_bf16 v[120:135], v[36:39], v[52:55], v[120:135]
  ds_read_b64_tr_b16 v[20:21], v9 offset:8192
  ds_read_b64_tr_b16 v[22:23], v9 offset:10240
  s_add_u32 s44, s44, 4096
  buffer_load_dwordx4 v1, s[8:11], s44 offen lds
  v_mfma_f32_32x32x16_bf16 v[136:151], v[40:43], v[52:55], v[136:151]
  ds_read_b64_tr_b16 v[24:25], v10 offset:8192
  ds_read_b64_tr_b16 v[26:27], v10 offset:10240
  s_add_u32 m0, s46, 4096
  s_add_u32 s43, s43, 16384
  v_mfma_f32_32x32x16_bf16 v[152:167], v[44:47], v[52:55], v[152:167]
  ds_read_b64_tr_b16 v[28:29], v11 offset:8192
  ds_read_b64_tr_b16 v[30:31], v11 offset:10240
  buffer_load_dwordx4 v3, s[12:15], s43 offen lds
  s_waitcnt lgkmcnt(0)
  v_mfma_f32_32x32x16_bf16 v[104:119], v[16:19], v[56:59], v[104:119]
  ds_read_b64_tr_b16 v[32:33], v8 offset:12288
  ds_read_b64_tr_b16 v[34:35], v8 offset:14336
  buffer_load_dwordx4 v[52:55], v1, s[8:11], s45 offen offset:1024
  s_add_u32 m0, s47, 8192
  v_mfma_f32_32x32x16_bf16 v[120:135], v[20:23], v[56:59], v[120:135]
  ds_read_b64_tr_b16 v[36:37], v9 offset:12288
  ds_read_b64_tr_b16 v[38:39], v9 offset:14336
  s_add_u32 s44, s44, 4096
  buffer_load_dwordx4 v1, s[8:11], s44 offen lds
  v_mfma_f32_32x32x16_bf16 v[136:151], v[24:27], v[56:59], v[136:151]
  ds_read_b64_tr_b16 v[40:41], v10 offset:12288
  ds_read_b64_tr_b16 v[42:43], v10 offset:14336
  s_add_u32 m0, s46, 8192
  s_add_u32 s43, s43, 49152
  v_mfma_f32_32x32x16_bf16 v[152:167], v[28:31], v[56:59], v[152:167]
  ds_read_b64_tr_b16 v[44:45], v11 offset:12288
  ds_read_b64_tr_b16 v[46:47], v11 offset:14336
  buffer_load_dwordx4 v3, s[12:15], s43 offen lds
  s_waitcnt lgkmcnt(0)
  v_mfma_f32_32x32x16_bf16 v[104:119], v[32:35], v[60:63], v[104:119]
  ds_read_b64_tr_b16 v[16:17], v8 offset:16384
  ds_read_b64_tr_b16 v[18:19], v8 offset:18432
  buffer_load_dwordx4 v[56:59], v1, s[8:11], s45 offen offset:2048
  s_add_u32 m0, s47, 12288
  v_mfma_f32_32x32x16_bf16 v[120:135], v[36:39], v[60:63], v[120:135]
  ds_read_b64_tr_b16 v[20:21], v9 offset:16384
  ds_read_b64_tr_b16 v[22:23], v9 offset:18432
  s_add_u32 s44, s44, 4096
  buffer_load_dwordx4 v1, s[8:11], s44 offen lds
  v_mfma_f32_32x32x16_bf16 v[136:151], v[40:43], v[60:63], v[136:151]
  ds_read_b64_tr_b16 v[24:25], v10 offset:16384
  ds_read_b64_tr_b16 v[26:27], v10 offset:18432
  s_add_u32 m0, s46, 12288
  s_add_u32 s43, s43, 16384
  v_mfma_f32_32x32x16_bf16 v[152:167], v[44:47], v[60:63], v[152:167]
  ds_read_b64_tr_b16 v[28:29], v11 offset:16384
  ds_read_b64_tr_b16 v[30:31], v11 offset:18432
  buffer_load_dwordx4 v3, s[12:15], s43 offen lds
  s_waitcnt lgkmcnt(0)
  v_mfma_f32_32x32x16_bf16 v[104:119], v[16:19], v[64:67], v[104:119]
  ds_read_b64_tr_b16 v[32:33], v8 offset:20480
  ds_read_b64_tr_b16 v[34:35], v8 offset:22528
  buffer_load_dwordx4 v[60:63], v1, s[8:11], s45 offen offset:3072
  v_mfma_f32_32x32x16_bf16 v[120:135], v[20:23], v[64:67], v[120:135]
  ds_read_b64_tr_b16 v[36:37], v9 offset:20480
  ds_read_b64_tr_b16 v[38:39], v9 offset:22528
  s_add_u32 m0, s46, 16384
  v_mfma_f32_32x32x16_bf16 v[136:151], v[24:27], v[64:67], v[136:151]
  ds_read_b64_tr_b16 v[40:41], v10 offset:20480
  ds_read_b64_tr_b16 v[42:43], v10 offset:22528
  s_add_u32 s43, s43, 49152
  v_mfma_f32_32x32x16_bf16 v[152:167], v[28:31], v[64:67], v[152:167]
  ds_read_b64_tr_b16 v[44:45], v11 offset:20480
  ds_read_b64_tr_b16 v[46:47], v11 offset:22528
  buffer_load_dwordx4 v3, s[12:15], s43 offen lds
  s_waitcnt lgkmcnt(0)
  v_mfma_f32_32x32x16_bf16 v[104:119], v[32:35], v[68:71], v[104:119]
  ds_read_b64_tr_b16 v[16:17], v8 offset:24576
  ds_read_b64_tr_b16 v[18:19], v8 offset:26624
  buffer_load_dwordx4 v[64:67], v2, s[8:11], s45 offen offset:0
  s_add_u32 m0, s46, 20480
  v_mfma_f32_32x32x16_bf16 v[120:135], v[36:39], v[68:71], v[120:135]
  ds_read_b64_tr_b16 v[20:21], v9 offset:24576
  ds_read_b64_tr_b16 v[22:23], v9 offset:26624
  s_add_u32 s43, s43, 16384
  buffer_load_dwordx4 v3, s[12:15], s43 offen lds
  v_mfma_f32_32x32x16_bf16 v[136:151], v[40:43], v[68:71], v[136:151]
  ds_read_b64_tr_b16 v[24:25], v10 offset:24576
  ds_read_b64_tr_b16 v[26:27], v10 offset:26624
  s_add_u32 m0, s46, 24576
  s_add_u32 s43, s43, 49152
  v_mfma_f32_32x32x16_bf16 v[152:167], v[44:47], v[68:71], v[152:167]
  ds_read_b64_tr_b16 v[28:29], v11 offset:24576
  ds_read_b64_tr_b16 v[30:31], v11 offset:26624
  buffer_load_dwordx4 v3, s[12:15], s43 offen lds
  buffer_load_dwordx4 v[68:71], v2, s[8:11], s45 offen offset:1024
  s_add_u32 s46, s46, 28672
  s_cmp_ge_u32 s46, 86016
  s_cselect_b32 s50, 86016, 0
  s_sub_u32 s46, s46, s50
  s_add_u32 s47, s47, 24576
  s_cmp_ge_u32 s47, 159744
  s_cselect_b32 s50, 73728, 0
  s_sub_u32 s47, s47, s50
  s_waitcnt vmcnt(18) lgkmcnt(0)
  s_barrier
  v_add_u32 v8, s48, v12
  v_add_u32 v9, s48, v13
  v_add_u32 v10, s48, v14
  v_add_u32 v11, s48, v15
  s_add_u32 s48, s48, 28672
  s_cmp_eq_u32 s48, 86016
  s_cselect_b32 s48, 0, s48
  v_mfma_f32_32x32x16_bf16 v[104:119], v[16:19], v[72:75], v[104:119]
  ds_read_b64_tr_b16 v[32:33], v8 offset:0
  ds_read_b64_tr_b16 v[34:35], v8 offset:2048
  v_mfma_f32_32x32x16_bf16 v[120:135], v[20:23], v[72:75], v[120:135]
  ds_read_b64_tr_b16 v[36:37], v9 offset:0
  ds_read_b64_tr_b16 v[38:39], v9 offset:2048
  v_mfma_f32_32x32x16_bf16 v[136:151], v[24:27], v[72:75], v[136:151]
  ds_read_b64_tr_b16 v[40:41], v10 offset:0
  ds_read_b64_tr_b16 v[42:43], v10 offset:2048
  v_mfma_f32_32x32x16_bf16 v[152:167], v[28:31], v[72:75], v[152:167]
  ds_read_b64_tr_b16 v[44:45], v11 offset:0
  ds_read_b64_tr_b16 v[46:47], v11 offset:2048
  s_waitcnt lgkmcnt(0)
  v_mfma_f32_32x32x16_bf16 v[104:119], v[32:35], v[76:79], v[104:119]
  ds_read_b64_tr_b16 v[16:17], v8 offset:4096
  ds_read_b64_tr_b16 v[18:19], v8 offset:6144
  buffer_load_dwordx4 v[72:75], v2, s[8:11], s45 offen offset:2048
  s_add_u32 s45, s45, 7168
  v_mfma_f32_32x32x16_bf16 v[120:135], v[36:39], v[76:79], v[120:135]
  ds_read_b64_tr_b16 v[20:21], v9 offset:4096
  ds_read_b64_tr_b16 v[22:23], v9 offset:6144
  s_add_u32 m0, s47, 0
  s_add_u32 s44, s44, 4096
  v_mfma_f32_32x32x16_bf16 v[136:151], v[40:43], v[76:79], v[136:151]
  ds_read_b64_tr_b16 v[24:25], v10 offset:4096
  ds_read_b64_tr_b16 v[26:27], v10 offset:6144
  buffer_load_dwordx4 v1, s[8:11], s44 offen lds
  s_add_u32 m0, s46, 0
  v_mfma_f32_32x32x16_bf16 v[152:167], v[44:47], v[76:79], v[152:167]
  ds_read_b64_tr_b16 v[28:29], v11 offset:4096
  ds_read_b64_tr_b16 v[30:31], v11 offset:6144
  s_add_u32 s43, s43, 16384
  buffer_load_dwordx4 v3, s[12:15], s43 offen lds
  s_waitcnt lgkmcnt(0)
  v_mfma_f32_32x32x16_bf16 v[104:119], v[16:19], v[80:83], v[104:119]
  ds_read_b64_tr_b16 v[32:33], v8 offset:8192
  ds_read_b64_tr_b16 v[34:35], v8 offset:10240
  buffer_load_dwordx4 v[76:79], v1, s[8:11], s45 offen offset:0
  s_add_u32 m0, s47, 4096
  v_mfma_f32_32x32x16_bf16 v[120:135], v[20:23], v[80:83], v[120:135]
  ds_read_b64_tr_b16 v[36:37], v9 offset:8192
  ds_read_b64_tr_b16 v[38:39], v9 offset:10240
  s_add_u32 s44, s44, 4096
  buffer_load_dwordx4 v1, s[8:11], s44 offen lds
  v_mfma_f32_32x32x16_bf16 v[136:151], v[24:27], v[80:83], v[136:151]
  ds_read_b64_tr_b16 v[40:41], v10 offset:8192
  ds_read_b64_tr_b16 v[42:43], v10 offset:10240
  s_add_u32 m0, s46, 4096
  s_add_u32 s43, s43, 49152
  v_mfma_f32_32x32x16_bf16 v[152:167], v[28:31], v[80:83], v[152:167]
  ds_read_b64_tr_b16 v[44:45], v11 offset:8192
  ds_read_b64_tr_b16 v[46:47], v11 offset:10240
  buffer_load_dwordx4 v3, s[12:15], s43 offen lds
  s_waitcnt lgkmcnt(0)
  v_mfma_f32_32x32x16_bf16 v[104:119], v[32:35], v[84:87], v[104:119]
  ds_read_b64_tr_b16 v[16:17], v8 offset:12288
  ds_read_b64_tr_b16 v[18:19], v8 offset:14336
  buffer_load_dwordx4 v[80:83], v1, s[8:11], s45 offen offset:1024
  s_add_u32 m0, s47, 8192
  v_mfma_f32_32x32x16_bf16 v[120:135], v[36:39], v[84:87], v[120:135]
  ds_read_b64_tr_b16 v[20:21], v9 offset:12288
  ds_read_b64_tr_b16 v[22:23], v9 offset:14336
  s_add_u32 s44, s44, 4096
  buffer_load_dwordx4 v1, s[8:11], s44 offen lds
  v_mfma_f32_32x32x16_bf16 v[136:151], v[40:43], v[84:87], v[136:151]
  ds_read_b64_tr_b16 v[24:25], v10 offset:12288
  ds_read_b64_tr_b16 v[26:27], v10 offset:14336
  s_add_u32 m0, s46, 8192
  s_add_u32 s43, s43, 16384
  v_mfma_f32_32x32x16_bf16 v[152:167], v[44:47], v[84:87], v[152:167]
  ds_read_b64_tr_b16 v[28:29], v11 offset:12288
  ds_read_b64_tr_b16 v[30:31], v11 offset:14336
  buffer_load_dwordx4 v3, s[12:15], s43 offen lds
  s_waitcnt lgkmcnt(0)
  v_mfma_f32_32x32x16_bf16 v[104:119], v[16:19], v[88:91], v[104:119]
  ds_read_b64_tr_b16 v[32:33], v8 offset:16384
  ds_read_b64_tr_b16 v[34:35], v8 offset:18432
  buffer_load_dwordx4 v[84:87], v1, s[8:11], s45 offen offset:2048
  s_add_u32 m0, s47, 12288
  v_mfma_f32_32x32x16_bf16 v[120:135], v[20:23], v[88:91], v[120:135]
  ds_read_b64_tr_b16 v[36:37], v9 offset:16384
  ds_read_b64_tr_b16 v[38:39], v9 offset:18432
  s_add_u32 s44, s44, 4096
  buffer_load_dwordx4 v1, s[8:11], s44 offen lds
  v_mfma_f32_32x32x16_bf16 v[136:151], v[24:27], v[88:91], v[136:151]
  ds_read_b64_tr_b16 v[40:41], v10 offset:16384
  ds_read_b64_tr_b16 v[42:43], v10 offset:18432
  s_add_u32 m0, s46, 12288
  s_add_u32 s43, s43, 49152
  v_mfma_f32_32x32x16_bf16 v[152:167], v[28:31], v[88:91], v[152:167]
  ds_read_b64_tr_b16 v[44:45], v11 offset:16384
  ds_read_b64_tr_b16 v[46:47], v11 offset:18432
  buffer_load_dwordx4 v3, s[12:15], s43 offen lds
  s_waitcnt lgkmcnt(0)
  v_mfma_f32_32x32x16_bf16 v[104:119], v[32:35], v[92:95], v[104:119]
  ds_read_b64_tr_b16 v[16:17], v8 offset:20480
  ds_read_b64_tr_b16 v[18:19], v8 offset:22528
  buffer_load_dwordx4 v[88:91], v1, s[8:11], s45 offen offset:3072
  v_mfma_f32_32x32x16_bf16 v[120:135], v[36:39], v[92:95], v[120:135]
  ds_read_b64_tr_b16 v[20:21], v9 offset:20480
  ds_read_b64_tr_b16 v[22:23], v9 offset:22528
  s_add_u32 m0, s46, 16384
  v_mfma_f32_32x32x16_bf16 v[136:151], v[40:43], v[92:95], v[136:151]
  ds_read_b64_tr_b16 v[24:25], v10 offset:20480
  ds_read_b64_tr_b16 v[26:27], v10 offset:22528
  s_add_u32 s43, s43, 16384
  v_mfma_f32_32x32x16_bf16 v[152:167], v[44:47], v[92:95], v[152:167]
  ds_read_b64_tr_b16 v[28:29], v11 offset:20480
  ds_read_b64_tr_b16 v[30:31], v11 offset:22528
  buffer_load_dwordx4 v3, s[12:15], s43 offen lds
  s_waitcnt lgkmcnt(0)
  v_mfma_f32_32x32x16_bf16 v[104:119], v[16:19], v[96:99], v[104:119]
  ds_read_b64_tr_b16 v[32:33], v8 offset:24576
  ds_read_b64_tr_b16 v[34:35], v8 offset:26624
  buffer_load_dwordx4 v[92:95], v2, s[8:11], s45 offen offset:0
  s_add_u32 m0, s46, 20480
  v_mfma_f32_32x32x16_bf16 v[120:135], v[20:23], v[96:99], v[120:135]
  ds_read_b64_tr_b16 v[36:37], v9 offset:24576
  ds_read_b64_tr_b16 v[38:39], v9 offset:26624
  s_add_u32 s43, s43, 49152
  buffer_load_dwordx4 v3, s[12:15], s43 offen lds
  v_mfma_f32_32x32x16_bf16 v[136:151], v[24:27], v[96:99], v[136:151]
  ds_read_b64_tr_b16 v[40:41], v10 offset:24576
  ds_read_b64_tr_b16 v[42:43], v10 offset:26624
  s_add_u32 m0, s46, 24576
  s_add_u32 s43, s43, 16384
  v_mfma_f32_32x32x16_bf16 v[152:167], v[28:31], v[96:99], v[152:167]
  ds_read_b64_tr_b16 v[44:45], v11 offset:24576
  ds_read_b64_tr_b16 v[46:47], v11 offset:26624
  buffer_load_dwordx4 v3, s[12:15], s43 offen lds
  buffer_load_dwordx4 v[96:99], v2, s[8:11], s45 offen offset:1024
  s_add_u32 s46, s46, 28672
  s_cmp_ge_u32 s46, 86016
  s_cselect_b32 s50, 86016, 0
  s_sub_u32 s46, s46, s50
  s_add_u32 s47, s47, 24576
  s_cmp_ge_u32 s47, 159744
  s_cselect_b32 s50, 73728, 0
  s_sub_u32 s47, s47, s50
  s_sub_u32 s49, s49, 1
  s_cmp_lg_u32 s49, 0
  s_cbranch_scc1 L_down_2
  s_waitcnt vmcnt(18) lgkmcnt(0)
  s_barrier
  v_add_u32 v8, s48, v12
  v_add_u32 v9, s48, v13
  v_add_u32 v10, s48, v14
  v_add_u32 v11, s48, v15
  s_add_u32 s48, s48, 28672
  s_cmp_eq_u32 s48, 86016
  s_cselect_b32 s48, 0, s48
  v_mfma_f32_32x32x16_bf16 v[104:119], v[32:35], v[100:103], v[104:119]
  ds_read_b64_tr_b16 v[16:17], v8 offset:0
  ds_read_b64_tr_b16 v[18:19], v8 offset:2048
  v_mfma_f32_32x32x16_bf16 v[120:135], v[36:39], v[100:103], v[120:135]
  ds_read_b64_tr_b16 v[20:21], v9 offset:0
  ds_read_b64_tr_b16 v[22:23], v9 offset:2048
  v_mfma_f32_32x32x16_bf16 v[136:151], v[40:43], v[100:103], v[136:151]
  ds_read_b64_tr_b16 v[24:25], v10 offset:0
  ds_read_b64_tr_b16 v[26:27], v10 offset:2048
  v_mfma_f32_32x32x16_bf16 v[152:167], v[44:47], v[100:103], v[152:167]
  ds_read_b64_tr_b16 v[28:29], v11 offset:0
  ds_read_b64_tr_b16 v[30:31], v11 offset:2048
  s_waitcnt lgkmcnt(0)
  v_mfma_f32_32x32x16_bf16 v[104:119], v[16:19], v[48:51], v[104:119]
  ds_read_b64_tr_b16 v[32:33], v8 offset:4096
  ds_read_b64_tr_b16 v[34:35], v8 offset:6144
  buffer_load_dwordx4 v[100:103], v2, s[8:11], s45 offen offset:2048
  s_add_u32 s45, s45, 7168
  s_add_u32 m0, s47, 0
  v_mfma_f32_32x32x16_bf16 v[120:135], v[20:23], v[48:51], v[120:135]
  ds_read_b64_tr_b16 v[36:37], v9 offset:4096
  ds_read_b64_tr_b16 v[38:39], v9 offset:6144
  s_add_u32 s44, s44, 4096
  buffer_load_dwordx4 v1, s[8:11], s44 offen lds
  s_add_u32 m0, s46, 0
  v_mfma_f32_32x32x16_bf16 v[136:151], v[24:27], v[48:51], v[136:151]
  ds_read_b64_tr_b16 v[40:41], v10 offset:4096
  ds_read_b64_tr_b16 v[42:43], v10 offset:6144
  s_add_u32 s43, s43, 49152
  buffer_load_dwordx4 v3, s[12:15], s43 offen lds
  v_mfma_f32_32x32x16_bf16 v[152:167], v[28:31], v[48:51], v[152:167]
  ds_read_b64_tr_b16 v[44:45], v11 offset:4096
  ds_read_b64_tr_b16 v[46:47], v11 offset:6144
  s_add_u32 s56, s65, 1048576
  buffer_load_dwordx4 v[184:187], v249, s[16:19], s56 offen
  s_waitcnt lgkmcnt(0)
  v_mfma_f32_32x32x16_bf16 v[104:119], v[32:35], v[52:55], v[104:119]
  ds_read_b64_tr_b16 v[16:17], v8 offset:8192
  ds_read_b64_tr_b16 v[18:19], v8 offset:10240
  buffer_load_dwordx4 v[48:51], v1, s[8:11], s45 offen offset:0
  s_add_u32 m0, s47, 4096
  s_add_u32 s44, s44, 4096
  v_mfma_f32_32x32x16_bf16 v[120:135], v[36:39], v[52:55], v[120:135]
  ds_read_b64_tr_b16 v[20:21], v9 offset:8192
  ds_read_b64_tr_b16 v[22:23], v9 offset:10240
  buffer_load_dwordx4 v1, s[8:11], s44 offen lds
  s_add_u32 m0, s46, 4096
  v_mfma_f32_32x32x16_bf16 v[136:151], v[40:43], v[52:55], v[136:151]
  ds_read_b64_tr_b16 v[24:25], v10 offset:8192
  ds_read_b64_tr_b16 v[26:27], v10 offset:10240
  s_add_u32 s43, s43, 16384
  buffer_load_dwordx4 v3, s[12:15], s43 offen lds
  v_mfma_f32_32x32x16_bf16 v[152:167], v[44:47], v[52:55], v[152:167]
  ds_read_b64_tr_b16 v[28:29], v11 offset:8192
  ds_read_b64_tr_b16 v[30:31], v11 offset:10240
  s_add_u32 s56, s65, 1114112
  buffer_load_dwordx4 v[188:191], v249, s[16:19], s56 offen
  s_waitcnt lgkmcnt(0)
  v_mfma_f32_32x32x16_bf16 v[104:119], v[16:19], v[56:59], v[104:119]
  ds_read_b64_tr_b16 v[32:33], v8 offset:12288
  ds_read_b64_tr_b16 v[34:35], v8 offset:14336
  buffer_load_dwordx4 v[52:55], v1, s[8:11], s45 offen offset:1024
  s_add_u32 m0, s47, 8192
  s_add_u32 s44, s44, 4096
  v_mfma_f32_32x32x16_bf16 v[120:135], v[20:23], v[56:59], v[120:135]
  ds_read_b64_tr_b16 v[36:37], v9 offset:12288
  ds_read_b64_tr_b16 v[38:39], v9 offset:14336
  buffer_load_dwordx4 v1, s[8:11], s44 offen lds
  s_add_u32 m0, s46, 8192
  v_mfma_f32_32x32x16_bf16 v[136:151], v[24:27], v[56:59], v[136:151]
  ds_read_b64_tr_b16 v[40:41], v10 offset:12288
  ds_read_b64_tr_b16 v[42:43], v10 offset:14336
  s_add_u32 s43, s43, 49152
  buffer_load_dwordx4 v3, s[12:15], s43 offen lds
  v_mfma_f32_32x32x16_bf16 v[152:167], v[28:31], v[56:59], v[152:167]
  ds_read_b64_tr_b16 v[44:45], v11 offset:12288
  ds_read_b64_tr_b16 v[46:47], v11 offset:14336
  s_add_u32 s56, s65, 1179648
  buffer_load_dwordx4 v[192:195], v249, s[16:19], s56 offen
  s_waitcnt lgkmcnt(0)
  v_mfma_f32_32x32x16_bf16 v[104:119], v[32:35], v[60:63], v[104:119]
  ds_read_b64_tr_b16 v[16:17], v8 offset:16384
  ds_read_b64_tr_b16 v[18:19], v8 offset:18432
  buffer_load_dwordx4 v[56:59], v1, s[8:11], s45 offen offset:2048
  s_add_u32 m0, s47, 12288
  s_add_u32 s44, s44, 4096
  v_mfma_f32_32x32x16_bf16 v[120:135], v[36:39], v[60:63], v[120:135]
  ds_read_b64_tr_b16 v[20:21], v9 offset:16384
  ds_read_b64_tr_b16 v[22:23], v9 offset:18432
  buffer_load_dwordx4 v1, s[8:11], s44 offen lds
  s_add_u32 m0, s46, 12288
  v_mfma_f32_32x32x16_bf16 v[136:151], v[40:43], v[60:63], v[136:151]
  ds_read_b64_tr_b16 v[24:25], v10 offset:16384
  ds_read_b64_tr_b16 v[26:27], v10 offset:18432
  s_add_u32 s43, s43, 16384
  buffer_load_dwordx4 v3, s[12:15], s43 offen lds
  v_mfma_f32_32x32x16_bf16 v[152:167], v[44:47], v[60:63], v[152:167]
  ds_read_b64_tr_b16 v[28:29], v11 offset:16384
  ds_read_b64_tr_b16 v[30:31], v11 offset:18432
  s_add_u32 s56, s65, 1245184
  buffer_load_dwordx4 v[196:199], v249, s[16:19], s56 offen
  s_waitcnt lgkmcnt(0)
  v_mfma_f32_32x32x16_bf16 v[104:119], v[16:19], v[64:67], v[104:119]
  ds_read_b64_tr_b16 v[32:33], v8 offset:20480
  ds_read_b64_tr_b16 v[34:35], v8 offset:22528
  buffer_load_dwordx4 v[60:63], v1, s[8:11], s45 offen offset:3072
  v_mfma_f32_32x32x16_bf16 v[120:135], v[20:23], v[64:67], v[120:135]
  ds_read_b64_tr_b16 v[36:37], v9 offset:20480
  ds_read_b64_tr_b16 v[38:39], v9 offset:22528
  s_add_u32 m0, s46, 16384
  v_mfma_f32_32x32x16_bf16 v[136:151], v[24:27], v[64:67], v[136:151]
  ds_read_b64_tr_b16 v[40:41], v10 offset:20480
  ds_read_b64_tr_b16 v[42:43], v10 offset:22528
  s_add_u32 s43, s43, 49152
  v_mfma_f32_32x32x16_bf16 v[152:167], v[28:31], v[64:67], v[152:167]
  ds_read_b64_tr_b16 v[44:45], v11 offset:20480
  ds_read_b64_tr_b16 v[46:47], v11 offset:22528
  buffer_load_dwordx4 v3, s[12:15], s43 offen lds
  s_waitcnt lgkmcnt(0)
  v_mfma_f32_32x32x16_bf16 v[104:119], v[32:35], v[68:71], v[104:119]
  ds_read_b64_tr_b16 v[16:17], v8 offset:24576
  ds_read_b64_tr_b16 v[18:19], v8 offset:26624
  buffer_load_dwordx4 v[64:67], v2, s[8:11], s45 offen offset:0
  s_add_u32 m0, s46, 20480
  v_mfma_f32_32x32x16_bf16 v[120:135], v[36:39], v[68:71], v[120:135]
  ds_read_b64_tr_b16 v[20:21], v9 offset:24576
  ds_read_b64_tr_b16 v[22:23], v9 offset:26624
  s_add_u32 s43, s43, 16384
  buffer_load_dwordx4 v3, s[12:15], s43 offen lds
  v_mfma_f32_32x32x16_bf16 v[136:151], v[40:43], v[68:71], v[136:151]
  ds_read_b64_tr_b16 v[24:25], v10 offset:24576
  ds_read_b64_tr_b16 v[26:27], v10 offset:26624
  s_add_u32 m0, s46, 24576
  s_add_u32 s43, s43, 49152
  v_mfma_f32_32x32x16_bf16 v[152:167], v[44:47], v[68:71], v[152:167]
  ds_read_b64_tr_b16 v[28:29], v11 offset:24576
  ds_read_b64_tr_b16 v[30:31], v11 offset:26624
  buffer_load_dwordx4 v3, s[12:15], s43 offen lds
  buffer_load_dwordx4 v[68:71], v2, s[8:11], s45 offen offset:1024
  s_add_u32 s46, s46, 28672
  s_cmp_ge_u32 s46, 86016
  s_cselect_b32 s50, 86016, 0
  s_sub_u32 s46, s46, s50
  s_add_u32 s47, s47, 24576
  s_cmp_ge_u32 s47, 159744
  s_cselect_b32 s50, 73728, 0
  s_sub_u32 s47, s47, s50
  s_waitcnt vmcnt(22) lgkmcnt(0)
  s_barrier
  v_add_u32 v8, s48, v12
  v_add_u32 v9, s48, v13
  v_add_u32 v10, s48, v14
  v_add_u32 v11, s48, v15
  s_add_u32 s48, s48, 28672
  s_cmp_eq_u32 s48, 86016
  s_cselect_b32 s48, 0, s48
  v_mfma_f32_32x32x16_bf16 v[104:119], v[16:19], v[72:75], v[104:119]
  ds_read_b64_tr_b16 v[32:33], v8 offset:0
  ds_read_b64_tr_b16 v[34:35], v8 offset:2048
  v_mfma_f32_32x32x16_bf16 v[120:135], v[20:23], v[72:75], v[120:135]
  ds_read_b64_tr_b16 v[36:37], v9 offset:0
  ds_read_b64_tr_b16 v[38:39], v9 offset:2048
  v_mfma_f32_32x32x16_bf16 v[136:151], v[24:27], v[72:75], v[136:151]
  ds_read_b64_tr_b16 v[40:41], v10 offset:0
  ds_read_b64_tr_b16 v[42:43], v10 offset:2048
  v_mfma_f32_32x32x16_bf16 v[152:167], v[28:31], v[72:75], v[152:167]
  ds_read_b64_tr_b16 v[44:45], v11 offset:0
  ds_read_b64_tr_b16 v[46:47], v11 offset:2048
  s_waitcnt lgkmcnt(0)
  v_mfma_f32_32x32x16_bf16 v[104:119], v[32:35], v[76:79], v[104:119]
  ds_read_b64_tr_b16 v[16:17], v8 offset:4096
  ds_read_b64_tr_b16 v[18:19], v8 offset:6144
  buffer_load_dwordx4 v[72:75], v2, s[8:11], s45 offen offset:2048
  s_add_u32 s45, s45, 7168
  s_add_u32 m0, s47, 0
  v_mfma_f32_32x32x16_bf16 v[120:135], v[36:39], v[76:79], v[120:135]
  ds_read_b64_tr_b16 v[20:21], v9 offset:4096
  ds_read_b64_tr_b16 v[22:23], v9 offset:6144
  s_add_u32 s44, s44, 4096
  buffer_load_dwordx4 v1, s[8:11], s44 offen lds
  s_add_u32 m0, s46, 0
  v_mfma_f32_32x32x16_bf16 v[136:151], v[40:43], v[76:79], v[136:151]
  ds_read_b64_tr_b16 v[24:25], v10 offset:4096
  ds_read_b64_tr_b16 v[26:27], v10 offset:6144
  s_add_u32 s43, s43, 16384
  buffer_load_dwordx4 v3, s[12:15], s43 offen lds
  v_mfma_f32_32x32x16_bf16 v[152:167], v[44:47], v[76:79], v[152:167]
  ds_read_b64_tr_b16 v[28:29], v11 offset:4096
  ds_read_b64_tr_b16 v[30:31], v11 offset:6144
  s_add_u32 s56, s65, 1310720
  buffer_load_dwordx4 v[200:203], v249, s[16:19], s56 offen
  s_waitcnt lgkmcnt(0)
  v_mfma_f32_32x32x16_bf16 v[104:119], v[16:19], v[80:83], v[104:119]
  ds_read_b64_tr_b16 v[32:33], v8 offset:8192
  ds_read_b64_tr_b16 v[34:35], v8 offset:10240
  buffer_load_dwordx4 v[76:79], v1, s[8:11], s45 offen offset:0
  s_add_u32 m0, s47, 4096
  s_add_u32 s44, s44, 4096
  v_mfma_f32_32x32x16_bf16 v[120:135], v[20:23], v[80:83], v[120:135]
  ds_read_b64_tr_b16 v[36:37], v9 offset:8192
  ds_read_b64_tr_b16 v[38:39], v9 offset:10240
  buffer_load_dwordx4 v1, s[8:11], s44 offen lds
  s_add_u32 m0, s46, 4096
  v_mfma_f32_32x32x16_bf16 v[136:151], v[24:27], v[80:83], v[136:151]
  ds_read_b64_tr_b16 v[40:41], v10 offset:8192
  ds_read_b64_tr_b16 v[42:43], v10 offset:10240
  s_add_u32 s43, s43, 49152
  buffer_load_dwordx4 v3, s[12:15], s43 offen lds
  v_mfma_f32_32x32x16_bf16 v[152:167], v[28:31], v[80:83], v[152:167]
  ds_read_b64_tr_b16 v[44:45], v11 offset:8192
  ds_read_b64_tr_b16 v[46:47], v11 offset:10240
  s_add_u32 s56, s65, 1376256
  buffer_load_dwordx4 v[204:207], v249, s[16:19], s56 offen
  s_waitcnt lgkmcnt(0)
  v_mfma_f32_32x32x16_bf16 v[104:119], v[32:35], v[84:87], v[104:119]
  ds_read_b64_tr_b16 v[16:17], v8 offset:12288
  ds_read_b64_tr_b16 v[18:19], v8 offset:14336
  buffer_load_dwordx4 v[80:83], v1, s[8:11], s45 offen offset:1024
  s_add_u32 m0, s47, 8192
  s_add_u32 s44, s44, 4096
  v_mfma_f32_32x32x16_bf16 v[120:135], v[36:39], v[84:87], v[120:135]
  ds_read_b64_tr_b16 v[20:21], v9 offset:12288
  ds_read_b64_tr_b16 v[22:23], v9 offset:14336
  buffer_load_dwordx4 v1, s[8:11], s44 offen lds
  s_add_u32 m0, s46, 8192
  v_mfma_f32_32x32x16_bf16 v[136:151], v[40:43], v[84:87], v[136:151]
  ds_read_b64_tr_b16 v[24:25], v10 offset:12288
  ds_read_b64_tr_b16 v[26:27], v10 offset:14336
  s_add_u32 s43, s43, 16384
  buffer_load_dwordx4 v3, s[12:15], s43 offen lds
  v_mfma_f32_32x32x16_bf16 v[152:167], v[44:47], v[84:87], v[152:167]
  ds_read_b64_tr_b16 v[28:29], v11 offset:12288
  ds_read_b64_tr_b16 v[30:31], v11 offset:14336
  s_add_u32 s56, s65, 1441792
  buffer_load_dwordx4 v[208:211], v249, s[16:19], s56 offen
  s_waitcnt lgkmcnt(0)
  v_mfma_f32_32x32x16_bf16 v[104:119], v[16:19], v[88:91], v[104:119]
  ds_read_b64_tr_b16 v[32:33], v8 offset:16384
  ds_read_b64_tr_b16 v[34:35], v8 offset:18432
  buffer_load_dwordx4 v[84:87], v1, s[8:11], s45 offen offset:2048
  s_add_u32 m0, s47, 12288
  s_add_u32 s44, s44, 4096
  v_mfma_f32_32x32x16_bf16 v[120:135], v[20:23], v[88:91], v[120:135]
  ds_read_b64_tr_b16 v[36:37], v9 offset:16384
  ds_read_b64_tr_b16 v[38:39], v9 offset:18432
  buffer_load_dwordx4 v1, s[8:11], s44 offen lds
  s_add_u32 m0, s46, 12288
  v_mfma_f32_32x32x16_bf16 v[136:151], v[24:27], v[88:91], v[136:151]
  ds_read_b64_tr_b16 v[40:41], v10 offset:16384
  ds_read_b64_tr_b16 v[42:43], v10 offset:18432
  s_add_u32 s43, s43, 49152
  buffer_load_dwordx4 v3, s[12:15], s43 offen lds
  v_mfma_f32_32x32x16_bf16 v[152:167], v[28:31], v[88:91], v[152:167]
  ds_read_b64_tr_b16 v[44:45], v11 offset:16384
  ds_read_b64_tr_b16 v[46:47], v11 offset:18432
  s_add_u32 s56, s65, 1507328
  buffer_load_dwordx4 v[212:215], v249, s[16:19], s56 offen
  s_waitcnt lgkmcnt(0)
  v_mfma_f32_32x32x16_bf16 v[104:119], v[32:35], v[92:95], v[104:119]
  ds_read_b64_tr_b16 v[16:17], v8 offset:20480
  ds_read_b64_tr_b16 v[18:19], v8 offset:22528
  buffer_load_dwordx4 v[88:91], v1, s[8:11], s45 offen offset:3072
  v_mfma_f32_32x32x16_bf16 v[120:135], v[36:39], v[92:95], v[120:135]
  ds_read_b64_tr_b16 v[20:21], v9 offset:20480
  ds_read_b64_tr_b16 v[22:23], v9 offset:22528
  s_add_u32 m0, s46, 16384
  v_mfma_f32_32x32x16_bf16 v[136:151], v[40:43], v[92:95], v[136:151]
  ds_read_b64_tr_b16 v[24:25], v10 offset:20480
  ds_read_b64_tr_b16 v[26:27], v10 offset:22528
  s_add_u32 s43, s43, 16384
  v_mfma_f32_32x32x16_bf16 v[152:167], v[44:47], v[92:95], v[152:167]
  ds_read_b64_tr_b16 v[28:29], v11 offset:20480
  ds_read_b64_tr_b16 v[30:31], v11 offset:22528
  buffer_load_dwordx4 v3, s[12:15], s43 offen lds
  s_waitcnt lgkmcnt(0)
  v_mfma_f32_32x32x16_bf16 v[104:119], v[16:19], v[96:99], v[104:119]
  ds_read_b64_tr_b16 v[32:33], v8 offset:24576
  ds_read_b64_tr_b16 v[34:35], v8 offset:26624
  buffer_load_dwordx4 v[92:95], v2, s[8:11], s45 offen offset:0
  s_add_u32 m0, s46, 20480
  v_mfma_f32_32x32x16_bf16 v[120:135], v[20:23], v[96:99], v[120:135]
  ds_read_b64_tr_b16 v[36:37], v9 offset:24576
  ds_read_b64_tr_b16 v[38:39], v9 offset:26624
  s_add_u32 s43, s43, 49152
  buffer_load_dwordx4 v3, s[12:15], s43 offen lds
  v_mfma_f32_32x32x16_bf16 v[136:151], v[24:27], v[96:99], v[136:151]
  ds_read_b64_tr_b16 v[40:41], v10 offset:24576
  ds_read_b64_tr_b16 v[42:43], v10 offset:26624
  s_add_u32 m0, s46, 24576
  s_add_u32 s43, s43, 16384
  v_mfma_f32_32x32x16_bf16 v[152:167], v[28:31], v[96:99], v[152:167]
  ds_read_b64_tr_b16 v[44:45], v11 offset:24576
  ds_read_b64_tr_b16 v[46:47], v11 offset:26624
  buffer_load_dwordx4 v3, s[12:15], s43 offen lds
  buffer_load_dwordx4 v[96:99], v2, s[8:11], s45 offen offset:1024
  s_add_u32 s46, s46, 28672
  s_cmp_ge_u32 s46, 86016
  s_cselect_b32 s50, 86016, 0
  s_sub_u32 s46, s46, s50
  s_add_u32 s47, s47, 24576
  s_cmp_ge_u32 s47, 159744
  s_cselect_b32 s50, 73728, 0
  s_sub_u32 s47, s47, s50
  s_waitcnt vmcnt(22) lgkmcnt(0)
  s_barrier
  v_add_u32 v8, s48, v12
  v_add_u32 v9, s48, v13
  v_add_u32 v10, s48, v14
  v_add_u32 v11, s48, v15
  s_add_u32 s48, s48, 28672
  s_cmp_eq_u32 s48, 86016
  s_cselect_b32 s48, 0, s48
  v_mfma_f32_32x32x16_bf16 v[104:119], v[32:35], v[100:103], v[104:119]
  ds_read_b64_tr_b16 v[16:17], v8 offset:0
  ds_read_b64_tr_b16 v[18:19], v8 offset:2048
  v_mfma_f32_32x32x16_bf16 v[120:135], v[36:39], v[100:103], v[120:135]
  ds_read_b64_tr_b16 v[20:21], v9 offset:0
  ds_read_b64_tr_b16 v[22:23], v9 offset:2048
  v_mfma_f32_32x32x16_bf16 v[136:151], v[40:43], v[100:103], v[136:151]
  ds_read_b64_tr_b16 v[24:25], v10 offset:0
  ds_read_b64_tr_b16 v[26:27], v10 offset:2048
  v_mfma_f32_32x32x16_bf16 v[152:167], v[44:47], v[100:103], v[152:167]
  ds_read_b64_tr_b16 v[28:29], v11 offset:0
  ds_read_b64_tr_b16 v[30:31], v11 offset:2048
  s_waitcnt lgkmcnt(0)
  v_mfma_f32_32x32x16_bf16 v[104:119], v[16:19], v[48:51], v[104:119]
  ds_read_b64_tr_b16 v[32:33], v8 offset:4096
  ds_read_b64_tr_b16 v[34:35], v8 offset:6144
  buffer_load_dwordx4 v[100:103], v2, s[8:11], s45 offen offset:2048
  s_add_u32 s45, s45, 7168
  s_add_u32 m0, s47, 0
  v_mfma_f32_32x32x16_bf16 v[120:135], v[20:23], v[48:51], v[120:135]
  ds_read_b64_tr_b16 v[36:37], v9 offset:4096
  ds_read_b64_tr_b16 v[38:39], v9 offset:6144
  s_add_u32 s44, s44, 4096
  buffer_load_dwordx4 v1, s[8:11], s44 offen lds
  s_add_u32 m0, s46, 0
  v_mfma_f32_32x32x16_bf16 v[136:151], v[24:27], v[48:51], v[136:151]
  ds_read_b64_tr_b16 v[40:41], v10 offset:4096
  ds_read_b64_tr_b16 v[42:43], v10 offset:6144
  s_add_u32 s43, s43, 49152
  buffer_load_dwordx4 v3, s[12:15], s43 offen lds
  v_mfma_f32_32x32x16_bf16 v[152:167], v[28:31], v[48:51], v[152:167]
  ds_read_b64_tr_b16 v[44:45], v11 offset:4096
  ds_read_b64_tr_b16 v[46:47], v11 offset:6144
  s_add_u32 s56, s65, 1572864
  buffer_load_dwordx4 v[216:219], v249, s[16:19], s56 offen
  s_waitcnt lgkmcnt(0)
  v_mfma_f32_32x32x16_bf16 v[104:119], v[32:35], v[52:55], v[104:119]
  ds_read_b64_tr_b16 v[16:17], v8 offset:8192
  ds_read_b64_tr_b16 v[18:19], v8 offset:10240
  buffer_load_dwordx4 v[48:51], v1, s[8:11], s45 offen offset:0
  s_add_u32 m0, s47, 4096
  s_add_u32 s44, s44, 4096
  v_mfma_f32_32x32x16_bf16 v[120:135], v[36:39], v[52:55], v[120:135]
  ds_read_b64_tr_b16 v[20:21], v9 offset:8192
  ds_read_b64_tr_b16 v[22:23], v9 offset:10240
  buffer_load_dwordx4 v1, s[8:11], s44 offen lds
  s_add_u32 m0, s46, 4096
  v_mfma_f32_32x32x16_bf16 v[136:151], v[40:43], v[52:55], v[136:151]
  ds_read_b64_tr_b16 v[24:25], v10 offset:8192
  ds_read_b64_tr_b16 v[26:27], v10 offset:10240
  s_add_u32 s43, s43, 16384
  buffer_load_dwordx4 v3, s[12:15], s43 offen lds
  v_mfma_f32_32x32x16_bf16 v[152:167], v[44:47], v[52:55], v[152:167]
  ds_read_b64_tr_b16 v[28:29], v11 offset:8192
  ds_read_b64_tr_b16 v[30:31], v11 offset:10240
  s_add_u32 s56, s65, 1638400
  buffer_load_dwordx4 v[220:223], v249, s[16:19], s56 offen
  s_waitcnt lgkmcnt(0)
  v_mfma_f32_32x32x16_bf16 v[104:119], v[16:19], v[56:59], v[104:119]
  ds_read_b64_tr_b16 v[32:33], v8 offset:12288
  ds_read_b64_tr_b16 v[34:35], v8 offset:14336
  buffer_load_dwordx4 v[52:55], v1, s[8:11], s45 offen offset:1024
  s_add_u32 m0, s47, 8192
  s_add_u32 s44, s44, 4096
  v_mfma_f32_32x32x16_bf16 v[120:135], v[20:23], v[56:59], v[120:135]
  ds_read_b64_tr_b16 v[36:37], v9 offset:12288
  ds_read_b64_tr_b16 v[38:39], v9 offset:14336
  buffer_load_dwordx4 v1, s[8:11], s44 offen lds
  s_add_u32 m0, s46, 8192
  v_mfma_f32_32x32x16_bf16 v[136:151], v[24:27], v[56:59], v[136:151]
  ds_read_b64_tr_b16 v[40:41], v10 offset:12288
  ds_read_b64_tr_b16 v[42:43], v10 offset:14336
  s_add_u32 s43, s43, 49152
  buffer_load_dwordx4 v3, s[12:15], s43 offen lds
  v_mfma_f32_32x32x16_bf16 v[152:167], v[28:31], v[56:59], v[152:167]
  ds_read_b64_tr_b16 v[44:45], v11 offset:12288
  ds_read_b64_tr_b16 v[46:47], v11 offset:14336
  s_add_u32 s56, s65, 1703936
  buffer_load_dwordx4 v[224:227], v249, s[16:19], s56 offen
  s_waitcnt lgkmcnt(0)
  v_mfma_f32_32x32x16_bf16 v[104:119], v[32:35], v[60:63], v[104:119]
  ds_read_b64_tr_b16 v[16:17], v8 offset:16384
  ds_read_b64_tr_b16 v[18:19], v8 offset:18432
  buffer_load_dwordx4 v[56:59], v1, s[8:11], s45 offen offset:2048
  s_add_u32 m0, s47, 12288
  s_add_u32 s44, s44, 4096
  v_mfma_f32_32x32x16_bf16 v[120:135], v[36:39], v[60:63], v[120:135]
  ds_read_b64_tr_b16 v[20:21], v9 offset:16384
  ds_read_b64_tr_b16 v[22:23], v9 offset:18432
  buffer_load_dwordx4 v1, s[8:11], s44 offen lds
  s_add_u32 m0, s46, 12288
  v_mfma_f32_32x32x16_bf16 v[136:151], v[40:43], v[60:63], v[136:151]
  ds_read_b64_tr_b16 v[24:25], v10 offset:16384
  ds_read_b64_tr_b16 v[26:27], v10 offset:18432
  s_add_u32 s43, s43, 16384
  buffer_load_dwordx4 v3, s[12:15], s43 offen lds
  v_mfma_f32_32x32x16_bf16 v[152:167], v[44:47], v[60:63], v[152:167]
  ds_read_b64_tr_b16 v[28:29], v11 offset:16384
  ds_read_b64_tr_b16 v[30:31], v11 offset:18432
  s_add_u32 s56, s65, 1769472
  buffer_load_dwordx4 v[228:231], v249, s[16:19], s56 offen
  s_waitcnt lgkmcnt(0)
  v_mfma_f32_32x32x16_bf16 v[104:119], v[16:19], v[64:67], v[104:119]
  ds_read_b64_tr_b16 v[32:33], v8 offset:20480
  ds_read_b64_tr_b16 v[34:35], v8 offset:22528
  buffer_load_dwordx4 v[60:63], v1, s[8:11], s45 offen offset:3072
  v_mfma_f32_32x32x16_bf16 v[120:135], v[20:23], v[64:67], v[120:135]
  ds_read_b64_tr_b16 v[36:37], v9 offset:20480
  ds_read_b64_tr_b16 v[38:39], v9 offset:22528
  s_add_u32 m0, s46, 16384
  v_mfma_f32_32x32x16_bf16 v[136:151], v[24:27], v[64:67], v[136:151]
  ds_read_b64_tr_b16 v[40:41], v10 offset:20480
  ds_read_b64_tr_b16 v[42:43], v10 offset:22528
  s_add_u32 s43, s43, 49152
  v_mfma_f32_32x32x16_bf16 v[152:167], v[28:31], v[64:67], v[152:167]
  ds_read_b64_tr_b16 v[44:45], v11 offset:20480
  ds_read_b64_tr_b16 v[46:47], v11 offset:22528
  buffer_load_dwordx4 v3, s[12:15], s43 offen lds
  s_waitcnt lgkmcnt(0)
  v_mfma_f32_32x32x16_bf16 v[104:119], v[32:35], v[68:71], v[104:119]
  ds_read_b64_tr_b16 v[16:17], v8 offset:24576
  ds_read_b64_tr_b16 v[18:19], v8 offset:26624
  buffer_load_dwordx4 v[64:67], v2, s[8:11], s45 offen offset:0
  s_add_u32 m0, s46, 20480
  v_mfma_f32_32x32x16_bf16 v[120:135], v[36:39], v[68:71], v[120:135]
  ds_read_b64_tr_b16 v[20:21], v9 offset:24576
  ds_read_b64_tr_b16 v[22:23], v9 offset:26624
  s_add_u32 s43, s43, 16384
  buffer_load_dwordx4 v3, s[12:15], s43 offen lds
  v_mfma_f32_32x32x16_bf16 v[136:151], v[40:43], v[68:71], v[136:151]
  ds_read_b64_tr_b16 v[24:25], v10 offset:24576
  ds_read_b64_tr_b16 v[26:27], v10 offset:26624
  s_add_u32 m0, s46, 24576
  s_add_u32 s43, s43, 49152
  v_mfma_f32_32x32x16_bf16 v[152:167], v[44:47], v[68:71], v[152:167]
  ds_read_b64_tr_b16 v[28:29], v11 offset:24576
  ds_read_b64_tr_b16 v[30:31], v11 offset:26624
  buffer_load_dwordx4 v3, s[12:15], s43 offen lds
  buffer_load_dwordx4 v[68:71], v2, s[8:11], s45 offen offset:1024
  s_add_u32 s46, s46, 28672
  s_cmp_ge_u32 s46, 86016
  s_cselect_b32 s50, 86016, 0
  s_sub_u32 s46, s46, s50
  s_add_u32 s47, s47, 24576
  s_cmp_ge_u32 s47, 159744
  s_cselect_b32 s50, 73728, 0
  s_sub_u32 s47, s47, s50
  s_waitcnt vmcnt(22) lgkmcnt(0)
  s_barrier
  v_add_u32 v8, s48, v12
  v_add_u32 v9, s48, v13
  v_add_u32 v10, s48, v14
  v_add_u32 v11, s48, v15
  s_add_u32 s48, s48, 28672
  s_cmp_eq_u32 s48, 86016
  s_cselect_b32 s48, 0, s48
  v_mfma_f32_32x32x16_bf16 v[104:119], v[16:19], v[72:75], v[104:119]
  ds_read_b64_tr_b16 v[32:33], v8 offset:0
  ds_read_b64_tr_b16 v[34:35], v8 offset:2048
  v_mfma_f32_32x32x16_bf16 v[120:135], v[20:23], v[72:75], v[120:135]
  ds_read_b64_tr_b16 v[36:37], v9 offset:0
  ds_read_b64_tr_b16 v[38:39], v9 offset:2048
  v_mfma_f32_32x32x16_bf16 v[136:151], v[24:27], v[72:75], v[136:151]
  ds_read_b64_tr_b16 v[40:41], v10 offset:0
  ds_read_b64_tr_b16 v[42:43], v10 offset:2048
  v_mfma_f32_32x32x16_bf16 v[152:167], v[28:31], v[72:75], v[152:167]
  ds_read_b64_tr_b16 v[44:45], v11 offset:0
  ds_read_b64_tr_b16 v[46:47], v11 offset:2048
  s_waitcnt lgkmcnt(0)
  v_mfma_f32_32x32x16_bf16 v[104:119], v[32:35], v[76:79], v[104:119]
  ds_read_b64_tr_b16 v[16:17], v8 offset:4096
  ds_read_b64_tr_b16 v[18:19], v8 offset:6144
  buffer_load_dwordx4 v[72:75], v2, s[8:11], s45 offen offset:2048
  s_add_u32 s45, s45, 7168
  s_add_u32 m0, s47, 0
  v_mfma_f32_32x32x16_bf16 v[120:135], v[36:39], v[76:79], v[120:135]
  ds_read_b64_tr_b16 v[20:21], v9 offset:4096
  ds_read_b64_tr_b16 v[22:23], v9 offset:6144
  s_add_u32 s44, s44, 4096
  buffer_load_dwordx4 v1, s[8:11], s44 offen lds
  s_add_u32 m0, s46, 0
  v_mfma_f32_32x32x16_bf16 v[136:151], v[40:43], v[76:79], v[136:151]
  ds_read_b64_tr_b16 v[24:25], v10 offset:4096
  ds_read_b64_tr_b16 v[26:27], v10 offset:6144
  s_add_u32 s43, s43, 16384
  buffer_load_dwordx4 v3, s[12:15], s43 offen lds
  v_mfma_f32_32x32x16_bf16 v[152:167], v[44:47], v[76:79], v[152:167]
  ds_read_b64_tr_b16 v[28:29], v11 offset:4096
  ds_read_b64_tr_b16 v[30:31], v11 offset:6144
  s_add_u32 s56, s65, 1835008
  buffer_load_dwordx4 v[232:235], v249, s[16:19], s56 offen
  s_waitcnt lgkmcnt(0)
  v_mfma_f32_32x32x16_bf16 v[104:119], v[16:19], v[80:83], v[104:119]
  ds_read_b64_tr_b16 v[32:33], v8 offset:8192
  ds_read_b64_tr_b16 v[34:35], v8 offset:10240
  buffer_load_dwordx4 v[76:79], v1, s[8:11], s45 offen offset:0
  s_add_u32 m0, s47, 4096
  s_add_u32 s44, s44, 4096
  v_mfma_f32_32x32x16_bf16 v[120:135], v[20:23], v[80:83], v[120:135]
  ds_read_b64_tr_b16 v[36:37], v9 offset:8192
  ds_read_b64_tr_b16 v[38:39], v9 offset:10240
  buffer_load_dwordx4 v1, s[8:11], s44 offen lds
  s_add_u32 m0, s46, 4096
  v_mfma_f32_32x32x16_bf16 v[136:151], v[24:27], v[80:83], v[136:151]
  ds_read_b64_tr_b16 v[40:41], v10 offset:8192
  ds_read_b64_tr_b16 v[42:43], v10 offset:10240
  s_add_u32 s43, s43, 49152
  buffer_load_dwordx4 v3, s[12:15], s43 offen lds
  v_mfma_f32_32x32x16_bf16 v[152:167], v[28:31], v[80:83], v[152:167]
  ds_read_b64_tr_b16 v[44:45], v11 offset:8192
  ds_read_b64_tr_b16 v[46:47], v11 offset:10240
  s_add_u32 s56, s65, 1900544
  buffer_load_dwordx4 v[236:239], v249, s[16:19], s56 offen
  s_waitcnt lgkmcnt(0)
  v_mfma_f32_32x32x16_bf16 v[104:119], v[32:35], v[84:87], v[104:119]
  ds_read_b64_tr_b16 v[16:17], v8 offset:12288
  ds_read_b64_tr_b16 v[18:19], v8 offset:14336
  buffer_load_dwordx4 v[80:83], v1, s[8:11], s45 offen offset:1024
  s_add_u32 m0, s47, 8192
  s_add_u32 s44, s44, 4096
  v_mfma_f32_32x32x16_bf16 v[120:135], v[36:39], v[84:87], v[120:135]
  ds_read_b64_tr_b16 v[20:21], v9 offset:12288
  ds_read_b64_tr_b16 v[22:23], v9 offset:14336
  buffer_load_dwordx4 v1, s[8:11], s44 offen lds
  s_add_u32 m0, s46, 8192
  v_mfma_f32_32x32x16_bf16 v[136:151], v[40:43], v[84:87], v[136:151]
  ds_read_b64_tr_b16 v[24:25], v10 offset:12288
  ds_read_b64_tr_b16 v[26:27], v10 offset:14336
  s_add_u32 s43, s43, 16384
  buffer_load_dwordx4 v3, s[12:15], s43 offen lds
  v_mfma_f32_32x32x16_bf16 v[152:167], v[44:47], v[84:87], v[152:167]
  ds_read_b64_tr_b16 v[28:29], v11 offset:12288
  ds_read_b64_tr_b16 v[30:31], v11 offset:14336
  s_add_u32 s56, s65, 1966080
  buffer_load_dwordx4 v[240:243], v249, s[16:19], s56 offen
  s_waitcnt lgkmcnt(0)
  v_mfma_f32_32x32x16_bf16 v[104:119], v[16:19], v[88:91], v[104:119]
  ds_read_b64_tr_b16 v[32:33], v8 offset:16384
  ds_read_b64_tr_b16 v[34:35], v8 offset:18432
  buffer_load_dwordx4 v[84:87], v1, s[8:11], s45 offen offset:2048
  s_add_u32 m0, s47, 12288
  s_add_u32 s44, s44, 4096
  v_mfma_f32_32x32x16_bf16 v[120:135], v[20:23], v[88:91], v[120:135]
  ds_read_b64_tr_b16 v[36:37], v9 offset:16384
  ds_read_b64_tr_b16 v[38:39], v9 offset:18432
  buffer_load_dwordx4 v1, s[8:11], s44 offen lds
  s_add_u32 m0, s46, 12288
  v_mfma_f32_32x32x16_bf16 v[136:151], v[24:27], v[88:91], v[136:151]
  ds_read_b64_tr_b16 v[40:41], v10 offset:16384
  ds_read_b64_tr_b16 v[42:43], v10 offset:18432
  s_add_u32 s43, s43, 49152
  buffer_load_dwordx4 v3, s[12:15], s43 offen lds
  v_mfma_f32_32x32x16_bf16 v[152:167], v[28:31], v[88:91], v[152:167]
  ds_read_b64_tr_b16 v[44:45], v11 offset:16384
  ds_read_b64_tr_b16 v[46:47], v11 offset:18432
  s_add_u32 s56, s65, 2031616
  buffer_load_dwordx4 v[244:247], v249, s[16:19], s56 offen
  s_waitcnt lgkmcnt(0)
  v_mfma_f32_32x32x16_bf16 v[104:119], v[32:35], v[92:95], v[104:119]
  ds_read_b64_tr_b16 v[16:17], v8 offset:20480
  ds_read_b64_tr_b16 v[18:19], v8 offset:22528
  buffer_load_dwordx4 v[88:91], v1, s[8:11], s45 offen offset:3072
  s_add_u32 m0, s47, 16384
  v_mfma_f32_32x32x16_bf16 v[120:135], v[36:39], v[92:95], v[120:135]
  ds_read_b64_tr_b16 v[20:21], v9 offset:20480
  ds_read_b64_tr_b16 v[22:23], v9 offset:22528
  s_add_u32 s44, s44, 4096
  buffer_load_dwordx4 v1, s[8:11], s44 offen lds
  v_mfma_f32_32x32x16_bf16 v[136:151], v[40:43], v[92:95], v[136:151]
  ds_read_b64_tr_b16 v[24:25], v10 offset:20480
  ds_read_b64_tr_b16 v[26:27], v10 offset:22528
  s_add_u32 m0, s46, 16384
  s_add_u32 s43, s43, 16384
  v_mfma_f32_32x32x16_bf16 v[152:167], v[44:47], v[92:95], v[152:167]
  ds_read_b64_tr_b16 v[28:29], v11 offset:20480
  ds_read_b64_tr_b16 v[30:31], v11 offset:22528
  buffer_load_dwordx4 v3, s[12:15], s43 offen lds
  s_waitcnt lgkmcnt(0)
  v_mfma_f32_32x32x16_bf16 v[104:119], v[16:19], v[96:99], v[104:119]
  ds_read_b64_tr_b16 v[32:33], v8 offset:24576
  ds_read_b64_tr_b16 v[34:35], v8 offset:26624
  buffer_load_dwordx4 v[92:95], v2, s[8:11], s45 offen offset:0
  s_add_u32 m0, s47, 20480
  s_add_u32 s44, s44, 4096
  v_mfma_f32_32x32x16_bf16 v[120:135], v[20:23], v[96:99], v[120:135]
  ds_read_b64_tr_b16 v[36:37], v9 offset:24576
  ds_read_b64_tr_b16 v[38:39], v9 offset:26624
  buffer_load_dwordx4 v1, s[8:11], s44 offen lds
  s_add_u32 m0, s46, 20480
  s_add_u32 s43, s43, 49152
  v_mfma_f32_32x32x16_bf16 v[136:151], v[24:27], v[96:99], v[136:151]
  ds_read_b64_tr_b16 v[40:41], v10 offset:24576
  ds_read_b64_tr_b16 v[42:43], v10 offset:26624
  buffer_load_dwordx4 v3, s[12:15], s43 offen lds
  s_add_u32 m0, s46, 24576
  v_mfma_f32_32x32x16_bf16 v[152:167], v[28:31], v[96:99], v[152:167]
  ds_read_b64_tr_b16 v[44:45], v11 offset:24576
  ds_read_b64_tr_b16 v[46:47], v11 offset:26624
  s_add_u32 s43, s43, 16384
  buffer_load_dwordx4 v3, s[12:15], s43 offen lds
  buffer_load_dwordx4 v[96:99], v2, s[8:11], s45 offen offset:1024
  s_add_u32 s46, s46, 28672
  s_cmp_ge_u32 s46, 86016
  s_cselect_b32 s50, 86016, 0
  s_sub_u32 s46, s46, s50
  s_add_u32 s47, s47, 24576
  s_cmp_ge_u32 s47, 159744
  s_cselect_b32 s50, 73728, 0
  s_sub_u32 s47, s47, s50
  s_waitcnt vmcnt(24) lgkmcnt(0)
  s_barrier
  v_add_u32 v8, s48, v12
  v_add_u32 v9, s48, v13
  v_add_u32 v10, s48, v14
  v_add_u32 v11, s48, v15
  s_add_u32 s48, s48, 28672
  s_cmp_eq_u32 s48, 86016
  s_cselect_b32 s48, 0, s48
  v_mfma_f32_32x32x16_bf16 v[104:119], v[32:35], v[100:103], v[104:119]
  ds_read_b64_tr_b16 v[16:17], v8 offset:0
  ds_read_b64_tr_b16 v[18:19], v8 offset:2048
  v_mfma_f32_32x32x16_bf16 v[120:135], v[36:39], v[100:103], v[120:135]
  ds_read_b64_tr_b16 v[20:21], v9 offset:0
  ds_read_b64_tr_b16 v[22:23], v9 offset:2048
  v_mfma_f32_32x32x16_bf16 v[136:151], v[40:43], v[100:103], v[136:151]
  ds_read_b64_tr_b16 v[24:25], v10 offset:0
  ds_read_b64_tr_b16 v[26:27], v10 offset:2048
  v_mfma_f32_32x32x16_bf16 v[152:167], v[44:47], v[100:103], v[152:167]
  ds_read_b64_tr_b16 v[28:29], v11 offset:0
  ds_read_b64_tr_b16 v[30:31], v11 offset:2048
  s_waitcnt lgkmcnt(0)
  v_mfma_f32_32x32x16_bf16 v[104:119], v[16:19], v[48:51], v[104:119]
  ds_read_b64_tr_b16 v[32:33], v8 offset:4096
  ds_read_b64_tr_b16 v[34:35], v8 offset:6144
  buffer_load_dwordx4 v[100:103], v2, s[8:11], s45 offen offset:2048
  s_add_u32 s45, s45, 7168
  v_mfma_f32_32x32x16_bf16 v[120:135], v[20:23], v[48:51], v[120:135]
  ds_read_b64_tr_b16 v[36:37], v9 offset:4096
  ds_read_b64_tr_b16 v[38:39], v9 offset:6144
  s_add_u32 m0, s47, 0
  s_add_u32 s44, s44, 4096
  v_mfma_f32_32x32x16_bf16 v[136:151], v[24:27], v[48:51], v[136:151]
  ds_read_b64_tr_b16 v[40:41], v10 offset:4096
  ds_read_b64_tr_b16 v[42:43], v10 offset:6144
  buffer_load_dwordx4 v1, s[8:11], s44 offen lds
  s_add_u32 m0, s46, 0
  v_mfma_f32_32x32x16_bf16 v[152:167], v[28:31], v[48:51], v[152:167]
  ds_read_b64_tr_b16 v[44:45], v11 offset:4096
  ds_read_b64_tr_b16 v[46:47], v11 offset:6144
  s_add_u32 s43, s43, 49152
  buffer_load_dwordx4 v3, s[12:15], s43 offen lds
  s_waitcnt lgkmcnt(0)
  v_mfma_f32_32x32x16_bf16 v[104:119], v[32:35], v[52:55], v[104:119]
  ds_read_b64_tr_b16 v[16:17], v8 offset:8192
  ds_read_b64_tr_b16 v[18:19], v8 offset:10240
  buffer_load_dwordx4 v[48:51], v1, s[8:11], s45 offen offset:0
  s_add_u32 m0, s47, 4096
  v_mfma_f32_32x32x16_bf16 v[120:135], v[36:39], v[52:55], v[120:135]
  ds_read_b64_tr_b16 v[20:21], v9 offset:8192
  ds_read_b64_tr_b16 v[22:23], v9 offset:10240
  s_add_u32 s44, s44, 4096
  buffer_load_dwordx4 v1, s[8:11], s44 offen lds
  v_mfma_f32_32x32x16_bf16 v[136:151], v[40:43], v[52:55], v[136:151]
  ds_read_b64_tr_b16 v[24:25], v10 offset:8192
  ds_read_b64_tr_b16 v[26:27], v10 offset:10240
  s_add_u32 m0, s46, 4096
  s_add_u32 s43, s43, 16384
  v_mfma_f32_32x32x16_bf16 v[152:167], v[44:47], v[52:55], v[152:167]
  ds_read_b64_tr_b16 v[28:29], v11 offset:8192
  ds_read_b64_tr_b16 v[30:31], v11 offset:10240
  buffer_load_dwordx4 v3, s[12:15], s43 offen lds
  s_waitcnt lgkmcnt(0)
  v_mfma_f32_32x32x16_bf16 v[104:119], v[16:19], v[56:59], v[104:119]
  ds_read_b64_tr_b16 v[32:33], v8 offset:12288
  ds_read_b64_tr_b16 v[34:35], v8 offset:14336
  buffer_load_dwordx4 v[52:55], v1, s[8:11], s45 offen offset:1024
  s_add_u32 m0, s47, 8192
  v_mfma_f32_32x32x16_bf16 v[120:135], v[20:23], v[56:59], v[120:135]
  ds_read_b64_tr_b16 v[36:37], v9 offset:12288
  ds_read_b64_tr_b16 v[38:39], v9 offset:14336
  s_add_u32 s44, s44, 4096
  buffer_load_dwordx4 v1, s[8:11], s44 offen lds
  v_mfma_f32_32x32x16_bf16 v[136:151], v[24:27], v[56:59], v[136:151]
  ds_read_b64_tr_b16 v[40:41], v10 offset:12288
  ds_read_b64_tr_b16 v[42:43], v10 offset:14336
  s_add_u32 m0, s46, 8192
  s_add_u32 s43, s43, 49152
  v_mfma_f32_32x32x16_bf16 v[152:167], v[28:31], v[56:59], v[152:167]
  ds_read_b64_tr_b16 v[44:45], v11 offset:12288
  ds_read_b64_tr_b16 v[46:47], v11 offset:14336
  buffer_load_dwordx4 v3, s[12:15], s43 offen lds
  s_waitcnt lgkmcnt(0)
  v_mfma_f32_32x32x16_bf16 v[104:119], v[32:35], v[60:63], v[104:119]
  ds_read_b64_tr_b16 v[16:17], v8 offset:16384
  ds_read_b64_tr_b16 v[18:19], v8 offset:18432
  buffer_load_dwordx4 v[56:59], v1, s[8:11], s45 offen offset:2048
  s_add_u32 m0, s47, 12288
  v_mfma_f32_32x32x16_bf16 v[120:135], v[36:39], v[60:63], v[120:135]
  ds_read_b64_tr_b16 v[20:21], v9 offset:16384
  ds_read_b64_tr_b16 v[22:23], v9 offset:18432
  s_add_u32 s44, s44, 4096
  buffer_load_dwordx4 v1, s[8:11], s44 offen lds
  v_mfma_f32_32x32x16_bf16 v[136:151], v[40:43], v[60:63], v[136:151]
  ds_read_b64_tr_b16 v[24:25], v10 offset:16384
  ds_read_b64_tr_b16 v[26:27], v10 offset:18432
  s_add_u32 m0, s46, 12288
  s_add_u32 s43, s43, 16384
  v_mfma_f32_32x32x16_bf16 v[152:167], v[44:47], v[60:63], v[152:167]
  ds_read_b64_tr_b16 v[28:29], v11 offset:16384
  ds_read_b64_tr_b16 v[30:31], v11 offset:18432
  buffer_load_dwordx4 v3, s[12:15], s43 offen lds
  s_waitcnt lgkmcnt(0)
  v_mfma_f32_32x32x16_bf16 v[104:119], v[16:19], v[64:67], v[104:119]
  ds_read_b64_tr_b16 v[32:33], v8 offset:20480
  ds_read_b64_tr_b16 v[34:35], v8 offset:22528
  buffer_load_dwordx4 v[60:63], v1, s[8:11], s45 offen offset:3072
  s_add_u32 m0, s47, 16384
  v_mfma_f32_32x32x16_bf16 v[120:135], v[20:23], v[64:67], v[120:135]
  ds_read_b64_tr_b16 v[36:37], v9 offset:20480
  ds_read_b64_tr_b16 v[38:39], v9 offset:22528
  s_add_u32 s44, s44, 4096
  buffer_load_dwordx4 v1, s[8:11], s44 offen lds
  v_mfma_f32_32x32x16_bf16 v[136:151], v[24:27], v[64:67], v[136:151]
  ds_read_b64_tr_b16 v[40:41], v10 offset:20480
  ds_read_b64_tr_b16 v[42:43], v10 offset:22528
  s_add_u32 m0, s46, 16384
  s_add_u32 s43, s43, 49152
  v_mfma_f32_32x32x16_bf16 v[152:167], v[28:31], v[64:67], v[152:167]
  ds_read_b64_tr_b16 v[44:45], v11 offset:20480
  ds_read_b64_tr_b16 v[46:47], v11 offset:22528
  buffer_load_dwordx4 v3, s[12:15], s43 offen lds
  s_waitcnt lgkmcnt(0)
  v_mfma_f32_32x32x16_bf16 v[104:119], v[32:35], v[68:71], v[104:119]
  ds_read_b64_tr_b16 v[16:17], v8 offset:24576
  ds_read_b64_tr_b16 v[18:19], v8 offset:26624
  buffer_load_dwordx4 v[64:67], v2, s[8:11], s45 offen offset:0
  s_add_u32 m0, s47, 20480
  s_add_u32 s44, s44, 4096
  v_mfma_f32_32x32x16_bf16 v[120:135], v[36:39], v[68:71], v[120:135]
  ds_read_b64_tr_b16 v[20:21], v9 offset:24576
  ds_read_b64_tr_b16 v[22:23], v9 offset:26624
  buffer_load_dwordx4 v1, s[8:11], s44 offen lds
  s_add_u32 m0, s46, 20480
  s_add_u32 s43, s43, 16384
  v_mfma_f32_32x32x16_bf16 v[136:151], v[40:43], v[68:71], v[136:151]
  ds_read_b64_tr_b16 v[24:25], v10 offset:24576
  ds_read_b64_tr_b16 v[26:27], v10 offset:26624
  buffer_load_dwordx4 v3, s[12:15], s43 offen lds
  s_add_u32 m0, s46, 24576
  v_mfma_f32_32x32x16_bf16 v[152:167], v[44:47], v[68:71], v[152:167]
  ds_read_b64_tr_b16 v[28:29], v11 offset:24576
  ds_read_b64_tr_b16 v[30:31], v11 offset:26624
  s_add_u32 s43, s43, 49152
  buffer_load_dwordx4 v3, s[12:15], s43 offen lds
  buffer_load_dwordx4 v[68:71], v2, s[8:11], s45 offen offset:1024
  s_add_u32 s46, s46, 28672
  s_cmp_ge_u32 s46, 86016
  s_cselect_b32 s50, 86016, 0
  s_sub_u32 s46, s46, s50
  s_add_u32 s47, s47, 24576
  s_cmp_ge_u32 s47, 159744
  s_cselect_b32 s50, 73728, 0
  s_sub_u32 s47, s47, s50
  s_waitcnt vmcnt(20) lgkmcnt(0)
  s_barrier
  v_add_u32 v8, s48, v12
  v_add_u32 v9, s48, v13
  v_add_u32 v10, s48, v14
  v_add_u32 v11, s48, v15
  s_add_u32 s48, s48, 28672
  s_cmp_eq_u32 s48, 86016
  s_cselect_b32 s48, 0, s48
  v_mfma_f32_32x32x16_bf16 v[104:119], v[16:19], v[72:75], v[104:119]
  ds_read_b64_tr_b16 v[32:33], v8 offset:0
  ds_read_b64_tr_b16 v[34:35], v8 offset:2048
  v_mfma_f32_32x32x16_bf16 v[120:135], v[20:23], v[72:75], v[120:135]
  ds_read_b64_tr_b16 v[36:37], v9 offset:0
  ds_read_b64_tr_b16 v[38:39], v9 offset:2048
  v_mfma_f32_32x32x16_bf16 v[136:151], v[24:27], v[72:75], v[136:151]
  ds_read_b64_tr_b16 v[40:41], v10 offset:0
  ds_read_b64_tr_b16 v[42:43], v10 offset:2048
  v_mfma_f32_32x32x16_bf16 v[152:167], v[28:31], v[72:75], v[152:167]
  ds_read_b64_tr_b16 v[44:45], v11 offset:0
  ds_read_b64_tr_b16 v[46:47], v11 offset:2048
  s_waitcnt lgkmcnt(0)
  v_mfma_f32_32x32x16_bf16 v[104:119], v[32:35], v[76:79], v[104:119]
  ds_read_b64_tr_b16 v[16:17], v8 offset:4096
  ds_read_b64_tr_b16 v[18:19], v8 offset:6144
  buffer_load_dwordx4 v[72:75], v2, s[8:11], s45 offen offset:2048
  s_add_u32 s45, s45, 7168
  v_mfma_f32_32x32x16_bf16 v[120:135], v[36:39], v[76:79], v[120:135]
  ds_read_b64_tr_b16 v[20:21], v9 offset:4096
  ds_read_b64_tr_b16 v[22:23], v9 offset:6144
  s_add_u32 m0, s46, 0
  v_mfma_f32_32x32x16_bf16 v[136:151], v[40:43], v[76:79], v[136:151]
  ds_read_b64_tr_b16 v[24:25], v10 offset:4096
  ds_read_b64_tr_b16 v[26:27], v10 offset:6144
  s_add_u32 s43, s43, 16384
  v_mfma_f32_32x32x16_bf16 v[152:167], v[44:47], v[76:79], v[152:167]
  ds_read_b64_tr_b16 v[28:29], v11 offset:4096
  ds_read_b64_tr_b16 v[30:31], v11 offset:6144
  buffer_load_dwordx4 v3, s[12:15], s43 offen lds
  s_waitcnt lgkmcnt(0)
  v_mfma_f32_32x32x16_bf16 v[104:119], v[16:19], v[80:83], v[104:119]
  ds_read_b64_tr_b16 v[32:33], v8 offset:8192
  ds_read_b64_tr_b16 v[34:35], v8 offset:10240
  buffer_load_dwordx4 v[76:79], v1, s[8:11], s45 offen offset:0
  v_mfma_f32_32x32x16_bf16 v[120:135], v[20:23], v[80:83], v[120:135]
  ds_read_b64_tr_b16 v[36:37], v9 offset:8192
  ds_read_b64_tr_b16 v[38:39], v9 offset:10240
  s_add_u32 m0, s46, 4096
  v_mfma_f32_32x32x16_bf16 v[136:151], v[24:27], v[80:83], v[136:151]
  ds_read_b64_tr_b16 v[40:41], v10 offset:8192
  ds_read_b64_tr_b16 v[42:43], v10 offset:10240
  s_add_u32 s43, s43, 49152
  v_mfma_f32_32x32x16_bf16 v[152:167], v[28:31], v[80:83], v[152:167]
  ds_read_b64_tr_b16 v[44:45], v11 offset:8192
  ds_read_b64_tr_b16 v[46:47], v11 offset:10240
  buffer_load_dwordx4 v3, s[12:15], s43 offen lds
  s_waitcnt lgkmcnt(0)
  v_mfma_f32_32x32x16_bf16 v[104:119], v[32:35], v[84:87], v[104:119]
  ds_read_b64_tr_b16 v[16:17], v8 offset:12288
  ds_read_b64_tr_b16 v[18:19], v8 offset:14336
  buffer_load_dwordx4 v[80:83], v1, s[8:11], s45 offen offset:1024
  v_mfma_f32_32x32x16_bf16 v[120:135], v[36:39], v[84:87], v[120:135]
  ds_read_b64_tr_b16 v[20:21], v9 offset:12288
  ds_read_b64_tr_b16 v[22:23], v9 offset:14336
  s_add_u32 m0, s46, 8192
  v_mfma_f32_32x32x16_bf16 v[136:151], v[40:43], v[84:87], v[136:151]
  ds_read_b64_tr_b16 v[24:25], v10 offset:12288
  ds_read_b64_tr_b16 v[26:27], v10 offset:14336
  s_add_u32 s43, s43, 16384
  v_mfma_f32_32x32x16_bf16 v[152:167], v[44:47], v[84:87], v[152:167]
  ds_read_b64_tr_b16 v[28:29], v11 offset:12288
  ds_read_b64_tr_b16 v[30:31], v11 offset:14336
  buffer_load_dwordx4 v3, s[12:15], s43 offen lds
  s_waitcnt lgkmcnt(0)
  v_mfma_f32_32x32x16_bf16 v[104:119], v[16:19], v[88:91], v[104:119]
  ds_read_b64_tr_b16 v[32:33], v8 offset:16384
  ds_read_b64_tr_b16 v[34:35], v8 offset:18432
  buffer_load_dwordx4 v[84:87], v1, s[8:11], s45 offen offset:2048
  v_mfma_f32_32x32x16_bf16 v[120:135], v[20:23], v[88:91], v[120:135]
  ds_read_b64_tr_b16 v[36:37], v9 offset:16384
  ds_read_b64_tr_b16 v[38:39], v9 offset:18432
  s_add_u32 m0, s46, 12288
  v_mfma_f32_32x32x16_bf16 v[136:151], v[24:27], v[88:91], v[136:151]
  ds_read_b64_tr_b16 v[40:41], v10 offset:16384
  ds_read_b64_tr_b16 v[42:43], v10 offset:18432
  s_add_u32 s43, s43, 49152
  v_mfma_f32_32x32x16_bf16 v[152:167], v[28:31], v[88:91], v[152:167]
  ds_read_b64_tr_b16 v[44:45], v11 offset:16384
  ds_read_b64_tr_b16 v[46:47], v11 offset:18432
  buffer_load_dwordx4 v3, s[12:15], s43 offen lds
  s_waitcnt lgkmcnt(0)
  v_mfma_f32_32x32x16_bf16 v[104:119], v[32:35], v[92:95], v[104:119]
  ds_read_b64_tr_b16 v[16:17], v8 offset:20480
  ds_read_b64_tr_b16 v[18:19], v8 offset:22528
  buffer_load_dwordx4 v[88:91], v1, s[8:11], s45 offen offset:3072
  v_mfma_f32_32x32x16_bf16 v[120:135], v[36:39], v[92:95], v[120:135]
  ds_read_b64_tr_b16 v[20:21], v9 offset:20480
  ds_read_b64_tr_b16 v[22:23], v9 offset:22528
  s_add_u32 m0, s46, 16384
  v_mfma_f32_32x32x16_bf16 v[136:151], v[40:43], v[92:95], v[136:151]
  ds_read_b64_tr_b16 v[24:25], v10 offset:20480
  ds_read_b64_tr_b16 v[26:27], v10 offset:22528
  s_add_u32 s43, s43, 16384
  v_mfma_f32_32x32x16_bf16 v[152:167], v[44:47], v[92:95], v[152:167]
  ds_read_b64_tr_b16 v[28:29], v11 offset:20480
  ds_read_b64_tr_b16 v[30:31], v11 offset:22528
  buffer_load_dwordx4 v3, s[12:15], s43 offen lds
  s_waitcnt lgkmcnt(0)
  v_mfma_f32_32x32x16_bf16 v[104:119], v[16:19], v[96:99], v[104:119]
  ds_read_b64_tr_b16 v[32:33], v8 offset:24576
  ds_read_b64_tr_b16 v[34:35], v8 offset:26624
  buffer_load_dwordx4 v[92:95], v2, s[8:11], s45 offen offset:0
  s_add_u32 m0, s46, 20480
  v_mfma_f32_32x32x16_bf16 v[120:135], v[20:23], v[96:99], v[120:135]
  ds_read_b64_tr_b16 v[36:37], v9 offset:24576
  ds_read_b64_tr_b16 v[38:39], v9 offset:26624
  s_add_u32 s43, s43, 49152
  buffer_load_dwordx4 v3, s[12:15], s43 offen lds
  v_mfma_f32_32x32x16_bf16 v[136:151], v[24:27], v[96:99], v[136:151]
  ds_read_b64_tr_b16 v[40:41], v10 offset:24576
  ds_read_b64_tr_b16 v[42:43], v10 offset:26624
  s_add_u32 m0, s46, 24576
  s_add_u32 s43, s43, 16384
  v_mfma_f32_32x32x16_bf16 v[152:167], v[28:31], v[96:99], v[152:167]
  ds_read_b64_tr_b16 v[44:45], v11 offset:24576
  ds_read_b64_tr_b16 v[46:47], v11 offset:26624
  buffer_load_dwordx4 v3, s[12:15], s43 offen lds
  buffer_load_dwordx4 v[96:99], v2, s[8:11], s45 offen offset:1024
  s_add_u32 s46, s46, 28672
  s_cmp_ge_u32 s46, 86016
  s_cselect_b32 s50, 86016, 0
  s_sub_u32 s46, s46, s50
  s_add_u32 s47, s47, 24576
  s_cmp_ge_u32 s47, 159744
  s_cselect_b32 s50, 73728, 0
  s_sub_u32 s47, s47, s50
  s_waitcnt vmcnt(14) lgkmcnt(0)
  s_barrier
  v_add_u32 v8, s48, v12
  v_add_u32 v9, s48, v13
  v_add_u32 v10, s48, v14
  v_add_u32 v11, s48, v15
  s_add_u32 s48, s48, 28672
  s_cmp_eq_u32 s48, 86016
  s_cselect_b32 s48, 0, s48
  v_mfma_f32_32x32x16_bf16 v[104:119], v[32:35], v[100:103], v[104:119]
  ds_read_b64_tr_b16 v[16:17], v8 offset:0
  ds_read_b64_tr_b16 v[18:19], v8 offset:2048
  v_mfma_f32_32x32x16_bf16 v[120:135], v[36:39], v[100:103], v[120:135]
  ds_read_b64_tr_b16 v[20:21], v9 offset:0
  ds_read_b64_tr_b16 v[22:23], v9 offset:2048
  v_mfma_f32_32x32x16_bf16 v[136:151], v[40:43], v[100:103], v[136:151]
  ds_read_b64_tr_b16 v[24:25], v10 offset:0
  ds_read_b64_tr_b16 v[26:27], v10 offset:2048
  v_mfma_f32_32x32x16_bf16 v[152:167], v[44:47], v[100:103], v[152:167]
  ds_read_b64_tr_b16 v[28:29], v11 offset:0
  ds_read_b64_tr_b16 v[30:31], v11 offset:2048
  s_waitcnt lgkmcnt(0)
  v_mfma_f32_32x32x16_bf16 v[104:119], v[16:19], v[48:51], v[104:119]
  ds_read_b64_tr_b16 v[32:33], v8 offset:4096
  ds_read_b64_tr_b16 v[34:35], v8 offset:6144
  buffer_load_dwordx4 v[100:103], v2, s[8:11], s45 offen offset:2048
  buffer_load_dwordx4 v[168:171], v248, s[24:27], s63 offen offset:0
  v_mfma_f32_32x32x16_bf16 v[120:135], v[20:23], v[48:51], v[120:135]
  ds_read_b64_tr_b16 v[36:37], v9 offset:4096
  ds_read_b64_tr_b16 v[38:39], v9 offset:6144
  buffer_load_dwordx4 v[172:175], v248, s[24:27], s63 offen offset:32
  v_mfma_f32_32x32x16_bf16 v[136:151], v[24:27], v[48:51], v[136:151]
  ds_read_b64_tr_b16 v[40:41], v10 offset:4096
  ds_read_b64_tr_b16 v[42:43], v10 offset:6144
  ds_write_b128 v250, v[184:187] offset:0
  v_mfma_f32_32x32x16_bf16 v[152:167], v[28:31], v[48:51], v[152:167]
  ds_read_b64_tr_b16 v[44:45], v11 offset:4096
  ds_read_b64_tr_b16 v[46:47], v11 offset:6144
  ds_write_b128 v250, v[188:191] offset:4096
  s_waitcnt lgkmcnt(0)
  v_mfma_f32_32x32x16_bf16 v[104:119], v[32:35], v[52:55], v[104:119]
  ds_read_b64_tr_b16 v[16:17], v8 offset:8192
  ds_read_b64_tr_b16 v[18:19], v8 offset:10240
  ds_write_b128 v250, v[192:195] offset:8192
  v_mfma_f32_32x32x16_bf16 v[120:135], v[36:39], v[52:55], v[120:135]
  ds_read_b64_tr_b16 v[20:21], v9 offset:8192
  ds_read_b64_tr_b16 v[22:23], v9 offset:10240
  ds_write_b128 v250, v[196:199] offset:12288
  v_mfma_f32_32x32x16_bf16 v[136:151], v[40:43], v[52:55], v[136:151]
  ds_read_b64_tr_b16 v[24:25], v10 offset:8192
  ds_read_b64_tr_b16 v[26:27], v10 offset:10240
  v_mfma_f32_32x32x16_bf16 v[152:167], v[44:47], v[52:55], v[152:167]
  ds_read_b64_tr_b16 v[28:29], v11 offset:8192
  ds_read_b64_tr_b16 v[30:31], v11 offset:10240
  s_waitcnt lgkmcnt(0)
  v_mfma_f32_32x32x16_bf16 v[104:119], v[16:19], v[56:59], v[104:119]
  ds_read_b64_tr_b16 v[32:33], v8 offset:12288
  ds_read_b64_tr_b16 v[34:35], v8 offset:14336
  ds_write_b128 v250, v[200:203] offset:16384
  v_mfma_f32_32x32x16_bf16 v[120:135], v[20:23], v[56:59], v[120:135]
  ds_read_b64_tr_b16 v[36:37], v9 offset:12288
  ds_read_b64_tr_b16 v[38:39], v9 offset:14336
  ds_write_b128 v250, v[204:207] offset:20480
  v_mfma_f32_32x32x16_bf16 v[136:151], v[24:27], v[56:59], v[136:151]
  ds_read_b64_tr_b16 v[40:41], v10 offset:12288
  ds_read_b64_tr_b16 v[42:43], v10 offset:14336
  v_mfma_f32_32x32x16_bf16 v[152:167], v[28:31], v[56:59], v[152:167]
  ds_read_b64_tr_b16 v[44:45], v11 offset:12288
  ds_read_b64_tr_b16 v[46:47], v11 offset:14336
  s_waitcnt lgkmcnt(0)
  v_mfma_f32_32x32x16_bf16 v[104:119], v[32:35], v[60:63], v[104:119]
  ds_read_b64_tr_b16 v[16:17], v8 offset:16384
  ds_read_b64_tr_b16 v[18:19], v8 offset:18432
  ds_write_b128 v250, v[208:211] offset:24576
  v_mfma_f32_32x32x16_bf16 v[120:135], v[36:39], v[60:63], v[120:135]
  ds_read_b64_tr_b16 v[20:21], v9 offset:16384
  ds_read_b64_tr_b16 v[22:23], v9 offset:18432
  v_mfma_f32_32x32x16_bf16 v[136:151], v[40:43], v[60:63], v[136:151]
  ds_read_b64_tr_b16 v[24:25], v10 offset:16384
  ds_read_b64_tr_b16 v[26:27], v10 offset:18432
  v_mfma_f32_32x32x16_bf16 v[152:167], v[44:47], v[60:63], v[152:167]
  ds_read_b64_tr_b16 v[28:29], v11 offset:16384
  ds_read_b64_tr_b16 v[30:31], v11 offset:18432
  s_waitcnt lgkmcnt(0)
  v_mfma_f32_32x32x16_bf16 v[104:119], v[16:19], v[64:67], v[104:119]
  ds_read_b64_tr_b16 v[32:33], v8 offset:20480
  ds_read_b64_tr_b16 v[34:35], v8 offset:22528
  v_mfma_f32_32x32x16_bf16 v[120:135], v[20:23], v[64:67], v[120:135]
  ds_read_b64_tr_b16 v[36:37], v9 offset:20480
  ds_read_b64_tr_b16 v[38:39], v9 offset:22528
  v_mfma_f32_32x32x16_bf16 v[136:151], v[24:27], v[64:67], v[136:151]
  ds_read_b64_tr_b16 v[40:41], v10 offset:20480
  ds_read_b64_tr_b16 v[42:43], v10 offset:22528
  v_mfma_f32_32x32x16_bf16 v[152:167], v[28:31], v[64:67], v[152:167]
  ds_read_b64_tr_b16 v[44:45], v11 offset:20480
  ds_read_b64_tr_b16 v[46:47], v11 offset:22528
  s_waitcnt lgkmcnt(0)
  v_mfma_f32_32x32x16_bf16 v[104:119], v[32:35], v[68:71], v[104:119]
  ds_read_b64_tr_b16 v[16:17], v8 offset:24576
  ds_read_b64_tr_b16 v[18:19], v8 offset:26624
  v_mfma_f32_32x32x16_bf16 v[120:135], v[36:39], v[68:71], v[120:135]
  ds_read_b64_tr_b16 v[20:21], v9 offset:24576
  ds_read_b64_tr_b16 v[22:23], v9 offset:26624
  v_mfma_f32_32x32x16_bf16 v[136:151], v[40:43], v[68:71], v[136:151]
  ds_read_b64_tr_b16 v[24:25], v10 offset:24576
  ds_read_b64_tr_b16 v[26:27], v10 offset:26624
  v_mfma_f32_32x32x16_bf16 v[152:167], v[44:47], v[68:71], v[152:167]
  ds_read_b64_tr_b16 v[28:29], v11 offset:24576
  ds_read_b64_tr_b16 v[30:31], v11 offset:26624
  s_waitcnt vmcnt(3) lgkmcnt(0)
  s_barrier
  v_add_u32 v8, s48, v12
  v_add_u32 v9, s48, v13
  v_add_u32 v10, s48, v14
  v_add_u32 v11, s48, v15
  s_add_u32 s48, s48, 28672
  s_cmp_eq_u32 s48, 86016
  s_cselect_b32 s48, 0, s48
  v_mfma_f32_32x32x16_bf16 v[104:119], v[16:19], v[72:75], v[104:119]
  ds_read_b64_tr_b16 v[32:33], v8 offset:0
  ds_read_b64_tr_b16 v[34:35], v8 offset:2048
  v_mfma_f32_32x32x16_bf16 v[120:135], v[20:23], v[72:75], v[120:135]
  ds_read_b64_tr_b16 v[36:37], v9 offset:0
  ds_read_b64_tr_b16 v[38:39], v9 offset:2048
  v_mfma_f32_32x32x16_bf16 v[136:151], v[24:27], v[72:75], v[136:151]
  ds_read_b64_tr_b16 v[40:41], v10 offset:0
  ds_read_b64_tr_b16 v[42:43], v10 offset:2048
  v_mfma_f32_32x32x16_bf16 v[152:167], v[28:31], v[72:75], v[152:167]
  ds_read_b64_tr_b16 v[44:45], v11 offset:0
  ds_read_b64_tr_b16 v[46:47], v11 offset:2048
  s_waitcnt lgkmcnt(0)
  v_mfma_f32_32x32x16_bf16 v[104:119], v[32:35], v[76:79], v[104:119]
  ds_read_b64_tr_b16 v[16:17], v8 offset:4096
  ds_read_b64_tr_b16 v[18:19], v8 offset:6144
  ds_write_b128 v250, v[212:215] offset:28672
  v_mfma_f32_32x32x16_bf16 v[120:135], v[36:39], v[76:79], v[120:135]
  ds_read_b64_tr_b16 v[20:21], v9 offset:4096
  ds_read_b64_tr_b16 v[22:23], v9 offset:6144
  ds_write_b128 v250, v[216:219] offset:32768
  v_mfma_f32_32x32x16_bf16 v[136:151], v[40:43], v[76:79], v[136:151]
  ds_read_b64_tr_b16 v[24:25], v10 offset:4096
  ds_read_b64_tr_b16 v[26:27], v10 offset:6144
  v_mfma_f32_32x32x16_bf16 v[152:167], v[44:47], v[76:79], v[152:167]
  ds_read_b64_tr_b16 v[28:29], v11 offset:4096
  ds_read_b64_tr_b16 v[30:31], v11 offset:6144
  s_waitcnt lgkmcnt(0)
  v_mfma_f32_32x32x16_bf16 v[104:119], v[16:19], v[80:83], v[104:119]
  ds_read_b64_tr_b16 v[32:33], v8 offset:8192
  ds_read_b64_tr_b16 v[34:35], v8 offset:10240
  ds_write_b128 v250, v[220:223] offset:36864
  v_mfma_f32_32x32x16_bf16 v[120:135], v[20:23], v[80:83], v[120:135]
  ds_read_b64_tr_b16 v[36:37], v9 offset:8192
  ds_read_b64_tr_b16 v[38:39], v9 offset:10240
  ds_write_b128 v250, v[224:227] offset:40960
  v_mfma_f32_32x32x16_bf16 v[136:151], v[24:27], v[80:83], v[136:151]
  ds_read_b64_tr_b16 v[40:41], v10 offset:8192
  ds_read_b64_tr_b16 v[42:43], v10 offset:10240
  v_mfma_f32_32x32x16_bf16 v[152:167], v[28:31], v[80:83], v[152:167]
  ds_read_b64_tr_b16 v[44:45], v11 offset:8192
  ds_read_b64_tr_b16 v[46:47], v11 offset:10240
  s_waitcnt lgkmcnt(0)
  v_mfma_f32_32x32x16_bf16 v[104:119], v[32:35], v[84:87], v[104:119]
  ds_read_b64_tr_b16 v[16:17], v8 offset:12288
  ds_read_b64_tr_b16 v[18:19], v8 offset:14336
  ds_write_b128 v250, v[228:231] offset:45056
  v_mfma_f32_32x32x16_bf16 v[120:135], v[36:39], v[84:87], v[120:135]
  ds_read_b64_tr_b16 v[20:21], v9 offset:12288
  ds_read_b64_tr_b16 v[22:23], v9 offset:14336
  ds_write_b128 v250, v[232:235] offset:49152
  v_mfma_f32_32x32x16_bf16 v[136:151], v[40:43], v[84:87], v[136:151]
  ds_read_b64_tr_b16 v[24:25], v10 offset:12288
  ds_read_b64_tr_b16 v[26:27], v10 offset:14336
  v_mfma_f32_32x32x16_bf16 v[152:167], v[44:47], v[84:87], v[152:167]
  ds_read_b64_tr_b16 v[28:29], v11 offset:12288
  ds_read_b64_tr_b16 v[30:31], v11 offset:14336
  s_waitcnt lgkmcnt(0)
  v_mfma_f32_32x32x16_bf16 v[104:119], v[16:19], v[88:91], v[104:119]
  ds_read_b64_tr_b16 v[32:33], v8 offset:16384
  ds_read_b64_tr_b16 v[34:35], v8 offset:18432
  ds_write_b128 v250, v[236:239] offset:53248
  v_mfma_f32_32x32x16_bf16 v[120:135], v[20:23], v[88:91], v[120:135]
  ds_read_b64_tr_b16 v[36:37], v9 offset:16384
  ds_read_b64_tr_b16 v[38:39], v9 offset:18432
  ds_write_b128 v251, v[240:243] offset:0
  v_mfma_f32_32x32x16_bf16 v[136:151], v[24:27], v[88:91], v[136:151]
  ds_read_b64_tr_b16 v[40:41], v10 offset:16384
  ds_read_b64_tr_b16 v[42:43], v10 offset:18432
  v_mfma_f32_32x32x16_bf16 v[152:167], v[28:31], v[88:91], v[152:167]
  ds_read_b64_tr_b16 v[44:45], v11 offset:16384
  ds_read_b64_tr_b16 v[46:47], v11 offset:18432
  s_waitcnt lgkmcnt(0)
  v_mfma_f32_32x32x16_bf16 v[104:119], v[32:35], v[92:95], v[104:119]
  ds_read_b64_tr_b16 v[16:17], v8 offset:20480
  ds_read_b64_tr_b16 v[18:19], v8 offset:22528
  ds_write_b128 v251, v[244:247] offset:4096
  v_mfma_f32_32x32x16_bf16 v[120:135], v[36:39], v[92:95], v[120:135]
  ds_read_b64_tr_b16 v[20:21], v9 offset:20480
  ds_read_b64_tr_b16 v[22:23], v9 offset:22528
  v_mfma_f32_32x32x16_bf16 v[136:151], v[40:43], v[92:95], v[136:151]
  ds_read_b64_tr_b16 v[24:25], v10 offset:20480
  ds_read_b64_tr_b16 v[26:27], v10 offset:22528
  v_mfma_f32_32x32x16_bf16 v[152:167], v[44:47], v[92:95], v[152:167]
  ds_read_b64_tr_b16 v[28:29], v11 offset:20480
  ds_read_b64_tr_b16 v[30:31], v11 offset:22528
  s_waitcnt lgkmcnt(0)
  v_mfma_f32_32x32x16_bf16 v[104:119], v[16:19], v[96:99], v[104:119]
  ds_read_b64_tr_b16 v[32:33], v8 offset:24576
  ds_read_b64_tr_b16 v[34:35], v8 offset:26624
  v_mfma_f32_32x32x16_bf16 v[120:135], v[20:23], v[96:99], v[120:135]
  ds_read_b64_tr_b16 v[36:37], v9 offset:24576
  ds_read_b64_tr_b16 v[38:39], v9 offset:26624
  v_mfma_f32_32x32x16_bf16 v[136:151], v[24:27], v[96:99], v[136:151]
  ds_read_b64_tr_b16 v[40:41], v10 offset:24576
  ds_read_b64_tr_b16 v[42:43], v10 offset:26624
  v_mfma_f32_32x32x16_bf16 v[152:167], v[28:31], v[96:99], v[152:167]
  ds_read_b64_tr_b16 v[44:45], v11 offset:24576
  ds_read_b64_tr_b16 v[46:47], v11 offset:26624
  s_waitcnt lgkmcnt(0) vmcnt(2)
  v_mfma_f32_32x32x16_bf16 v[104:119], v[32:35], v[100:103], v[104:119]
  v_mfma_f32_32x32x16_bf16 v[120:135], v[36:39], v[100:103], v[120:135]
  v_mfma_f32_32x32x16_bf16 v[136:151], v[40:43], v[100:103], v[136:151]
  v_mfma_f32_32x32x16_bf16 v[152:167], v[44:47], v[100:103], v[152:167]
  s_lshl_b32 s45, s51, 6
  s_lshl_b32 s55, s52, 3
  s_add_u32 s45, s45, s55
  s_xor_b32 s55, s53, 1
  s_lshl_b32 s55, s55, 2
  s_add_u32 s45, s45, s55
  s_lshl_b32 s45, s45, 10
  s_add_u32 s45, s45, 37748736
  s_nop 7
  v_cvt_pk_bf16_f32 v64, v136, v137
  v_cvt_pk_bf16_f32 v65, v138, v139
  v_cvt_pk_bf16_f32 v66, v140, v141
  v_cvt_pk_bf16_f32 v67, v142, v143
  buffer_store_dwordx4 v[64:67], v1, s[8:11], s45 offen offset:2048 sc1
  v_cvt_pk_bf16_f32 v68, v144, v145
  v_cvt_pk_bf16_f32 v69, v146, v147
  v_cvt_pk_bf16_f32 v70, v148, v149
  v_cvt_pk_bf16_f32 v71, v150, v151
  buffer_store_dwordx4 v[68:71], v1, s[8:11], s45 offen offset:3072 sc1
  v_cvt_pk_bf16_f32 v72, v152, v153
  v_cvt_pk_bf16_f32 v73, v154, v155
  v_cvt_pk_bf16_f32 v74, v156, v157
  v_cvt_pk_bf16_f32 v75, v158, v159
  buffer_store_dwordx4 v[72:75], v1, s[8:11], s45 offen offset:0 sc1
  v_cvt_pk_bf16_f32 v76, v160, v161
  v_cvt_pk_bf16_f32 v77, v162, v163
  v_cvt_pk_bf16_f32 v78, v164, v165
  v_cvt_pk_bf16_f32 v79, v166, v167
  buffer_store_dwordx4 v[76:79], v1, s[8:11], s45 offen offset:1024 sc1
  v_mov_b32 v5, 1
  s_lshl_b32 s3, s2, 3
  s_add_u32 s3, s3, s39
  s_lshl_b32 s3, s3, 7
  s_add_u32 s3, s3, 2097152
  s_sub_u32 s62, s61, 1
  s_cmp_lt_u32 s62, 33
  s_cbranch_scc1 L_k2_next
  s_waitcnt lgkmcnt(0)
  s_barrier
  s_waitcnt vmcnt(0)
  s_mov_b64 exec, 1
  buffer_store_dword v5, off, s[8:11], s3 sc1
  s_mov_b64 exec, -1
  s_xor_b32 s59, s3, 1024
  v_permlane32_swap_b32 v168, v170
  v_permlane32_swap_b32 v169, v171
  v_permlane32_swap_b32 v172, v174
  v_permlane32_swap_b32 v173, v175
  s_mov_b32 s50, 0xffff0000
  v_lshlrev_b32 v4, 16, v168
  v_and_b32 v5, s50, v168
  v_add_f32 v104, v104, v4
  v_add_f32 v105, v105, v5
  v_lshlrev_b32 v4, 16, v169
  v_and_b32 v5, s50, v169
  v_add_f32 v106, v106, v4
  v_add_f32 v107, v107, v5
  v_lshlrev_b32 v4, 16, v170
  v_and_b32 v5, s50, v170
  v_add_f32 v108, v108, v4
  v_add_f32 v109, v109, v5
  v_lshlrev_b32 v4, 16, v171
  v_and_b32 v5, s50, v171
  v_add_f32 v110, v110, v4
  v_add_f32 v111, v111, v5
  v_lshlrev_b32 v4, 16, v172
  v_and_b32 v5, s50, v172
  v_add_f32 v112, v112, v4
  v_add_f32 v113, v113, v5
  v_lshlrev_b32 v4, 16, v173
  v_and_b32 v5, s50, v173
  v_add_f32 v114, v114, v4
  v_add_f32 v115, v115, v5
  v_lshlrev_b32 v4, 16, v174
  v_and_b32 v5, s50, v174
  v_add_f32 v116, v116, v4
  v_add_f32 v117, v117, v5
  v_lshlrev_b32 v4, 16, v175
  v_and_b32 v5, s50, v175
  v_add_f32 v118, v118, v4
  v_add_f32 v119, v119, v5
L_k2_out:
  s_lshr_b32 s45, s39, 2
  s_lshl_b32 s44, s67, 1
  s_add_u32 s44, s44, s45
  s_lshl_b32 s44, s44, 15
  s_add_u32 s44, s44, 33554432
  s_lshl_b32 s48, s67, 4
  s_add_u32 s48, s48, s68
  s_lshl_b32 s48, s48, 12
  s_add_u32 s48, s48, 37748736
  s_mov_b32 s52, s69
  s_mov_b32 s53, s69
  s_cmp_eq_u32 s45, 0
  s_mov_b32 s46, 28672
  s_cselect_b32 s46, 86016, s46
  s_cselect_b32 s47, 99, 7
  s_lshl_b32 s57, s39, 12
  s_xor_b32 s58, s57, 16384
  v_lshrrev_b32 v4, 4, v1
  v_bfe_u32 v5, v4, 2, 2
  v_lshrrev_b32 v6, 5, v4
  v_lshl_add_u32 v5, v6, 2, v5
  v_lshlrev_b32 v5, 7, v5
  v_bfe_u32 v6, v4, 3, 1
  v_xor_b32 v6, s45, v6
  v_lshl_add_u32 v5, v6, 6, v5
  v_bfe_u32 v6, v4, 4, 1
  v_lshl_add_u32 v5, v6, 5, v5
  v_and_b32 v6, 3, v4
  v_lshl_add_u32 v12, v6, 3, v5
  v_xor_b32 v13, 64, v12
  v_add_u32 v14, s57, v1
  v_add_u32 v15, s58, v1
  v_mov_b32 v6, 159744
  s_mov_b32 s28, s22
  s_mov_b32 s29, s23
  s_mov_b32 s30, 4194304
  s_mov_b32 s31, 0x20000
  s_branch L_k2_state1
L_k2_state:
  s_sleep 2
L_k2_state1:
  ds_read_b32 v5, v6 offset:16
  s_waitcnt lgkmcnt(0)
  v_readfirstlane_b32 s62, v5
  s_cmp_eq_u32 s62, 0
  s_cbranch_scc1 L_k2_state
  s_cmp_eq_u32 s62, 2
  s_cbranch_scc1 L_k2_f1
  s_lshl_b32 s3, s53, 13
  s_add_u32 s3, s3, s46
  s_cmp_eq_u32 s53, s47
  s_cselect_b32 s3, 151552, s3
  s_add_u32 s53, s53, 1
  s_and_b32 s53, s53, 7
  v_add_u32 v8, s3, v12
  v_add_u32 v9, s3, v13
  s_lshl_b32 s55, s52, 12
  s_add_u32 s55, s55, s44
  s_add_u32 s52, s52, 1
  s_and_b32 s52, s52, 7
  buffer_load_dwordx4 v[136:139], v1, s[8:11], s55 offen offset:0
  buffer_load_dwordx4 v[140:143], v1, s[8:11], s55 offen offset:1024
  buffer_load_dwordx4 v[144:147], v1, s[8:11], s55 offen offset:2048
  buffer_load_dwordx4 v[148:151], v1, s[8:11], s55 offen offset:3072
  s_lshl_b32 s55, s52, 12
  s_add_u32 s55, s55, s44
  s_add_u32 s52, s52, 1
  s_and_b32 s52, s52, 7
  buffer_load_dwordx4 v[152:155], v1, s[8:11], s55 offen offset:0
  buffer_load_dwordx4 v[156:159], v1, s[8:11], s55 offen offset:1024
  buffer_load_dwordx4 v[160:163], v1, s[8:11], s55 offen offset:2048
  buffer_load_dwordx4 v[164:167], v1, s[8:11], s55 offen offset:3072
  s_lshl_b32 s55, s52, 12
  s_add_u32 s55, s55, s44
  s_add_u32 s52, s52, 1
  s_and_b32 s52, s52, 7
  buffer_load_dwordx4 v[168:171], v1, s[8:11], s55 offen offset:0
  buffer_load_dwordx4 v[172:175], v1, s[8:11], s55 offen offset:1024
  buffer_load_dwordx4 v[176:179], v1, s[8:11], s55 offen offset:2048
  buffer_load_dwordx4 v[180:183], v1, s[8:11], s55 offen offset:3072
  s_lshl_b32 s55, s52, 12
  s_add_u32 s55, s55, s44
  s_add_u32 s52, s52, 1
  s_and_b32 s52, s52, 7
  buffer_load_dwordx4 v[200:203], v1, s[8:11], s55 offen offset:0
  buffer_load_dwordx4 v[204:207], v1, s[8:11], s55 offen offset:1024
  buffer_load_dwordx4 v[208:211], v1, s[8:11], s55 offen offset:2048
  buffer_load_dwordx4 v[212:215], v1, s[8:11], s55 offen offset:3072
  ds_read_b64_tr_b16 v[16:17], v8 offset:0
  ds_read_b64_tr_b16 v[18:19], v8 offset:1024
  ds_read_b64_tr_b16 v[20:21], v9 offset:0
  ds_read_b64_tr_b16 v[22:23], v9 offset:1024
  ds_read_b64_tr_b16 v[24:25], v8 offset:2048
  ds_read_b64_tr_b16 v[26:27], v8 offset:3072
  ds_read_b64_tr_b16 v[28:29], v9 offset:2048
  ds_read_b64_tr_b16 v[30:31], v9 offset:3072
  ds_read_b64_tr_b16 v[32:33], v8 offset:4096
  ds_read_b64_tr_b16 v[34:35], v8 offset:5120
  ds_read_b64_tr_b16 v[36:37], v9 offset:4096
  ds_read_b64_tr_b16 v[38:39], v9 offset:5120
  ds_read_b64_tr_b16 v[40:41], v8 offset:6144
  ds_read_b64_tr_b16 v[42:43], v8 offset:7168
  ds_read_b64_tr_b16 v[44:45], v9 offset:6144
  ds_read_b64_tr_b16 v[46:47], v9 offset:7168
  s_cmp_lg_u32 s45, 0
  s_cbranch_scc1 L_k2_p2d
  s_lshl_b32 s3, s53, 13
  s_add_u32 s3, s3, s46
  s_cmp_eq_u32 s53, s47
  s_cselect_b32 s3, 151552, s3
  s_add_u32 s53, s53, 1
  s_and_b32 s53, s53, 7
  v_add_u32 v8, s3, v12
  v_add_u32 v9, s3, v13
  s_waitcnt vmcnt(12) lgkmcnt(0)
  v_mfma_f32_32x32x16_bf16 v[104:119], v[16:19], v[136:139], v[104:119]
  ds_read_b64_tr_b16 v[48:49], v8 offset:0
  ds_read_b64_tr_b16 v[50:51], v8 offset:1024
  s_lshl_b32 s55, s52, 12
  s_add_u32 s55, s55, s44
  s_add_u32 s52, s52, 1
  s_and_b32 s52, s52, 7
  buffer_load_dwordx4 v[216:219], v1, s[8:11], s55 offen offset:0
  v_mfma_f32_32x32x16_bf16 v[120:135], v[20:23], v[136:139], v[120:135]
  ds_read_b64_tr_b16 v[52:53], v9 offset:0
  ds_read_b64_tr_b16 v[54:55], v9 offset:1024
  buffer_load_dwordx4 v[220:223], v1, s[8:11], s55 offen offset:1024
  v_mfma_f32_32x32x16_bf16 v[104:119], v[24:27], v[140:143], v[104:119]
  ds_read_b64_tr_b16 v[56:57], v8 offset:2048
  ds_read_b64_tr_b16 v[58:59], v8 offset:3072
  buffer_load_dwordx4 v[224:227], v1, s[8:11], s55 offen offset:2048
  v_mfma_f32_32x32x16_bf16 v[120:135], v[28:31], v[140:143], v[120:135]
  ds_read_b64_tr_b16 v[60:61], v9 offset:2048
  ds_read_b64_tr_b16 v[62:63], v9 offset:3072
  buffer_load_dwordx4 v[228:231], v1, s[8:11], s55 offen offset:3072
  v_mfma_f32_32x32x16_bf16 v[104:119], v[32:35], v[144:147], v[104:119]
  ds_read_b64_tr_b16 v[64:65], v8 offset:4096
  ds_read_b64_tr_b16 v[66:67], v8 offset:5120
  v_mfma_f32_32x32x16_bf16 v[120:135], v[36:39], v[144:147], v[120:135]
  ds_read_b64_tr_b16 v[68:69], v9 offset:4096
  ds_read_b64_tr_b16 v[70:71], v9 offset:5120
  v_mfma_f32_32x32x16_bf16 v[104:119], v[40:43], v[148:151], v[104:119]
  ds_read_b64_tr_b16 v[72:73], v8 offset:6144
  ds_read_b64_tr_b16 v[74:75], v8 offset:7168
  v_mfma_f32_32x32x16_bf16 v[120:135], v[44:47], v[148:151], v[120:135]
  ds_read_b64_tr_b16 v[76:77], v9 offset:6144
  ds_read_b64_tr_b16 v[78:79], v9 offset:7168
  s_lshl_b32 s3, s53, 13
  s_add_u32 s3, s3, s46
  s_cmp_eq_u32 s53, s47
  s_cselect_b32 s3, 151552, s3
  s_add_u32 s53, s53, 1
  s_and_b32 s53, s53, 7
  v_add_u32 v8, s3, v12
  v_add_u32 v9, s3, v13
  s_waitcnt vmcnt(12) lgkmcnt(0)
  v_mfma_f32_32x32x16_bf16 v[104:119], v[48:51], v[152:155], v[104:119]
  ds_read_b64_tr_b16 v[16:17], v8 offset:0
  ds_read_b64_tr_b16 v[18:19], v8 offset:1024
  s_lshl_b32 s55, s52, 12
  s_add_u32 s55, s55, s44
  s_add_u32 s52, s52, 1
  s_and_b32 s52, s52, 7
  buffer_load_dwordx4 v[232:235], v1, s[8:11], s55 offen offset:0
  v_mfma_f32_32x32x16_bf16 v[120:135], v[52:55], v[152:155], v[120:135]
  ds_read_b64_tr_b16 v[20:21], v9 offset:0
  ds_read_b64_tr_b16 v[22:23], v9 offset:1024
  buffer_load_dwordx4 v[236:239], v1, s[8:11], s55 offen offset:1024
  v_mfma_f32_32x32x16_bf16 v[104:119], v[56:59], v[156:159], v[104:119]
  ds_read_b64_tr_b16 v[24:25], v8 offset:2048
  ds_read_b64_tr_b16 v[26:27], v8 offset:3072
  buffer_load_dwordx4 v[240:243], v1, s[8:11], s55 offen offset:2048
  v_mfma_f32_32x32x16_bf16 v[120:135], v[60:63], v[156:159], v[120:135]
  ds_read_b64_tr_b16 v[28:29], v9 offset:2048
  ds_read_b64_tr_b16 v[30:31], v9 offset:3072
  buffer_load_dwordx4 v[244:247], v1, s[8:11], s55 offen offset:3072
  v_mfma_f32_32x32x16_bf16 v[104:119], v[64:67], v[160:163], v[104:119]
  ds_read_b64_tr_b16 v[32:33], v8 offset:4096
  ds_read_b64_tr_b16 v[34:35], v8 offset:5120
  v_mfma_f32_32x32x16_bf16 v[120:135], v[68:71], v[160:163], v[120:135]
  ds_read_b64_tr_b16 v[36:37], v9 offset:4096
  ds_read_b64_tr_b16 v[38:39], v9 offset:5120
  v_mfma_f32_32x32x16_bf16 v[104:119], v[72:75], v[164:167], v[104:119]
  ds_read_b64_tr_b16 v[40:41], v8 offset:6144
  ds_read_b64_tr_b16 v[42:43], v8 offset:7168
  v_mfma_f32_32x32x16_bf16 v[120:135], v[76:79], v[164:167], v[120:135]
  ds_read_b64_tr_b16 v[44:45], v9 offset:6144
  ds_read_b64_tr_b16 v[46:47], v9 offset:7168
  s_lshl_b32 s3, s53, 13
  s_add_u32 s3, s3, s46
  s_cmp_eq_u32 s53, s47
  s_cselect_b32 s3, 151552, s3
  s_add_u32 s53, s53, 1
  s_and_b32 s53, s53, 7
  v_add_u32 v8, s3, v12
  v_add_u32 v9, s3, v13
  s_waitcnt vmcnt(12) lgkmcnt(0)
  v_mfma_f32_32x32x16_bf16 v[104:119], v[16:19], v[168:171], v[104:119]
  ds_read_b64_tr_b16 v[48:49], v8 offset:0
  ds_read_b64_tr_b16 v[50:51], v8 offset:1024
  s_lshl_b32 s55, s52, 12
  s_add_u32 s55, s55, s44
  s_add_u32 s52, s52, 1
  s_and_b32 s52, s52, 7
  buffer_load_dwordx4 v[136:139], v1, s[8:11], s55 offen offset:0
  v_mfma_f32_32x32x16_bf16 v[120:135], v[20:23], v[168:171], v[120:135]
  ds_read_b64_tr_b16 v[52:53], v9 offset:0
  ds_read_b64_tr_b16 v[54:55], v9 offset:1024
  buffer_load_dwordx4 v[140:143], v1, s[8:11], s55 offen offset:1024
  v_mfma_f32_32x32x16_bf16 v[104:119], v[24:27], v[172:175], v[104:119]
  ds_read_b64_tr_b16 v[56:57], v8 offset:2048
  ds_read_b64_tr_b16 v[58:59], v8 offset:3072
  buffer_load_dwordx4 v[144:147], v1, s[8:11], s55 offen offset:2048
  v_mfma_f32_32x32x16_bf16 v[120:135], v[28:31], v[172:175], v[120:135]
  ds_read_b64_tr_b16 v[60:61], v9 offset:2048
  ds_read_b64_tr_b16 v[62:63], v9 offset:3072
  buffer_load_dwordx4 v[148:151], v1, s[8:11], s55 offen offset:3072
  v_mfma_f32_32x32x16_bf16 v[104:119], v[32:35], v[176:179], v[104:119]
  ds_read_b64_tr_b16 v[64:65], v8 offset:4096
  ds_read_b64_tr_b16 v[66:67], v8 offset:5120
  v_mfma_f32_32x32x16_bf16 v[120:135], v[36:39], v[176:179], v[120:135]
  ds_read_b64_tr_b16 v[68:69], v9 offset:4096
  ds_read_b64_tr_b16 v[70:71], v9 offset:5120
  v_mfma_f32_32x32x16_bf16 v[104:119], v[40:43], v[180:183], v[104:119]
  ds_read_b64_tr_b16 v[72:73], v8 offset:6144
  ds_read_b64_tr_b16 v[74:75], v8 offset:7168
  v_mfma_f32_32x32x16_bf16 v[120:135], v[44:47], v[180:183], v[120:135]
  ds_read_b64_tr_b16 v[76:77], v9 offset:6144
  ds_read_b64_tr_b16 v[78:79], v9 offset:7168
  s_lshl_b32 s3, s53, 13
  s_add_u32 s3, s3, s46
  s_cmp_eq_u32 s53, s47
  s_cselect_b32 s3, 151552, s3
  s_add_u32 s53, s53, 1
  s_and_b32 s53, s53, 7
  v_add_u32 v8, s3, v12
  v_add_u32 v9, s3, v13
  s_waitcnt vmcnt(12) lgkmcnt(0)
  v_mfma_f32_32x32x16_bf16 v[104:119], v[48:51], v[200:203], v[104:119]
  ds_read_b64_tr_b16 v[16:17], v8 offset:0
  ds_read_b64_tr_b16 v[18:19], v8 offset:1024
  s_lshl_b32 s55, s52, 12
  s_add_u32 s55, s55, s44
  s_add_u32 s52, s52, 1
  s_and_b32 s52, s52, 7
  buffer_load_dwordx4 v[152:155], v1, s[8:11], s55 offen offset:0
  v_mfma_f32_32x32x16_bf16 v[120:135], v[52:55], v[200:203], v[120:135]
  ds_read_b64_tr_b16 v[20:21], v9 offset:0
  ds_read_b64_tr_b16 v[22:23], v9 offset:1024
  buffer_load_dwordx4 v[156:159], v1, s[8:11], s55 offen offset:1024
  v_mfma_f32_32x32x16_bf16 v[104:119], v[56:59], v[204:207], v[104:119]
  ds_read_b64_tr_b16 v[24:25], v8 offset:2048
  ds_read_b64_tr_b16 v[26:27], v8 offset:3072
  buffer_load_dwordx4 v[160:163], v1, s[8:11], s55 offen offset:2048
  v_mfma_f32_32x32x16_bf16 v[120:135], v[60:63], v[204:207], v[120:135]
  ds_read_b64_tr_b16 v[28:29], v9 offset:2048
  ds_read_b64_tr_b16 v[30:31], v9 offset:3072
  buffer_load_dwordx4 v[164:167], v1, s[8:11], s55 offen offset:3072
  v_mfma_f32_32x32x16_bf16 v[104:119], v[64:67], v[208:211], v[104:119]
  ds_read_b64_tr_b16 v[32:33], v8 offset:4096
  ds_read_b64_tr_b16 v[34:35], v8 offset:5120
  v_mfma_f32_32x32x16_bf16 v[120:135], v[68:71], v[208:211], v[120:135]
  ds_read_b64_tr_b16 v[36:37], v9 offset:4096
  ds_read_b64_tr_b16 v[38:39], v9 offset:5120
  v_mfma_f32_32x32x16_bf16 v[104:119], v[72:75], v[212:215], v[104:119]
  ds_read_b64_tr_b16 v[40:41], v8 offset:6144
  ds_read_b64_tr_b16 v[42:43], v8 offset:7168
  v_mfma_f32_32x32x16_bf16 v[120:135], v[76:79], v[212:215], v[120:135]
  ds_read_b64_tr_b16 v[44:45], v9 offset:6144
  ds_read_b64_tr_b16 v[46:47], v9 offset:7168
  s_lshl_b32 s3, s53, 13
  s_add_u32 s3, s3, s46
  s_cmp_eq_u32 s53, s47
  s_cselect_b32 s3, 151552, s3
  s_add_u32 s53, s53, 1
  s_and_b32 s53, s53, 7
  v_add_u32 v8, s3, v12
  v_add_u32 v9, s3, v13
  s_waitcnt vmcnt(12) lgkmcnt(0)
  v_mfma_f32_32x32x16_bf16 v[104:119], v[16:19], v[216:219], v[104:119]
  ds_read_b64_tr_b16 v[48:49], v8 offset:0
  ds_read_b64_tr_b16 v[50:51], v8 offset:1024
  v_mfma_f32_32x32x16_bf16 v[120:135], v[20:23], v[216:219], v[120:135]
  ds_read_b64_tr_b16 v[52:53], v9 offset:0
  ds_read_b64_tr_b16 v[54:55], v9 offset:1024
  v_mfma_f32_32x32x16_bf16 v[104:119], v[24:27], v[220:223], v[104:119]
  ds_read_b64_tr_b16 v[56:57], v8 offset:2048
  ds_read_b64_tr_b16 v[58:59], v8 offset:3072
  v_mfma_f32_32x32x16_bf16 v[120:135], v[28:31], v[220:223], v[120:135]
  ds_read_b64_tr_b16 v[60:61], v9 offset:2048
  ds_read_b64_tr_b16 v[62:63], v9 offset:3072
  v_mfma_f32_32x32x16_bf16 v[104:119], v[32:35], v[224:227], v[104:119]
  ds_read_b64_tr_b16 v[64:65], v8 offset:4096
  ds_read_b64_tr_b16 v[66:67], v8 offset:5120
  v_mfma_f32_32x32x16_bf16 v[120:135], v[36:39], v[224:227], v[120:135]
  ds_read_b64_tr_b16 v[68:69], v9 offset:4096
  ds_read_b64_tr_b16 v[70:71], v9 offset:5120
  v_mfma_f32_32x32x16_bf16 v[104:119], v[40:43], v[228:231], v[104:119]
  ds_read_b64_tr_b16 v[72:73], v8 offset:6144
  ds_read_b64_tr_b16 v[74:75], v8 offset:7168
  v_mfma_f32_32x32x16_bf16 v[120:135], v[44:47], v[228:231], v[120:135]
  ds_read_b64_tr_b16 v[76:77], v9 offset:6144
  ds_read_b64_tr_b16 v[78:79], v9 offset:7168
  s_lshl_b32 s3, s53, 13
  s_add_u32 s3, s3, s46
  s_cmp_eq_u32 s53, s47
  s_cselect_b32 s3, 151552, s3
  s_add_u32 s53, s53, 1
  s_and_b32 s53, s53, 7
  v_add_u32 v8, s3, v12
  v_add_u32 v9, s3, v13
  s_waitcnt vmcnt(8) lgkmcnt(0)
  v_mfma_f32_32x32x16_bf16 v[104:119], v[48:51], v[232:235], v[104:119]
  ds_read_b64_tr_b16 v[16:17], v8 offset:0
  ds_read_b64_tr_b16 v[18:19], v8 offset:1024
  v_mfma_f32_32x32x16_bf16 v[120:135], v[52:55], v[232:235], v[120:135]
  ds_read_b64_tr_b16 v[20:21], v9 offset:0
  ds_read_b64_tr_b16 v[22:23], v9 offset:1024
  v_mfma_f32_32x32x16_bf16 v[104:119], v[56:59], v[236:239], v[104:119]
  ds_read_b64_tr_b16 v[24:25], v8 offset:2048
  ds_read_b64_tr_b16 v[26:27], v8 offset:3072
  v_mfma_f32_32x32x16_bf16 v[120:135], v[60:63], v[236:239], v[120:135]
  ds_read_b64_tr_b16 v[28:29], v9 offset:2048
  ds_read_b64_tr_b16 v[30:31], v9 offset:3072
  v_mfma_f32_32x32x16_bf16 v[104:119], v[64:67], v[240:243], v[104:119]
  ds_read_b64_tr_b16 v[32:33], v8 offset:4096
  ds_read_b64_tr_b16 v[34:35], v8 offset:5120
  v_mfma_f32_32x32x16_bf16 v[120:135], v[68:71], v[240:243], v[120:135]
  ds_read_b64_tr_b16 v[36:37], v9 offset:4096
  ds_read_b64_tr_b16 v[38:39], v9 offset:5120
  v_mfma_f32_32x32x16_bf16 v[104:119], v[72:75], v[244:247], v[104:119]
  ds_read_b64_tr_b16 v[40:41], v8 offset:6144
  ds_read_b64_tr_b16 v[42:43], v8 offset:7168
  v_mfma_f32_32x32x16_bf16 v[120:135], v[76:79], v[244:247], v[120:135]
  ds_read_b64_tr_b16 v[44:45], v9 offset:6144
  ds_read_b64_tr_b16 v[46:47], v9 offset:7168
  s_lshl_b32 s3, s53, 13
  s_add_u32 s3, s3, s46
  s_cmp_eq_u32 s53, s47
  s_cselect_b32 s3, 151552, s3
  s_add_u32 s53, s53, 1
  s_and_b32 s53, s53, 7
  v_add_u32 v8, s3, v12
  v_add_u32 v9, s3, v13
  s_waitcnt vmcnt(4) lgkmcnt(0)
  v_mfma_f32_32x32x16_bf16 v[104:119], v[16:19], v[136:139], v[104:119]
  ds_read_b64_tr_b16 v[48:49], v8 offset:0
  ds_read_b64_tr_b16 v[50:51], v8 offset:1024
  v_mfma_f32_32x32x16_bf16 v[120:135], v[20:23], v[136:139], v[120:135]
  ds_read_b64_tr_b16 v[52:53], v9 offset:0
  ds_read_b64_tr_b16 v[54:55], v9 offset:1024
  v_mfma_f32_32x32x16_bf16 v[104:119], v[24:27], v[140:143], v[104:119]
  ds_read_b64_tr_b16 v[56:57], v8 offset:2048
  ds_read_b64_tr_b16 v[58:59], v8 offset:3072
  v_mfma_f32_32x32x16_bf16 v[120:135], v[28:31], v[140:143], v[120:135]
  ds_read_b64_tr_b16 v[60:61], v9 offset:2048
  ds_read_b64_tr_b16 v[62:63], v9 offset:3072
  v_mfma_f32_32x32x16_bf16 v[104:119], v[32:35], v[144:147], v[104:119]
  ds_read_b64_tr_b16 v[64:65], v8 offset:4096
  ds_read_b64_tr_b16 v[66:67], v8 offset:5120
  v_mfma_f32_32x32x16_bf16 v[120:135], v[36:39], v[144:147], v[120:135]
  ds_read_b64_tr_b16 v[68:69], v9 offset:4096
  ds_read_b64_tr_b16 v[70:71], v9 offset:5120
  v_mfma_f32_32x32x16_bf16 v[104:119], v[40:43], v[148:151], v[104:119]
  ds_read_b64_tr_b16 v[72:73], v8 offset:6144
  ds_read_b64_tr_b16 v[74:75], v8 offset:7168
  v_mfma_f32_32x32x16_bf16 v[120:135], v[44:47], v[148:151], v[120:135]
  ds_read_b64_tr_b16 v[76:77], v9 offset:6144
  ds_read_b64_tr_b16 v[78:79], v9 offset:7168
  s_waitcnt vmcnt(0) lgkmcnt(0)
  v_mfma_f32_32x32x16_bf16 v[104:119], v[48:51], v[152:155], v[104:119]
  v_mfma_f32_32x32x16_bf16 v[120:135], v[52:55], v[152:155], v[120:135]
  v_mfma_f32_32x32x16_bf16 v[104:119], v[56:59], v[156:159], v[104:119]
  v_mfma_f32_32x32x16_bf16 v[120:135], v[60:63], v[156:159], v[120:135]
  v_mfma_f32_32x32x16_bf16 v[104:119], v[64:67], v[160:163], v[104:119]
  v_mfma_f32_32x32x16_bf16 v[120:135], v[68:71], v[160:163], v[120:135]
  v_mfma_f32_32x32x16_bf16 v[104:119], v[72:75], v[164:167], v[104:119]
  v_mfma_f32_32x32x16_bf16 v[120:135], v[76:79], v[164:167], v[120:135]
  s_branch L_k2_f1
L_k2_p2d:
  s_lshl_b32 s3, s53, 13
  s_add_u32 s3, s3, s46
  s_cmp_eq_u32 s53, s47
  s_cselect_b32 s3, 151552, s3
  s_add_u32 s53, s53, 1
  s_and_b32 s53, s53, 7
  v_add_u32 v8, s3, v12
  v_add_u32 v9, s3, v13
  s_waitcnt vmcnt(12) lgkmcnt(0)
  v_mfma_f32_32x32x16_bf16 v[104:119], v[16:19], v[136:139], v[104:119]
  ds_read_b64_tr_b16 v[48:49], v8 offset:0
  ds_read_b64_tr_b16 v[50:51], v8 offset:1024
  s_lshl_b32 s55, s52, 12
  s_add_u32 s55, s55, s44
  s_add_u32 s52, s52, 1
  s_and_b32 s52, s52, 7
  buffer_load_dwordx4 v[216:219], v1, s[8:11], s55 offen offset:0
  v_mfma_f32_32x32x16_bf16 v[120:135], v[20:23], v[136:139], v[120:135]
  ds_read_b64_tr_b16 v[52:53], v9 offset:0
  ds_read_b64_tr_b16 v[54:55], v9 offset:1024
  buffer_load_dwordx4 v[220:223], v1, s[8:11], s55 offen offset:1024
  v_mfma_f32_32x32x16_bf16 v[104:119], v[24:27], v[140:143], v[104:119]
  ds_read_b64_tr_b16 v[56:57], v8 offset:2048
  ds_read_b64_tr_b16 v[58:59], v8 offset:3072
  buffer_load_dwordx4 v[224:227], v1, s[8:11], s55 offen offset:2048
  v_mfma_f32_32x32x16_bf16 v[120:135], v[28:31], v[140:143], v[120:135]
  ds_read_b64_tr_b16 v[60:61], v9 offset:2048
  ds_read_b64_tr_b16 v[62:63], v9 offset:3072
  buffer_load_dwordx4 v[228:231], v1, s[8:11], s55 offen offset:3072
  v_mfma_f32_32x32x16_bf16 v[104:119], v[32:35], v[144:147], v[104:119]
  ds_read_b64_tr_b16 v[64:65], v8 offset:4096
  ds_read_b64_tr_b16 v[66:67], v8 offset:5120
  v_mfma_f32_32x32x16_bf16 v[120:135], v[36:39], v[144:147], v[120:135]
  ds_read_b64_tr_b16 v[68:69], v9 offset:4096
  ds_read_b64_tr_b16 v[70:71], v9 offset:5120
  v_mfma_f32_32x32x16_bf16 v[104:119], v[40:43], v[148:151], v[104:119]
  ds_read_b64_tr_b16 v[72:73], v8 offset:6144
  ds_read_b64_tr_b16 v[74:75], v8 offset:7168
  v_mfma_f32_32x32x16_bf16 v[120:135], v[44:47], v[148:151], v[120:135]
  ds_read_b64_tr_b16 v[76:77], v9 offset:6144
  ds_read_b64_tr_b16 v[78:79], v9 offset:7168
  s_lshl_b32 s3, s53, 13
  s_add_u32 s3, s3, s46
  s_cmp_eq_u32 s53, s47
  s_cselect_b32 s3, 151552, s3
  s_add_u32 s53, s53, 1
  s_and_b32 s53, s53, 7
  v_add_u32 v8, s3, v12
  v_add_u32 v9, s3, v13
  s_waitcnt vmcnt(12) lgkmcnt(0)
  v_mfma_f32_32x32x16_bf16 v[104:119], v[48:51], v[152:155], v[104:119]
  ds_read_b64_tr_b16 v[16:17], v8 offset:0
  ds_read_b64_tr_b16 v[18:19], v8 offset:1024
  s_lshl_b32 s55, s52, 12
  s_add_u32 s55, s55, s44
  s_add_u32 s52, s52, 1
  s_and_b32 s52, s52, 7
  buffer_load_dwordx4 v[232:235], v1, s[8:11], s55 offen offset:0
  v_mfma_f32_32x32x16_bf16 v[120:135], v[52:55], v[152:155], v[120:135]
  ds_read_b64_tr_b16 v[20:21], v9 offset:0
  ds_read_b64_tr_b16 v[22:23], v9 offset:1024
  buffer_load_dwordx4 v[236:239], v1, s[8:11], s55 offen offset:1024
  v_mfma_f32_32x32x16_bf16 v[104:119], v[56:59], v[156:159], v[104:119]
  ds_read_b64_tr_b16 v[24:25], v8 offset:2048
  ds_read_b64_tr_b16 v[26:27], v8 offset:3072
  buffer_load_dwordx4 v[240:243], v1, s[8:11], s55 offen offset:2048
  v_mfma_f32_32x32x16_bf16 v[120:135], v[60:63], v[156:159], v[120:135]
  ds_read_b64_tr_b16 v[28:29], v9 offset:2048
  ds_read_b64_tr_b16 v[30:31], v9 offset:3072
  buffer_load_dwordx4 v[244:247], v1, s[8:11], s55 offen offset:3072
  v_mfma_f32_32x32x16_bf16 v[104:119], v[64:67], v[160:163], v[104:119]
  ds_read_b64_tr_b16 v[32:33], v8 offset:4096
  ds_read_b64_tr_b16 v[34:35], v8 offset:5120
  v_mfma_f32_32x32x16_bf16 v[120:135], v[68:71], v[160:163], v[120:135]
  ds_read_b64_tr_b16 v[36:37], v9 offset:4096
  ds_read_b64_tr_b16 v[38:39], v9 offset:5120
  v_mfma_f32_32x32x16_bf16 v[104:119], v[72:75], v[164:167], v[104:119]
  ds_read_b64_tr_b16 v[40:41], v8 offset:6144
  ds_read_b64_tr_b16 v[42:43], v8 offset:7168
  v_mfma_f32_32x32x16_bf16 v[120:135], v[76:79], v[164:167], v[120:135]
  ds_read_b64_tr_b16 v[44:45], v9 offset:6144
  ds_read_b64_tr_b16 v[46:47], v9 offset:7168
  s_lshl_b32 s3, s53, 13
  s_add_u32 s3, s3, s46
  s_cmp_eq_u32 s53, s47
  s_cselect_b32 s3, 151552, s3
  s_add_u32 s53, s53, 1
  s_and_b32 s53, s53, 7
  v_add_u32 v8, s3, v12
  v_add_u32 v9, s3, v13
  s_waitcnt vmcnt(12) lgkmcnt(0)
  v_mfma_f32_32x32x16_bf16 v[104:119], v[16:19], v[168:171], v[104:119]
  ds_read_b64_tr_b16 v[48:49], v8 offset:0
  ds_read_b64_tr_b16 v[50:51], v8 offset:1024
  s_lshl_b32 s55, s52, 12
  s_add_u32 s55, s55, s44
  s_add_u32 s52, s52, 1
  s_and_b32 s52, s52, 7
  buffer_load_dwordx4 v[136:139], v1, s[8:11], s55 offen offset:0
  v_mfma_f32_32x32x16_bf16 v[120:135], v[20:23], v[168:171], v[120:135]
  ds_read_b64_tr_b16 v[52:53], v9 offset:0
  ds_read_b64_tr_b16 v[54:55], v9 offset:1024
  buffer_load_dwordx4 v[140:143], v1, s[8:11], s55 offen offset:1024
  v_mfma_f32_32x32x16_bf16 v[104:119], v[24:27], v[172:175], v[104:119]
  ds_read_b64_tr_b16 v[56:57], v8 offset:2048
  ds_read_b64_tr_b16 v[58:59], v8 offset:3072
  buffer_load_dwordx4 v[144:147], v1, s[8:11], s55 offen offset:2048
  v_mfma_f32_32x32x16_bf16 v[120:135], v[28:31], v[172:175], v[120:135]
  ds_read_b64_tr_b16 v[60:61], v9 offset:2048
  ds_read_b64_tr_b16 v[62:63], v9 offset:3072
  buffer_load_dwordx4 v[148:151], v1, s[8:11], s55 offen offset:3072
  v_mfma_f32_32x32x16_bf16 v[104:119], v[32:35], v[176:179], v[104:119]
  ds_read_b64_tr_b16 v[64:65], v8 offset:4096
  ds_read_b64_tr_b16 v[66:67], v8 offset:5120
  buffer_load_dword v7, off, s[8:11], s59 sc1
  v_mfma_f32_32x32x16_bf16 v[120:135], v[36:39], v[176:179], v[120:135]
  ds_read_b64_tr_b16 v[68:69], v9 offset:4096
  ds_read_b64_tr_b16 v[70:71], v9 offset:5120
  v_mfma_f32_32x32x16_bf16 v[104:119], v[40:43], v[180:183], v[104:119]
  ds_read_b64_tr_b16 v[72:73], v8 offset:6144
  ds_read_b64_tr_b16 v[74:75], v8 offset:7168
  v_mfma_f32_32x32x16_bf16 v[120:135], v[44:47], v[180:183], v[120:135]
  ds_read_b64_tr_b16 v[76:77], v9 offset:6144
  ds_read_b64_tr_b16 v[78:79], v9 offset:7168
  s_lshl_b32 s3, s53, 13
  s_add_u32 s3, s3, s46
  s_cmp_eq_u32 s53, s47
  s_cselect_b32 s3, 151552, s3
  s_add_u32 s53, s53, 1
  s_and_b32 s53, s53, 7
  v_add_u32 v8, s3, v12
  v_add_u32 v9, s3, v13
  s_waitcnt vmcnt(13) lgkmcnt(0)
  v_mfma_f32_32x32x16_bf16 v[104:119], v[48:51], v[200:203], v[104:119]
  ds_read_b64_tr_b16 v[16:17], v8 offset:0
  ds_read_b64_tr_b16 v[18:19], v8 offset:1024
  s_lshl_b32 s55, s52, 12
  s_add_u32 s55, s55, s44
  s_add_u32 s52, s52, 1
  s_and_b32 s52, s52, 7
  buffer_load_dwordx4 v[152:155], v1, s[8:11], s55 offen offset:0
  v_mfma_f32_32x32x16_bf16 v[120:135], v[52:55], v[200:203], v[120:135]
  ds_read_b64_tr_b16 v[20:21], v9 offset:0
  ds_read_b64_tr_b16 v[22:23], v9 offset:1024
  buffer_load_dwordx4 v[156:159], v1, s[8:11], s55 offen offset:1024
  v_mfma_f32_32x32x16_bf16 v[104:119], v[56:59], v[204:207], v[104:119]
  ds_read_b64_tr_b16 v[24:25], v8 offset:2048
  ds_read_b64_tr_b16 v[26:27], v8 offset:3072
  buffer_load_dwordx4 v[160:163], v1, s[8:11], s55 offen offset:2048
  v_mfma_f32_32x32x16_bf16 v[120:135], v[60:63], v[204:207], v[120:135]
  ds_read_b64_tr_b16 v[28:29], v9 offset:2048
  ds_read_b64_tr_b16 v[30:31], v9 offset:3072
  buffer_load_dwordx4 v[164:167], v1, s[8:11], s55 offen offset:3072
  v_mfma_f32_32x32x16_bf16 v[104:119], v[64:67], v[208:211], v[104:119]
  ds_read_b64_tr_b16 v[32:33], v8 offset:4096
  ds_read_b64_tr_b16 v[34:35], v8 offset:5120
  v_mfma_f32_32x32x16_bf16 v[120:135], v[68:71], v[208:211], v[120:135]
  ds_read_b64_tr_b16 v[36:37], v9 offset:4096
  ds_read_b64_tr_b16 v[38:39], v9 offset:5120
  v_mfma_f32_32x32x16_bf16 v[104:119], v[72:75], v[212:215], v[104:119]
  ds_read_b64_tr_b16 v[40:41], v8 offset:6144
  ds_read_b64_tr_b16 v[42:43], v8 offset:7168
  v_mfma_f32_32x32x16_bf16 v[120:135], v[76:79], v[212:215], v[120:135]
  ds_read_b64_tr_b16 v[44:45], v9 offset:6144
  ds_read_b64_tr_b16 v[46:47], v9 offset:7168
  s_lshl_b32 s3, s53, 13
  s_add_u32 s3, s3, s46
  s_cmp_eq_u32 s53, s47
  s_cselect_b32 s3, 151552, s3
  s_add_u32 s53, s53, 1
  s_and_b32 s53, s53, 7
  v_add_u32 v8, s3, v12
  v_add_u32 v9, s3, v13
  s_waitcnt vmcnt(13) lgkmcnt(0)
  v_mfma_f32_32x32x16_bf16 v[104:119], v[16:19], v[216:219], v[104:119]
  ds_read_b64_tr_b16 v[48:49], v8 offset:0
  ds_read_b64_tr_b16 v[50:51], v8 offset:1024
  v_mfma_f32_32x32x16_bf16 v[120:135], v[20:23], v[216:219], v[120:135]
  ds_read_b64_tr_b16 v[52:53], v9 offset:0
  ds_read_b64_tr_b16 v[54:55], v9 offset:1024
  v_mfma_f32_32x32x16_bf16 v[104:119], v[24:27], v[220:223], v[104:119]
  ds_read_b64_tr_b16 v[56:57], v8 offset:2048
  ds_read_b64_tr_b16 v[58:59], v8 offset:3072
  v_mfma_f32_32x32x16_bf16 v[120:135], v[28:31], v[220:223], v[120:135]
  ds_read_b64_tr_b16 v[60:61], v9 offset:2048
  ds_read_b64_tr_b16 v[62:63], v9 offset:3072
  v_mfma_f32_32x32x16_bf16 v[104:119], v[32:35], v[224:227], v[104:119]
  ds_read_b64_tr_b16 v[64:65], v8 offset:4096
  ds_read_b64_tr_b16 v[66:67], v8 offset:5120
  v_mfma_f32_32x32x16_bf16 v[120:135], v[36:39], v[224:227], v[120:135]
  ds_read_b64_tr_b16 v[68:69], v9 offset:4096
  ds_read_b64_tr_b16 v[70:71], v9 offset:5120
  v_mfma_f32_32x32x16_bf16 v[104:119], v[40:43], v[228:231], v[104:119]
  ds_read_b64_tr_b16 v[72:73], v8 offset:6144
  ds_read_b64_tr_b16 v[74:75], v8 offset:7168
  v_mfma_f32_32x32x16_bf16 v[120:135], v[44:47], v[228:231], v[120:135]
  ds_read_b64_tr_b16 v[76:77], v9 offset:6144
  ds_read_b64_tr_b16 v[78:79], v9 offset:7168
  s_lshl_b32 s3, s53, 13
  s_add_u32 s3, s3, s46
  s_cmp_eq_u32 s53, s47
  s_cselect_b32 s3, 151552, s3
  s_add_u32 s53, s53, 1
  s_and_b32 s53, s53, 7
  v_add_u32 v8, s3, v12
  v_add_u32 v9, s3, v13
  s_waitcnt vmcnt(9) lgkmcnt(0)
  v_mfma_f32_32x32x16_bf16 v[104:119], v[48:51], v[232:235], v[104:119]
  ds_read_b64_tr_b16 v[16:17], v8 offset:0
  ds_read_b64_tr_b16 v[18:19], v8 offset:1024
  v_mfma_f32_32x32x16_bf16 v[120:135], v[52:55], v[232:235], v[120:135]
  ds_read_b64_tr_b16 v[20:21], v9 offset:0
  ds_read_b64_tr_b16 v[22:23], v9 offset:1024
  v_mfma_f32_32x32x16_bf16 v[104:119], v[56:59], v[236:239], v[104:119]
  ds_read_b64_tr_b16 v[24:25], v8 offset:2048
  ds_read_b64_tr_b16 v[26:27], v8 offset:3072
  v_mfma_f32_32x32x16_bf16 v[120:135], v[60:63], v[236:239], v[120:135]
  ds_read_b64_tr_b16 v[28:29], v9 offset:2048
  ds_read_b64_tr_b16 v[30:31], v9 offset:3072
  v_mfma_f32_32x32x16_bf16 v[104:119], v[64:67], v[240:243], v[104:119]
  ds_read_b64_tr_b16 v[32:33], v8 offset:4096
  ds_read_b64_tr_b16 v[34:35], v8 offset:5120
  v_mfma_f32_32x32x16_bf16 v[120:135], v[68:71], v[240:243], v[120:135]
  ds_read_b64_tr_b16 v[36:37], v9 offset:4096
  ds_read_b64_tr_b16 v[38:39], v9 offset:5120
  v_mfma_f32_32x32x16_bf16 v[104:119], v[72:75], v[244:247], v[104:119]
  ds_read_b64_tr_b16 v[40:41], v8 offset:6144
  ds_read_b64_tr_b16 v[42:43], v8 offset:7168
  v_mfma_f32_32x32x16_bf16 v[120:135], v[76:79], v[244:247], v[120:135]
  ds_read_b64_tr_b16 v[44:45], v9 offset:6144
  ds_read_b64_tr_b16 v[46:47], v9 offset:7168
  s_lshl_b32 s3, s53, 13
  s_add_u32 s3, s3, s46
  s_cmp_eq_u32 s53, s47
  s_cselect_b32 s3, 151552, s3
  s_add_u32 s53, s53, 1
  s_and_b32 s53, s53, 7
  v_add_u32 v8, s3, v12
  v_add_u32 v9, s3, v13
  s_waitcnt vmcnt(4) lgkmcnt(0)
  s_cmp_lg_u32 s61, 0
  s_cbranch_scc1 L_k2_yok
  s_mov_b32 s62, 256
L_k2_ypoll:
  v_readfirstlane_b32 s3, v7
  s_cmp_eq_u32 s3, 1
  s_cbranch_scc1 L_k2_yok
  buffer_load_dword v7, off, s[8:11], s59 sc1
  s_waitcnt vmcnt(0)
  s_sub_u32 s62, s62, 1
  s_cmp_lg_u32 s62, 0
  s_cbranch_scc1 L_k2_ypoll
  v_mov_b32 v7, 1
  ds_write_b32 v6, v7 offset:20
  s_branch L_k2_f1
L_k2_yok:
  buffer_load_dwordx4 v[80:83], v1, s[8:11], s48 offen offset:0
  buffer_load_dwordx4 v[84:87], v1, s[8:11], s48 offen offset:1024
  buffer_load_dwordx4 v[88:91], v1, s[8:11], s48 offen offset:2048
  buffer_load_dwordx4 v[92:95], v1, s[8:11], s48 offen offset:3072
  v_mfma_f32_32x32x16_bf16 v[104:119], v[16:19], v[136:139], v[104:119]
  ds_read_b64_tr_b16 v[48:49], v8 offset:0
  ds_read_b64_tr_b16 v[50:51], v8 offset:1024
  v_mfma_f32_32x32x16_bf16 v[120:135], v[20:23], v[136:139], v[120:135]
  ds_read_b64_tr_b16 v[52:53], v9 offset:0
  ds_read_b64_tr_b16 v[54:55], v9 offset:1024
  v_mfma_f32_32x32x16_bf16 v[104:119], v[24:27], v[140:143], v[104:119]
  ds_read_b64_tr_b16 v[56:57], v8 offset:2048
  ds_read_b64_tr_b16 v[58:59], v8 offset:3072
  v_mfma_f32_32x32x16_bf16 v[120:135], v[28:31], v[140:143], v[120:135]
  ds_read_b64_tr_b16 v[60:61], v9 offset:2048
  ds_read_b64_tr_b16 v[62:63], v9 offset:3072
  v_mfma_f32_32x32x16_bf16 v[104:119], v[32:35], v[144:147], v[104:119]
  ds_read_b64_tr_b16 v[64:65], v8 offset:4096
  ds_read_b64_tr_b16 v[66:67], v8 offset:5120
  v_mfma_f32_32x32x16_bf16 v[120:135], v[36:39], v[144:147], v[120:135]
  ds_read_b64_tr_b16 v[68:69], v9 offset:4096
  ds_read_b64_tr_b16 v[70:71], v9 offset:5120
  v_mfma_f32_32x32x16_bf16 v[104:119], v[40:43], v[148:151], v[104:119]
  ds_read_b64_tr_b16 v[72:73], v8 offset:6144
  ds_read_b64_tr_b16 v[74:75], v8 offset:7168
  v_mfma_f32_32x32x16_bf16 v[120:135], v[44:47], v[148:151], v[120:135]
  ds_read_b64_tr_b16 v[76:77], v9 offset:6144
  ds_read_b64_tr_b16 v[78:79], v9 offset:7168
  s_waitcnt vmcnt(4) lgkmcnt(0)
  v_mfma_f32_32x32x16_bf16 v[104:119], v[48:51], v[152:155], v[104:119]
  v_mfma_f32_32x32x16_bf16 v[120:135], v[52:55], v[152:155], v[120:135]
  v_mfma_f32_32x32x16_bf16 v[104:119], v[56:59], v[156:159], v[104:119]
  v_mfma_f32_32x32x16_bf16 v[120:135], v[60:63], v[156:159], v[120:135]
  v_mfma_f32_32x32x16_bf16 v[104:119], v[64:67], v[160:163], v[104:119]
  v_mfma_f32_32x32x16_bf16 v[120:135], v[68:71], v[160:163], v[120:135]
  v_mfma_f32_32x32x16_bf16 v[104:119], v[72:75], v[164:167], v[104:119]
  v_mfma_f32_32x32x16_bf16 v[120:135], v[76:79], v[164:167], v[120:135]
  s_nop 7
  s_waitcnt vmcnt(0)
  s_nop 7
  v_lshlrev_b32 v4, 16, v80
  v_and_b32 v5, s50, v80
  v_add_f32 v120, v120, v4
  v_add_f32 v121, v121, v5
  v_lshlrev_b32 v4, 16, v81
  v_and_b32 v5, s50, v81
  v_add_f32 v122, v122, v4
  v_add_f32 v123, v123, v5
  v_lshlrev_b32 v4, 16, v82
  v_and_b32 v5, s50, v82
  v_add_f32 v124, v124, v4
  v_add_f32 v125, v125, v5
  v_lshlrev_b32 v4, 16, v83
  v_and_b32 v5, s50, v83
  v_add_f32 v126, v126, v4
  v_add_f32 v127, v127, v5
  v_lshlrev_b32 v4, 16, v84
  v_and_b32 v5, s50, v84
  v_add_f32 v128, v128, v4
  v_add_f32 v129, v129, v5
  v_lshlrev_b32 v4, 16, v85
  v_and_b32 v5, s50, v85
  v_add_f32 v130, v130, v4
  v_add_f32 v131, v131, v5
  v_lshlrev_b32 v4, 16, v86
  v_and_b32 v5, s50, v86
  v_add_f32 v132, v132, v4
  v_add_f32 v133, v133, v5
  v_lshlrev_b32 v4, 16, v87
  v_and_b32 v5, s50, v87
  v_add_f32 v134, v134, v4
  v_add_f32 v135, v135, v5
  v_lshlrev_b32 v4, 16, v88
  v_and_b32 v5, s50, v88
  v_add_f32 v104, v104, v4
  v_add_f32 v105, v105, v5
  v_lshlrev_b32 v4, 16, v89
  v_and_b32 v5, s50, v89
  v_add_f32 v106, v106, v4
  v_add_f32 v107, v107, v5
  v_lshlrev_b32 v4, 16, v90
  v_and_b32 v5, s50, v90
  v_add_f32 v108, v108, v4
  v_add_f32 v109, v109, v5
  v_lshlrev_b32 v4, 16, v91
  v_and_b32 v5, s50, v91
  v_add_f32 v110, v110, v4
  v_add_f32 v111, v111, v5
  v_lshlrev_b32 v4, 16, v92
  v_and_b32 v5, s50, v92
  v_add_f32 v112, v112, v4
  v_add_f32 v113, v113, v5
  v_lshlrev_b32 v4, 16, v93
  v_and_b32 v5, s50, v93
  v_add_f32 v114, v114, v4
  v_add_f32 v115, v115, v5
  v_lshlrev_b32 v4, 16, v94
  v_and_b32 v5, s50, v94
  v_add_f32 v116, v116, v4
  v_add_f32 v117, v117, v5
  v_lshlrev_b32 v4, 16, v95
  v_and_b32 v5, s50, v95
  v_add_f32 v118, v118, v4
  v_add_f32 v119, v119, v5
L_k2_f1:
  s_nop 7
  s_waitcnt lgkmcnt(0)
  s_nop 7
  s_barrier
  ds_read_b64 v[10:11], v6 offset:16
  ds_write_b128 v14, v[120:123] offset:0
  ds_write_b128 v14, v[124:127] offset:1024
  ds_write_b128 v14, v[128:131] offset:2048
  ds_write_b128 v14, v[132:135] offset:3072
  s_waitcnt lgkmcnt(0)
  s_barrier
  ds_read_b128 v[16:19], v15 offset:0
  ds_read_b128 v[20:23], v15 offset:1024
  ds_read_b128 v[24:27], v15 offset:2048
  ds_read_b128 v[28:31], v15 offset:3072
  v_readfirstlane_b32 s3, v10
  v_readfirstlane_b32 s62, v11
  s_lshl_b32 s62, s62, 1
  s_or_b32 s3, s3, s62
  s_cmp_lg_u32 s3, 1
  s_cbranch_scc1 L_k2_next
  s_waitcnt lgkmcnt(3)
  v_add_f32 v104, v104, v16
  v_add_f32 v105, v105, v17
  v_add_f32 v106, v106, v18
  v_add_f32 v107, v107, v19
  s_waitcnt lgkmcnt(2)
  v_add_f32 v108, v108, v20
  v_add_f32 v109, v109, v21
  v_add_f32 v110, v110, v22
  v_add_f32 v111, v111, v23
  s_nop 1
  v_permlane32_swap_b32 v104, v108
  v_permlane32_swap_b32 v105, v109
  v_permlane32_swap_b32 v106, v110
  v_permlane32_swap_b32 v107, v111
  s_nop 1
  v_cvt_pk_bf16_f32 v80, v104, v105
  v_cvt_pk_bf16_f32 v81, v106, v107
  v_cvt_pk_bf16_f32 v82, v108, v109
  v_cvt_pk_bf16_f32 v83, v110, v111
  buffer_store_dwordx4 v[80:83], v248, s[28:31], s63 offen offset:0
  s_waitcnt lgkmcnt(1)
  v_add_f32 v112, v112, v24
  v_add_f32 v113, v113, v25
  v_add_f32 v114, v114, v26
  v_add_f32 v115, v115, v27
  s_waitcnt lgkmcnt(0)
  v_add_f32 v116, v116, v28
  v_add_f32 v117, v117, v29
  v_add_f32 v118, v118, v30
  v_add_f32 v119, v119, v31
  s_nop 1
  v_permlane32_swap_b32 v112, v116
  v_permlane32_swap_b32 v113, v117
  v_permlane32_swap_b32 v114, v118
  v_permlane32_swap_b32 v115, v119
  s_nop 1
  v_cvt_pk_bf16_f32 v84, v112, v113
  v_cvt_pk_bf16_f32 v85, v114, v115
  v_cvt_pk_bf16_f32 v86, v116, v117
  v_cvt_pk_bf16_f32 v87, v118, v119
  buffer_store_dwordx4 v[84:87], v248, s[28:31], s63 offen offset:32
L_k2_end:
  s_endpgm
.section .rodata,"a"
.p2align 6
.amdhsa_kernel k2_attn_kernel
  .amdhsa_next_free_vgpr 256
  .amdhsa_next_free_sgpr 102
  .amdhsa_accum_offset 256
  .amdhsa_group_segment_fixed_size 0
  .amdhsa_kernarg_size 80
  .amdhsa_user_sgpr_count 2
  .amdhsa_user_sgpr_kernarg_segment_ptr 1
  .amdhsa_system_sgpr_workgroup_id_x 1
  .amdhsa_float_denorm_mode_32 3
.end_amdhsa_kernel
```
